```python
import torch

def _softmax(x, axis=-1):
    return torch.softmax(x, dim=axis)
def _gelu(x):
    return torch.nn.functional.gelu(x, approximate="tanh")
def _silu(x):
    return torch.nn.functional.silu(x)
def _sigmoid(x):
    return torch.sigmoid(x)
def _layernorm(x, axis=-1, eps=1e-5):
    m = x.mean(dim=axis, keepdim=True)
    v = x.var(dim=axis, keepdim=True, unbiased=False)
    return (x - m) / torch.sqrt(v + eps)
def _scatter_add(tgt, idx, src, axis=0):
    return tgt.clone().index_add_(axis, idx, src)
def _segment_sum(src, seg, n):
    out = torch.zeros((n,) + src.shape[1:], dtype=src.dtype)
    return out.index_add_(0, seg, src)
def _pad(x, pw):
    flat = tuple(v for pair in reversed(pw) for v in pair)
    return torch.nn.functional.pad(x, flat)

kernel_name = 'recurrent_scan__compressed_kv_cla__glu_gated_glu__prompt'

def setup_inputs():

    _w = (lambda a: (lambda t: t.to(torch.bfloat16) if t.is_floating_point() else t)(torch.as_tensor(a)))
    def _A_setup():
        B, H, Sq, Sk, D, M = 1, 32, 2048, 2048, 128, 512
        Dc = 4 * D
        return {
            "x": _w((lambda *s: torch.randn(*s, dtype=torch.bfloat16) * 0.05)(B, Sq, M)),
            "c_kv": _w((lambda *s: torch.randn(*s, dtype=torch.bfloat16) * 0.2)(B, Sk, Dc)),
            "w_q": _w((lambda *s: torch.randn(*s, dtype=torch.bfloat16) * 3.2)(M, H, D) * (M ** -0.5)),
            "w_uk": _w((lambda *s: torch.randn(*s, dtype=torch.bfloat16) * 3.2)(Dc, H, D) * (Dc ** -0.5)),
            "w_uv": _w((lambda *s: torch.randn(*s, dtype=torch.bfloat16) * 0.2)(Dc, H, D) * (Dc ** -0.5)),
            "w_o": _w((lambda *s: torch.randn(*s, dtype=torch.bfloat16) * 0.2)(H, D, M) * ((H * D) ** -0.5)),
        }
    _A_in = _A_setup()

    def _B_setup():
        B, S, D, F = 1, 2048, 512, 1792
        return {
            "x": _w((lambda *s: torch.randn(*s, dtype=torch.bfloat16) * 0.05)(B, S, D)),
            "w_gate": _w((lambda *s: torch.randn(*s, dtype=torch.bfloat16) * 0.2)(D, F)),
            "w_up": _w((lambda *s: torch.randn(*s, dtype=torch.bfloat16) * 0.1)(D, F)),
            "w_down": _w((lambda *s: torch.randn(*s, dtype=torch.bfloat16) * 0.1)(F, D)),
        }
    _B_in = _B_setup()

    return {
        "A_x": _A_in["x"],
        "A_c_kv": _A_in["c_kv"],
        "A_w_q": _A_in["w_q"],
        "A_w_uk": _A_in["w_uk"],
        "A_w_uv": _A_in["w_uv"],
        "A_w_o": _A_in["w_o"],
        "B_x": _B_in["x"],
        "B_w_gate": _B_in["w_gate"],
        "B_w_up": _B_in["w_up"],
        "B_w_down": _B_in["w_down"],
    }

def reference(A_x, A_c_kv, A_w_q, A_w_uk, A_w_uv, A_w_o, B_x, B_w_gate, B_w_up, B_w_down):
    def _A_ref(x, c_kv, w_q, w_uk, w_uv, w_o):
        B, Sq, M = x.shape[0], x.shape[1], x.shape[2]
        Sk = c_kv.shape[1]
        H, D = w_q.shape[1], w_q.shape[2]
        q = torch.einsum("bqm,mhd->bhqd", x, w_q)
        k = torch.einsum("bkc,chd->bhkd", c_kv, w_uk)
        v = torch.einsum("bkc,chd->bhkd", c_kv, w_uv)
        scores = torch.einsum("bhqd,bhkd->bhqk", q, k) * (D ** -0.5)
        off = Sk - Sq
        qi = torch.arange(Sq)[:, None]
        kj = torch.arange(Sk)[None, :]
        cmask = kj <= (qi + off)
        scores = torch.where(cmask[None, None], scores, -1e9)
        p = _softmax(scores, axis=-1)
        ctx = torch.einsum("bhqk,bhkd->bhqd", p, v)
        return torch.einsum("bhqd,hdm->bqm", ctx, w_o)

    def _B_ref(x, w_gate, w_up, w_down):
        g = torch.einsum("bsd,df->bsf", x, w_gate)
        u = torch.einsum("bsd,df->bsf", x, w_up)
        h = _sigmoid(g) * u
        return torch.einsum("bsf,fd->bsd", h, w_down)

    x = A_x
    xn = _layernorm(x, axis=-1)
    s = _A_ref(xn, A_c_kv, A_w_q, A_w_uk, A_w_uv, A_w_o)
    g = _silu(_B_ref(xn, B_w_gate, B_w_up, B_w_down))
    return x + s * g
```

```asm
; @launch kernel=kvproj_kernel grid=(256,1,1) block=(512,1,1) lds=163840
.amdgcn_target "amdgcn-amd-amdhsa--gfx950"
.text
.globl kvproj_kernel
.p2align 8
.type kvproj_kernel,@function
kvproj_kernel:
    s_cmp_ge_u32 s2, 256
    s_cbranch_scc1 .Lk1_end
    s_load_dwordx4 s[32:35], s[0:1], 0
    s_load_dwordx4 s[36:39], s[0:1], 24
    s_load_dwordx2 s[40:41], s[0:1], 96
    s_load_dwordx2 s[52:53], s[0:1], 16
    s_load_dwordx4 s[56:59], s[0:1], 56
    s_load_dwordx2 s[92:93], s[0:1], 88
    v_lshrrev_b32 v1, 6, v0
    v_and_b32 v2, 63, v0
    v_readfirstlane_b32 s24, v1
    s_lshr_b32 s42, s2, 5
    s_and_b32 s43, s2, 31
    s_lshl_b32 s26, s24, 13
    s_lshl_b32 s27, s24, 12
    v_lshlrev_b32 v3, 4, v2
    s_lshl_b32 s44, s2, 3
    s_add_u32 s44, s44, s24
    s_lshl_b32 s45, s44, 10
    s_waitcnt lgkmcnt(0)
    s_mov_b32 s16, s32
    s_and_b32 s17, s33, 0xffff
    s_mov_b32 s18, 0x200000
    s_mov_b32 s19, 0x00020000
    s_cmp_lt_u32 s43, 16
    s_cselect_b32 s46, s36, s38
    s_cselect_b32 s47, s37, s39
    s_mov_b32 s4, s46
    s_and_b32 s5, s47, 0xffff
    s_mov_b32 s6, 0x400000
    s_mov_b32 s7, 0x00020000
    s_mov_b32 s8, s34
    s_and_b32 s9, s35, 0xffff
    s_mov_b32 s10, 0x200000
    s_mov_b32 s11, 0x00020000
    v_lshrrev_b32 v5, 5, v2
    v_lshlrev_b32 v5, 2, v5
    v_bfe_u32 v6, v2, 2, 2
    v_add_u32 v5, v5, v6
    v_lshlrev_b32 v5, 13, v5
    v_bfe_u32 v6, v2, 4, 1
    v_lshlrev_b32 v6, 6, v6
    v_and_b32 v7, 3, v2
    v_lshlrev_b32 v7, 4, v7
    v_add3_u32 v4, v5, v6, v7
    s_lshr_b32 s65, s43, 3
    s_lshl_b32 s65, s65, 1
    s_add_u32 s65, s65, s42
    s_add_u32 s48, s24, s65
    s_and_b32 s48, s48, 7
    s_lshl_b32 s48, s48, 19
    s_and_b32 s49, s43, 15
    s_lshl_b32 s49, s49, 9
    s_add_u32 s25, s48, s49
    s_lshl_b32 s66, s24, 16
    s_add_u32 s66, s66, s49
    s_lshl_b32 s67, s24, 10
    s_add_u32 m0, s67, 0x0
    s_add_u32 s28, s65, 0
    s_and_b32 s28, s28, 7
    s_lshl_b32 s28, s28, 19
    s_add_u32 s28, s28, s66
    buffer_load_dwordx4 v4, s[4:7], s28 offen lds
    s_add_u32 m0, s67, 0x2000
    s_add_u32 s28, s65, 1
    s_and_b32 s28, s28, 7
    s_lshl_b32 s28, s28, 19
    s_add_u32 s28, s28, s66
    buffer_load_dwordx4 v4, s[4:7], s28 offen lds
    v_lshrrev_b32 v5, 3, v2
    v_lshlrev_b32 v5, 10, v5
    v_and_b32 v6, 7, v2
    v_lshrrev_b32 v7, 4, v2
    v_xor_b32 v6, v6, v7
    v_lshlrev_b32 v6, 4, v6
    v_add_u32 v8, v5, v6
    v_xor_b32 v9, 64, v8
    s_lshl_b32 s48, s42, 18
    s_lshl_b32 s49, s24, 15
    s_add_u32 s29, s48, s49
    s_add_u32 s68, s65, 0
    s_and_b32 s68, s68, 7
    s_lshl_b32 s68, s68, 7
    s_add_u32 s68, s68, s29
    s_add_u32 m0, s27, 0x20000
    s_add_u32 s28, s68, 0x0
    buffer_load_dwordx4 v8, s[8:11], s28 offen lds
    s_add_u32 m0, s27, 0x20400
    s_add_u32 s28, s68, 0x2000
    buffer_load_dwordx4 v9, s[8:11], s28 offen lds
    s_add_u32 m0, s27, 0x20800
    s_add_u32 s28, s68, 0x4000
    buffer_load_dwordx4 v8, s[8:11], s28 offen lds
    s_add_u32 m0, s27, 0x20c00
    s_add_u32 s28, s68, 0x6000
    buffer_load_dwordx4 v9, s[8:11], s28 offen lds
    v_lshlrev_b32 v14, 13, v2
    s_lshl_b32 s50, s42, 19
    s_add_u32 s69, s66, s50
    s_add_u32 s69, s69, 128
    v_mov_b32 v5, 0x40000000
    v_cmp_gt_u32 vcc, 8, v2
    s_nop 1
    v_cndmask_b32 v14, v5, v14, vcc
    s_add_u32 s12, s40, 0x200000
    s_addc_u32 s13, s41, 0
    s_and_b32 s13, s13, 0xffff
    s_mov_b32 s14, 0x2000000
    s_mov_b32 s15, 0x00020000
    s_mov_b32 s20, s40
    s_and_b32 s21, s41, 0xffff
    s_mov_b32 s22, 0x200000
    s_mov_b32 s23, 0x00020000
    v_lshrrev_b32 v5, 5, v2
    v_lshlrev_b32 v5, 10, v5
    v_bfe_u32 v6, v2, 2, 2
    v_lshlrev_b32 v6, 6, v6
    v_bfe_u32 v7, v2, 4, 1
    v_lshlrev_b32 v7, 5, v7
    v_add3_u32 v5, v5, v6, v7
    v_and_b32 v6, 3, v2
    v_lshlrev_b32 v6, 3, v6
    v_add_u32 v10, v5, v6
    v_add_u32 v11, 0x10000, v10
    v_and_b32 v5, 31, v2
    v_lshrrev_b32 v6, 1, v5
    v_and_b32 v6, 7, v6
    v_lshrrev_b32 v7, 5, v2
    v_xor_b32 v6, v6, v7
    v_lshlrev_b32 v6, 4, v6
    v_lshl_add_u32 v5, v5, 7, v6
    s_add_u32 s48, s26, 0x10000
    s_add_u32 s49, s27, 0x20000
    v_xor_b32 v6, 0, v5
    v_add_u32 v96, s48, v6
    v_add_u32 v100, s49, v6
    v_xor_b32 v6, 32, v5
    v_add_u32 v97, s48, v6
    v_add_u32 v101, s49, v6
    v_xor_b32 v6, 64, v5
    v_add_u32 v98, s48, v6
    v_add_u32 v102, s49, v6
    v_xor_b32 v6, 96, v5
    v_add_u32 v99, s48, v6
    v_add_u32 v103, s49, v6
    s_and_b32 s48, s43, 15
    s_lshl_b32 s48, s48, 6
    s_lshl_b32 s49, s42, 2
    s_add_u32 s48, s48, s49
    s_lshr_b32 s49, s24, 1
    s_add_u32 s48, s48, s49
    s_lshl_b32 s48, s48, 15
    s_and_b32 s49, s24, 1
    s_lshl_b32 s49, s49, 13
    s_add_u32 s30, s48, s49
    s_and_b32 s48, s2, 7
    s_lshr_b32 s49, s2, 3
    s_and_b32 s49, s49, 3
    s_lshl_b32 s49, s49, 3
    s_add_u32 s48, s48, s49
    s_lshl_b32 s50, s42, 3
    s_add_u32 s50, s50, s24
    s_mul_i32 s49, s48, 7
    s_lshr_b32 s49, s49, 1
    s_lshl_b32 s49, s49, 5
    s_mul_i32 s64, s50, 28672
    s_add_u32 s64, s64, s49
    s_lshl_b32 s48, s48, 8
    s_lshl_b32 s80, s50, 16
    s_add_u32 s80, s80, s48
    s_mov_b32 s72, s56
    s_and_b32 s73, s57, 0xffff
    s_mov_b32 s74, 0x1c0000
    s_mov_b32 s75, 0x00020000
    s_mov_b32 s76, s58
    s_and_b32 s77, s59, 0xffff
    s_mov_b32 s78, 0x1c0000
    s_mov_b32 s79, 0x00020000
    s_mov_b32 s60, s52
    s_and_b32 s61, s53, 0xffff
    s_mov_b32 s62, 0x400000
    s_mov_b32 s63, 0x00020000
    v_lshrrev_b32 v5, 1, v2
    v_and_b32 v6, 1, v2
    v_mul_u32_u24 v13, 3584, v5
    v_mul_u32_u24 v7, 124, v6
    v_add_u32 v13, v13, v7
    v_mov_b32 v7, 0x40000000
    v_cmp_gt_u32 vcc, 16, v2
    s_nop 1
    v_cndmask_b32 v13, v7, v13, vcc
    s_add_u32 s84, s40, 0x6000000
    s_addc_u32 s85, s41, 0
    s_and_b32 s85, s85, 0xffff
    s_mov_b32 s86, 0x60000
    s_mov_b32 s87, 0x00020000
    s_lshl_b32 s81, s2, 3
    s_add_u32 s81, s81, s24
    s_cmp_lg_u32 s81, 1
    s_cbranch_scc1 .Lk1_nz
    v_lshlrev_b32 v5, 8, v2
    v_mov_b32 v6, 0
    s_mov_b32 s48, 0x0
    buffer_store_dword v6, v5, s[84:87], s48 offen sc1
    s_mov_b32 s48, 0x4000
    buffer_store_dword v6, v5, s[84:87], s48 offen sc1
    s_mov_b32 s48, 0x8000
    buffer_store_dword v6, v5, s[84:87], s48 offen sc1
    s_mov_b32 s48, 0xc000
    buffer_store_dword v6, v5, s[84:87], s48 offen sc1
    s_mov_b32 s48, 0x10000
    buffer_store_dword v6, v5, s[84:87], s48 offen sc1
    s_mov_b32 s48, 0x14000
    buffer_store_dword v6, v5, s[84:87], s48 offen sc1
    s_mov_b32 s48, 0x18000
    buffer_store_dword v6, v5, s[84:87], s48 offen sc1
    s_mov_b32 s48, 0x1c000
    buffer_store_dword v6, v5, s[84:87], s48 offen sc1
    s_mov_b32 s48, 0x20000
    buffer_store_dword v6, v5, s[84:87], s48 offen sc1
    s_mov_b32 s48, 0x24000
    buffer_store_dword v6, v5, s[84:87], s48 offen sc1
    s_mov_b32 s48, 0x28000
    buffer_store_dword v6, v5, s[84:87], s48 offen sc1
    s_mov_b32 s48, 0x2c000
    buffer_store_dword v6, v5, s[84:87], s48 offen sc1
    s_mov_b32 s48, 0x30000
    buffer_store_dword v6, v5, s[84:87], s48 offen sc1
    s_mov_b32 s48, 0x34000
    buffer_store_dword v6, v5, s[84:87], s48 offen sc1
    s_mov_b32 s48, 0x38000
    buffer_store_dword v6, v5, s[84:87], s48 offen sc1
    s_mov_b32 s48, 0x3c000
    buffer_store_dword v6, v5, s[84:87], s48 offen sc1
    s_mov_b32 s48, 0x40000
    buffer_store_dword v6, v5, s[84:87], s48 offen sc1
    s_mov_b32 s48, 0x44000
    buffer_store_dword v6, v5, s[84:87], s48 offen sc1
    s_mov_b32 s48, 0x48000
    buffer_store_dword v6, v5, s[84:87], s48 offen sc1
    s_mov_b32 s48, 0x4c000
    buffer_store_dword v6, v5, s[84:87], s48 offen sc1
    s_mov_b32 s48, 0x50000
    buffer_store_dword v6, v5, s[84:87], s48 offen sc1
    s_mov_b32 s48, 0x54000
    buffer_store_dword v6, v5, s[84:87], s48 offen sc1
    s_mov_b32 s48, 0x58000
    buffer_store_dword v6, v5, s[84:87], s48 offen sc1
    s_mov_b32 s48, 0x5c000
    buffer_store_dword v6, v5, s[84:87], s48 offen sc1
.Lk1_nz:
    s_mov_b32 s88, s92
    s_and_b32 s89, s93, 0xffff
    s_mov_b32 s90, 0x100
    s_mov_b32 s91, 0x00020000
    s_waitcnt vmcnt(4)
    s_barrier
    s_add_u32 s68, s65, 1
    s_and_b32 s68, s68, 7
    s_lshl_b32 s68, s68, 7
    s_add_u32 s68, s68, s29
    s_add_u32 m0, s26, 0x10000
    s_add_u32 s28, s68, 0x0
    buffer_load_dwordx4 v8, s[8:11], s28 offen lds
    s_add_u32 m0, s26, 0x10400
    s_add_u32 s28, s68, 0x2000
    buffer_load_dwordx4 v9, s[8:11], s28 offen lds
    s_add_u32 m0, s26, 0x10800
    s_add_u32 s28, s68, 0x4000
    buffer_load_dwordx4 v8, s[8:11], s28 offen lds
    s_add_u32 m0, s26, 0x10c00
    s_add_u32 s28, s68, 0x6000
    buffer_load_dwordx4 v9, s[8:11], s28 offen lds
    s_add_u32 m0, s67, 0x4000
    s_add_u32 s28, s65, 2
    s_and_b32 s28, s28, 7
    s_lshl_b32 s28, s28, 19
    s_add_u32 s28, s28, s66
    buffer_load_dwordx4 v4, s[4:7], s28 offen lds
    s_add_u32 m0, s67, 0x6000
    s_add_u32 s28, s65, 3
    s_and_b32 s28, s28, 7
    s_lshl_b32 s28, s28, 19
    s_add_u32 s28, s28, s66
    buffer_load_dwordx4 v4, s[4:7], s28 offen lds
    s_add_u32 s68, s65, 2
    s_and_b32 s68, s68, 7
    s_lshl_b32 s68, s68, 7
    s_add_u32 s68, s68, s29
    s_add_u32 m0, s26, 0x11000
    s_add_u32 s28, s68, 0x0
    buffer_load_dwordx4 v8, s[8:11], s28 offen lds
    s_add_u32 m0, s26, 0x11400
    s_add_u32 s28, s68, 0x2000
    buffer_load_dwordx4 v9, s[8:11], s28 offen lds
    s_add_u32 m0, s26, 0x11800
    s_add_u32 s28, s68, 0x4000
    buffer_load_dwordx4 v8, s[8:11], s28 offen lds
    s_add_u32 m0, s26, 0x11c00
    s_add_u32 s28, s68, 0x6000
    buffer_load_dwordx4 v9, s[8:11], s28 offen lds
    s_cmp_lt_u32 s43, 16
    s_cbranch_scc0 .Lk1_v
    ds_read_b64_tr_b16 v[32:33], v10 offset:0
    ds_read_b64_tr_b16 v[34:35], v10 offset:512
    ds_read_b64_tr_b16 v[36:37], v10 offset:256
    ds_read_b64_tr_b16 v[38:39], v10 offset:768
    ds_read_b64_tr_b16 v[40:41], v10 offset:2048
    ds_read_b64_tr_b16 v[42:43], v10 offset:2560
    ds_read_b64_tr_b16 v[44:45], v10 offset:2304
    ds_read_b64_tr_b16 v[46:47], v10 offset:2816
    ds_read_b64_tr_b16 v[48:49], v10 offset:4096
    ds_read_b64_tr_b16 v[50:51], v10 offset:4608
    ds_read_b64_tr_b16 v[52:53], v10 offset:4352
    ds_read_b64_tr_b16 v[54:55], v10 offset:4864
    s_waitcnt vmcnt(10)
    ds_read_b128 v[128:131], v100 offset:0
    ds_read_b128 v[132:135], v101 offset:0
    ds_read_b128 v[136:139], v102 offset:0
    ds_read_b128 v[140:143], v103 offset:0
    s_waitcnt lgkmcnt(3)
    v_mfma_f32_32x32x16_bf16 v[64:79], v[32:35], v[128:131], 0
    ds_read_b64_tr_b16 v[56:57], v10 offset:6144
    ds_read_b64_tr_b16 v[58:59], v10 offset:6656
    v_mfma_f32_32x32x16_bf16 v[80:95], v[36:39], v[128:131], 0
    ds_read_b64_tr_b16 v[60:61], v10 offset:6400
    ds_read_b64_tr_b16 v[62:63], v10 offset:6912
    s_waitcnt lgkmcnt(4)
    s_add_u32 s68, s65, 3
    s_and_b32 s68, s68, 7
    s_lshl_b32 s68, s68, 7
    s_add_u32 s68, s68, s29
    s_add_u32 m0, s27, 0x20000
    s_add_u32 s28, s68, 0x0
    buffer_load_dwordx4 v8, s[8:11], s28 offen lds
    s_add_u32 m0, s27, 0x20400
    s_add_u32 s28, s68, 0x2000
    buffer_load_dwordx4 v9, s[8:11], s28 offen lds
    s_add_u32 m0, s27, 0x20800
    s_add_u32 s28, s68, 0x4000
    buffer_load_dwordx4 v8, s[8:11], s28 offen lds
    s_add_u32 m0, s27, 0x20c00
    s_add_u32 s28, s68, 0x6000
    buffer_load_dwordx4 v9, s[8:11], s28 offen lds
    v_mfma_f32_32x32x16_bf16 v[64:79], v[40:43], v[132:135], v[64:79]
    ds_read_b64_tr_b16 v[32:33], v10 offset:8192
    ds_read_b64_tr_b16 v[34:35], v10 offset:8704
    s_waitcnt vmcnt(10)
    ds_read_b128 v[144:147], v96 offset:0
    ds_read_b128 v[148:151], v97 offset:0
    ds_read_b128 v[152:155], v98 offset:0
    ds_read_b128 v[156:159], v99 offset:0
    v_mfma_f32_32x32x16_bf16 v[80:95], v[44:47], v[132:135], v[80:95]
    ds_read_b64_tr_b16 v[36:37], v10 offset:8448
    ds_read_b64_tr_b16 v[38:39], v10 offset:8960
    v_mfma_f32_32x32x16_bf16 v[64:79], v[48:51], v[136:139], v[64:79]
    ds_read_b64_tr_b16 v[40:41], v10 offset:10240
    ds_read_b64_tr_b16 v[42:43], v10 offset:10752
    v_mfma_f32_32x32x16_bf16 v[80:95], v[52:55], v[136:139], v[80:95]
    ds_read_b64_tr_b16 v[44:45], v10 offset:10496
    ds_read_b64_tr_b16 v[46:47], v10 offset:11008
    s_waitcnt lgkmcnt(6)
    s_add_u32 s68, s65, 4
    s_and_b32 s68, s68, 7
    s_lshl_b32 s68, s68, 7
    s_add_u32 s68, s68, s29
    s_add_u32 m0, s26, 0x10000
    s_add_u32 s28, s68, 0x0
    buffer_load_dwordx4 v8, s[8:11], s28 offen lds
    s_add_u32 m0, s26, 0x10400
    s_add_u32 s28, s68, 0x2000
    buffer_load_dwordx4 v9, s[8:11], s28 offen lds
    s_add_u32 m0, s26, 0x10800
    s_add_u32 s28, s68, 0x4000
    buffer_load_dwordx4 v8, s[8:11], s28 offen lds
    s_add_u32 m0, s26, 0x10c00
    s_add_u32 s28, s68, 0x6000
    buffer_load_dwordx4 v9, s[8:11], s28 offen lds
    v_mfma_f32_32x32x16_bf16 v[64:79], v[56:59], v[140:143], v[64:79]
    ds_read_b64_tr_b16 v[48:49], v10 offset:12288
    ds_read_b64_tr_b16 v[50:51], v10 offset:12800
    s_add_u32 m0, s67, 0x8000
    s_add_u32 s28, s65, 4
    s_and_b32 s28, s28, 7
    s_lshl_b32 s28, s28, 19
    s_add_u32 s28, s28, s66
    buffer_load_dwordx4 v4, s[4:7], s28 offen lds
    s_add_u32 m0, s67, 0xa000
    s_add_u32 s28, s65, 5
    s_and_b32 s28, s28, 7
    s_lshl_b32 s28, s28, 19
    s_add_u32 s28, s28, s66
    buffer_load_dwordx4 v4, s[4:7], s28 offen lds
    v_mfma_f32_32x32x16_bf16 v[80:95], v[60:63], v[140:143], v[80:95]
    ds_read_b64_tr_b16 v[52:53], v10 offset:12544
    ds_read_b64_tr_b16 v[54:55], v10 offset:13056
    v_mfma_f32_32x32x16_bf16 v[64:79], v[32:35], v[144:147], v[64:79]
    ds_read_b64_tr_b16 v[56:57], v10 offset:14336
    ds_read_b64_tr_b16 v[58:59], v10 offset:14848
    s_waitcnt lgkmcnt(10)
    v_mfma_f32_32x32x16_bf16 v[80:95], v[36:39], v[144:147], v[80:95]
    ds_read_b64_tr_b16 v[60:61], v10 offset:14592
    ds_read_b64_tr_b16 v[62:63], v10 offset:15104
    s_waitcnt lgkmcnt(10)
    v_mfma_f32_32x32x16_bf16 v[64:79], v[40:43], v[148:151], v[64:79]
    s_waitcnt vmcnt(10)
    ds_read_b128 v[160:163], v96 offset:4096
    ds_read_b128 v[164:167], v97 offset:4096
    ds_read_b128 v[168:171], v98 offset:4096
    ds_read_b128 v[172:175], v99 offset:4096
    s_waitcnt lgkmcnt(12)
    v_mfma_f32_32x32x16_bf16 v[80:95], v[44:47], v[148:151], v[80:95]
    s_barrier
    ds_read_b64_tr_b16 v[32:33], v10 offset:16384
    ds_read_b64_tr_b16 v[34:35], v10 offset:16896
    ds_read_b64_tr_b16 v[36:37], v10 offset:16640
    ds_read_b64_tr_b16 v[38:39], v10 offset:17152
    ds_read_b64_tr_b16 v[40:41], v10 offset:18432
    ds_read_b64_tr_b16 v[42:43], v10 offset:18944
    ds_read_b64_tr_b16 v[44:45], v10 offset:18688
    ds_read_b64_tr_b16 v[46:47], v10 offset:19200
    s_waitcnt lgkmcnt(15)
    v_mfma_f32_32x32x16_bf16 v[64:79], v[48:51], v[152:155], v[64:79]
    v_mfma_f32_32x32x16_bf16 v[80:95], v[52:55], v[152:155], v[80:95]
    s_waitcnt lgkmcnt(8)
    s_add_u32 s68, s65, 5
    s_and_b32 s68, s68, 7
    s_lshl_b32 s68, s68, 7
    s_add_u32 s68, s68, s29
    s_add_u32 m0, s26, 0x11000
    s_add_u32 s28, s68, 0x0
    buffer_load_dwordx4 v8, s[8:11], s28 offen lds
    s_add_u32 m0, s26, 0x11400
    s_add_u32 s28, s68, 0x2000
    buffer_load_dwordx4 v9, s[8:11], s28 offen lds
    s_add_u32 m0, s26, 0x11800
    s_add_u32 s28, s68, 0x4000
    buffer_load_dwordx4 v8, s[8:11], s28 offen lds
    s_add_u32 m0, s26, 0x11c00
    s_add_u32 s28, s68, 0x6000
    buffer_load_dwordx4 v9, s[8:11], s28 offen lds
    s_cmp_lg_u32 s81, 1
    s_cbranch_scc1 .Lkvproj_kernel_zs_1
.Lkvproj_kernel_wb_2:
    s_waitcnt vmcnt(0)
    s_lshl_b32 s48, s2, 8
    s_add_u32 s48, s48, 0x0
    v_mov_b32 v5, s48
    v_mov_b32 v6, 1
    s_mov_b64 exec, 1
    buffer_store_dword v6, v5, s[88:91], 0 offen sc1
    s_mov_b64 exec, -1
.Lkvproj_kernel_zs_1:
    v_mfma_f32_32x32x16_bf16 v[64:79], v[56:59], v[156:159], v[64:79]
    ds_read_b64_tr_b16 v[48:49], v10 offset:20480
    ds_read_b64_tr_b16 v[50:51], v10 offset:20992
    buffer_load_dword v1, v14, s[4:7], s69 offen
    v_mfma_f32_32x32x16_bf16 v[80:95], v[60:63], v[156:159], v[80:95]
    ds_read_b64_tr_b16 v[52:53], v10 offset:20736
    ds_read_b64_tr_b16 v[54:55], v10 offset:21248
    s_waitcnt lgkmcnt(10)
    v_mfma_f32_32x32x16_bf16 v[64:79], v[32:35], v[160:163], v[64:79]
    ds_read_b64_tr_b16 v[56:57], v10 offset:22528
    ds_read_b64_tr_b16 v[58:59], v10 offset:23040
    s_waitcnt lgkmcnt(10)
    v_mfma_f32_32x32x16_bf16 v[80:95], v[36:39], v[160:163], v[80:95]
    ds_read_b64_tr_b16 v[60:61], v10 offset:22784
    ds_read_b64_tr_b16 v[62:63], v10 offset:23296
    s_waitcnt lgkmcnt(10)
    v_mfma_f32_32x32x16_bf16 v[64:79], v[40:43], v[164:167], v[64:79]
    ds_read_b64_tr_b16 v[32:33], v10 offset:24576
    ds_read_b64_tr_b16 v[34:35], v10 offset:25088
    s_waitcnt vmcnt(11)
    ds_read_b128 v[176:179], v100 offset:0
    ds_read_b128 v[180:183], v101 offset:0
    ds_read_b128 v[184:187], v102 offset:0
    ds_read_b128 v[188:191], v103 offset:0
    s_waitcnt lgkmcnt(14)
    v_mfma_f32_32x32x16_bf16 v[80:95], v[44:47], v[164:167], v[80:95]
    ds_read_b64_tr_b16 v[36:37], v10 offset:24832
    ds_read_b64_tr_b16 v[38:39], v10 offset:25344
    s_waitcnt lgkmcnt(14)
    v_mfma_f32_32x32x16_bf16 v[64:79], v[48:51], v[168:171], v[64:79]
    ds_read_b64_tr_b16 v[40:41], v10 offset:26624
    ds_read_b64_tr_b16 v[42:43], v10 offset:27136
    s_waitcnt lgkmcnt(14)
    v_mfma_f32_32x32x16_bf16 v[80:95], v[52:55], v[168:171], v[80:95]
    ds_read_b64_tr_b16 v[44:45], v10 offset:26880
    ds_read_b64_tr_b16 v[46:47], v10 offset:27392
    s_waitcnt lgkmcnt(6)
    s_add_u32 s68, s65, 6
    s_and_b32 s68, s68, 7
    s_lshl_b32 s68, s68, 7
    s_add_u32 s68, s68, s29
    s_add_u32 m0, s27, 0x20000
    s_add_u32 s28, s68, 0x0
    buffer_load_dwordx4 v8, s[8:11], s28 offen lds
    s_add_u32 m0, s27, 0x20400
    s_add_u32 s28, s68, 0x2000
    buffer_load_dwordx4 v9, s[8:11], s28 offen lds
    s_add_u32 m0, s27, 0x20800
    s_add_u32 s28, s68, 0x4000
    buffer_load_dwordx4 v8, s[8:11], s28 offen lds
    s_add_u32 m0, s27, 0x20c00
    s_add_u32 s28, s68, 0x6000
    buffer_load_dwordx4 v9, s[8:11], s28 offen lds
    v_mfma_f32_32x32x16_bf16 v[64:79], v[56:59], v[172:175], v[64:79]
    ds_read_b64_tr_b16 v[48:49], v10 offset:28672
    ds_read_b64_tr_b16 v[50:51], v10 offset:29184
    s_add_u32 m0, s67, 0xc000
    s_add_u32 s28, s65, 6
    s_and_b32 s28, s28, 7
    s_lshl_b32 s28, s28, 19
    s_add_u32 s28, s28, s66
    buffer_load_dwordx4 v4, s[4:7], s28 offen lds
    s_add_u32 m0, s67, 0xe000
    s_add_u32 s28, s65, 7
    s_and_b32 s28, s28, 7
    s_lshl_b32 s28, s28, 19
    s_add_u32 s28, s28, s66
    buffer_load_dwordx4 v4, s[4:7], s28 offen lds
    v_mfma_f32_32x32x16_bf16 v[80:95], v[60:63], v[172:175], v[80:95]
    ds_read_b64_tr_b16 v[52:53], v10 offset:28928
    ds_read_b64_tr_b16 v[54:55], v10 offset:29440
    v_mfma_f32_32x32x16_bf16 v[64:79], v[32:35], v[176:179], v[64:79]
    ds_read_b64_tr_b16 v[56:57], v10 offset:30720
    ds_read_b64_tr_b16 v[58:59], v10 offset:31232
    s_waitcnt lgkmcnt(10)
    v_mfma_f32_32x32x16_bf16 v[80:95], v[36:39], v[176:179], v[80:95]
    ds_read_b64_tr_b16 v[60:61], v10 offset:30976
    ds_read_b64_tr_b16 v[62:63], v10 offset:31488
    s_waitcnt lgkmcnt(10)
    v_mfma_f32_32x32x16_bf16 v[64:79], v[40:43], v[180:183], v[64:79]
    s_waitcnt vmcnt(13)
    ds_read_b128 v[192:195], v96 offset:0
    ds_read_b128 v[196:199], v97 offset:0
    ds_read_b128 v[200:203], v98 offset:0
    ds_read_b128 v[204:207], v99 offset:0
    s_waitcnt lgkmcnt(12)
    v_mfma_f32_32x32x16_bf16 v[80:95], v[44:47], v[180:183], v[80:95]
    s_waitcnt vmcnt(11)
    s_barrier
    ds_read_b64_tr_b16 v[32:33], v10 offset:32768
    ds_read_b64_tr_b16 v[34:35], v10 offset:33280
    ds_read_b64_tr_b16 v[36:37], v10 offset:33024
    ds_read_b64_tr_b16 v[38:39], v10 offset:33536
    ds_read_b64_tr_b16 v[40:41], v10 offset:34816
    ds_read_b64_tr_b16 v[42:43], v10 offset:35328
    ds_read_b64_tr_b16 v[44:45], v10 offset:35072
    ds_read_b64_tr_b16 v[46:47], v10 offset:35584
    s_waitcnt lgkmcnt(15)
    v_mfma_f32_32x32x16_bf16 v[64:79], v[48:51], v[184:187], v[64:79]
    v_mfma_f32_32x32x16_bf16 v[80:95], v[52:55], v[184:187], v[80:95]
    s_waitcnt lgkmcnt(8)
    s_add_u32 s68, s65, 7
    s_and_b32 s68, s68, 7
    s_lshl_b32 s68, s68, 7
    s_add_u32 s68, s68, s29
    s_add_u32 m0, s26, 0x10000
    s_add_u32 s28, s68, 0x0
    buffer_load_dwordx4 v8, s[8:11], s28 offen lds
    s_add_u32 m0, s26, 0x10400
    s_add_u32 s28, s68, 0x2000
    buffer_load_dwordx4 v9, s[8:11], s28 offen lds
    s_add_u32 m0, s26, 0x10800
    s_add_u32 s28, s68, 0x4000
    buffer_load_dwordx4 v8, s[8:11], s28 offen lds
    s_add_u32 m0, s26, 0x10c00
    s_add_u32 s28, s68, 0x6000
    buffer_load_dwordx4 v9, s[8:11], s28 offen lds
    v_mfma_f32_32x32x16_bf16 v[64:79], v[56:59], v[188:191], v[64:79]
    ds_read_b64_tr_b16 v[48:49], v10 offset:36864
    ds_read_b64_tr_b16 v[50:51], v10 offset:37376
    buffer_load_dword v1, v14, s[4:7], s69 offen offset:128
    v_mfma_f32_32x32x16_bf16 v[80:95], v[60:63], v[188:191], v[80:95]
    ds_read_b64_tr_b16 v[52:53], v10 offset:37120
    ds_read_b64_tr_b16 v[54:55], v10 offset:37632
    s_waitcnt lgkmcnt(10)
    v_mfma_f32_32x32x16_bf16 v[64:79], v[32:35], v[192:195], v[64:79]
    ds_read_b64_tr_b16 v[56:57], v10 offset:38912
    ds_read_b64_tr_b16 v[58:59], v10 offset:39424
    s_waitcnt lgkmcnt(10)
    v_mfma_f32_32x32x16_bf16 v[80:95], v[36:39], v[192:195], v[80:95]
    ds_read_b64_tr_b16 v[60:61], v10 offset:39168
    ds_read_b64_tr_b16 v[62:63], v10 offset:39680
    s_waitcnt lgkmcnt(10)
    v_mfma_f32_32x32x16_bf16 v[64:79], v[40:43], v[196:199], v[64:79]
    ds_read_b64_tr_b16 v[32:33], v10 offset:40960
    ds_read_b64_tr_b16 v[34:35], v10 offset:41472
    s_waitcnt vmcnt(12)
    ds_read_b128 v[208:211], v96 offset:4096
    ds_read_b128 v[212:215], v97 offset:4096
    ds_read_b128 v[216:219], v98 offset:4096
    ds_read_b128 v[220:223], v99 offset:4096
    s_waitcnt lgkmcnt(14)
    v_mfma_f32_32x32x16_bf16 v[80:95], v[44:47], v[196:199], v[80:95]
    ds_read_b64_tr_b16 v[36:37], v10 offset:41216
    ds_read_b64_tr_b16 v[38:39], v10 offset:41728
    s_waitcnt lgkmcnt(14)
    v_mfma_f32_32x32x16_bf16 v[64:79], v[48:51], v[200:203], v[64:79]
    ds_read_b64_tr_b16 v[40:41], v10 offset:43008
    ds_read_b64_tr_b16 v[42:43], v10 offset:43520
    s_waitcnt lgkmcnt(14)
    v_mfma_f32_32x32x16_bf16 v[80:95], v[52:55], v[200:203], v[80:95]
    ds_read_b64_tr_b16 v[44:45], v10 offset:43264
    ds_read_b64_tr_b16 v[46:47], v10 offset:43776
    s_waitcnt lgkmcnt(6)
    s_add_u32 m0, s26, 0x11000
    s_add_u32 s28, s25, 0x40080
    buffer_load_dwordx4 v4, s[4:7], s28 offen lds
    s_add_u32 m0, s26, 0x11400
    s_add_u32 s28, s25, 0x50080
    buffer_load_dwordx4 v4, s[4:7], s28 offen lds
    s_add_u32 m0, s26, 0x11800
    s_add_u32 s28, s25, 0x60080
    buffer_load_dwordx4 v4, s[4:7], s28 offen lds
    s_add_u32 m0, s26, 0x11c00
    s_add_u32 s28, s25, 0x70080
    buffer_load_dwordx4 v4, s[4:7], s28 offen lds
    v_mfma_f32_32x32x16_bf16 v[64:79], v[56:59], v[204:207], v[64:79]
    ds_read_b64_tr_b16 v[48:49], v10 offset:45056
    ds_read_b64_tr_b16 v[50:51], v10 offset:45568
    v_mfma_f32_32x32x16_bf16 v[80:95], v[60:63], v[204:207], v[80:95]
    ds_read_b64_tr_b16 v[52:53], v10 offset:45312
    ds_read_b64_tr_b16 v[54:55], v10 offset:45824
    v_mfma_f32_32x32x16_bf16 v[64:79], v[32:35], v[208:211], v[64:79]
    ds_read_b64_tr_b16 v[56:57], v10 offset:47104
    ds_read_b64_tr_b16 v[58:59], v10 offset:47616
    buffer_load_dwordx4 v[6:9], v3, s[16:19], s45 offen
    s_waitcnt lgkmcnt(10)
    v_mfma_f32_32x32x16_bf16 v[80:95], v[36:39], v[208:211], v[80:95]
    ds_read_b64_tr_b16 v[60:61], v10 offset:47360
    ds_read_b64_tr_b16 v[62:63], v10 offset:47872
    s_waitcnt lgkmcnt(10)
    v_mfma_f32_32x32x16_bf16 v[64:79], v[40:43], v[212:215], v[64:79]
    s_waitcnt vmcnt(12)
    ds_read_b128 v[224:227], v100 offset:0
    ds_read_b128 v[228:231], v101 offset:0
    ds_read_b128 v[232:235], v102 offset:0
    ds_read_b128 v[236:239], v103 offset:0
    s_waitcnt lgkmcnt(12)
    v_mfma_f32_32x32x16_bf16 v[80:95], v[44:47], v[212:215], v[80:95]
    s_waitcnt vmcnt(10)
    s_barrier
    ds_read_b64_tr_b16 v[32:33], v10 offset:49152
    ds_read_b64_tr_b16 v[34:35], v10 offset:49664
    ds_read_b64_tr_b16 v[36:37], v10 offset:49408
    ds_read_b64_tr_b16 v[38:39], v10 offset:49920
    ds_read_b64_tr_b16 v[40:41], v10 offset:51200
    ds_read_b64_tr_b16 v[42:43], v10 offset:51712
    ds_read_b64_tr_b16 v[44:45], v10 offset:51456
    ds_read_b64_tr_b16 v[46:47], v10 offset:51968
    s_waitcnt lgkmcnt(15)
    v_mfma_f32_32x32x16_bf16 v[64:79], v[48:51], v[216:219], v[64:79]
    v_mfma_f32_32x32x16_bf16 v[80:95], v[52:55], v[216:219], v[80:95]
    s_waitcnt lgkmcnt(8)
    v_mfma_f32_32x32x16_bf16 v[64:79], v[56:59], v[220:223], v[64:79]
    ds_read_b64_tr_b16 v[48:49], v10 offset:53248
    ds_read_b64_tr_b16 v[50:51], v10 offset:53760
    buffer_load_dword v1, v14, s[4:7], s69 offen offset:256
    v_mfma_f32_32x32x16_bf16 v[80:95], v[60:63], v[220:223], v[80:95]
    ds_read_b64_tr_b16 v[52:53], v10 offset:53504
    ds_read_b64_tr_b16 v[54:55], v10 offset:54016
    s_waitcnt lgkmcnt(10)
    v_mfma_f32_32x32x16_bf16 v[64:79], v[32:35], v[224:227], v[64:79]
    ds_read_b64_tr_b16 v[56:57], v10 offset:55296
    ds_read_b64_tr_b16 v[58:59], v10 offset:55808
    s_waitcnt lgkmcnt(10)
    v_mfma_f32_32x32x16_bf16 v[80:95], v[36:39], v[224:227], v[80:95]
    ds_read_b64_tr_b16 v[60:61], v10 offset:55552
    ds_read_b64_tr_b16 v[62:63], v10 offset:56064
    s_waitcnt lgkmcnt(10)
    v_mfma_f32_32x32x16_bf16 v[64:79], v[40:43], v[228:231], v[64:79]
    ds_read_b64_tr_b16 v[32:33], v10 offset:57344
    ds_read_b64_tr_b16 v[34:35], v10 offset:57856
    s_waitcnt vmcnt(7)
    ds_read_b128 v[240:243], v96 offset:0
    ds_read_b128 v[244:247], v97 offset:0
    ds_read_b128 v[248:251], v98 offset:0
    ds_read_b128 v[252:255], v99 offset:0
    s_waitcnt lgkmcnt(14)
    v_mfma_f32_32x32x16_bf16 v[80:95], v[44:47], v[228:231], v[80:95]
    ds_read_b64_tr_b16 v[36:37], v10 offset:57600
    ds_read_b64_tr_b16 v[38:39], v10 offset:58112
    s_waitcnt lgkmcnt(14)
    v_mfma_f32_32x32x16_bf16 v[64:79], v[48:51], v[232:235], v[64:79]
    ds_read_b64_tr_b16 v[40:41], v10 offset:59392
    ds_read_b64_tr_b16 v[42:43], v10 offset:59904
    s_waitcnt lgkmcnt(14)
    v_mfma_f32_32x32x16_bf16 v[80:95], v[52:55], v[232:235], v[80:95]
    ds_read_b64_tr_b16 v[44:45], v10 offset:59648
    ds_read_b64_tr_b16 v[46:47], v10 offset:60160
    s_waitcnt lgkmcnt(6)
    s_add_u32 m0, s26, 0x10000
    s_add_u32 s28, s25, 0x80
    buffer_load_dwordx4 v4, s[4:7], s28 offen lds
    s_add_u32 m0, s26, 0x10400
    s_add_u32 s28, s25, 0x10080
    buffer_load_dwordx4 v4, s[4:7], s28 offen lds
    s_add_u32 m0, s26, 0x10800
    s_add_u32 s28, s25, 0x20080
    buffer_load_dwordx4 v4, s[4:7], s28 offen lds
    s_add_u32 m0, s26, 0x10c00
    s_add_u32 s28, s25, 0x30080
    buffer_load_dwordx4 v4, s[4:7], s28 offen lds
    v_mfma_f32_32x32x16_bf16 v[64:79], v[56:59], v[236:239], v[64:79]
    ds_read_b64_tr_b16 v[48:49], v10 offset:61440
    ds_read_b64_tr_b16 v[50:51], v10 offset:61952
    v_mfma_f32_32x32x16_bf16 v[80:95], v[60:63], v[236:239], v[80:95]
    ds_read_b64_tr_b16 v[52:53], v10 offset:61696
    ds_read_b64_tr_b16 v[54:55], v10 offset:62208
    v_mfma_f32_32x32x16_bf16 v[64:79], v[32:35], v[240:243], v[64:79]
    ds_read_b64_tr_b16 v[56:57], v10 offset:63488
    ds_read_b64_tr_b16 v[58:59], v10 offset:64000
    s_waitcnt lgkmcnt(10)
    v_mfma_f32_32x32x16_bf16 v[80:95], v[36:39], v[240:243], v[80:95]
    ds_read_b64_tr_b16 v[60:61], v10 offset:63744
    ds_read_b64_tr_b16 v[62:63], v10 offset:64256
    s_waitcnt lgkmcnt(10)
    v_mfma_f32_32x32x16_bf16 v[64:79], v[40:43], v[244:247], v[64:79]
    s_waitcnt lgkmcnt(8)
    v_mfma_f32_32x32x16_bf16 v[80:95], v[44:47], v[244:247], v[80:95]
    s_waitcnt vmcnt(6) lgkmcnt(0)
    s_barrier
    ds_read_b64_tr_b16 v[32:33], v11 offset:4096
    ds_read_b64_tr_b16 v[34:35], v11 offset:4608
    ds_read_b64_tr_b16 v[36:37], v11 offset:4352
    ds_read_b64_tr_b16 v[38:39], v11 offset:4864
    ds_read_b64_tr_b16 v[40:41], v11 offset:6144
    ds_read_b64_tr_b16 v[42:43], v11 offset:6656
    ds_read_b64_tr_b16 v[44:45], v11 offset:6400
    ds_read_b64_tr_b16 v[46:47], v11 offset:6912
    v_mfma_f32_32x32x16_bf16 v[64:79], v[48:51], v[248:251], v[64:79]
    v_mfma_f32_32x32x16_bf16 v[80:95], v[52:55], v[248:251], v[80:95]
    v_mfma_f32_32x32x16_bf16 v[64:79], v[56:59], v[252:255], v[64:79]
    ds_read_b64_tr_b16 v[48:49], v11 offset:12288
    ds_read_b64_tr_b16 v[50:51], v11 offset:12800
    v_mfma_f32_32x32x16_bf16 v[80:95], v[60:63], v[252:255], v[80:95]
    ds_read_b64_tr_b16 v[52:53], v11 offset:12544
    ds_read_b64_tr_b16 v[54:55], v11 offset:13056
    s_waitcnt lgkmcnt(10)
    v_mfma_f32_32x32x16_bf16 v[96:111], v[32:35], v[136:139], 0
    ds_read_b64_tr_b16 v[56:57], v11 offset:14336
    ds_read_b64_tr_b16 v[58:59], v11 offset:14848
    s_waitcnt lgkmcnt(10)
    v_mfma_f32_32x32x16_bf16 v[112:127], v[36:39], v[136:139], 0
    ds_read_b64_tr_b16 v[60:61], v11 offset:14592
    ds_read_b64_tr_b16 v[62:63], v11 offset:15104
    s_add_u32 m0, s26, 0x0
    s_add_u32 s28, s25, 0x100
    buffer_load_dwordx4 v4, s[4:7], s28 offen lds
    s_waitcnt lgkmcnt(10)
    v_mfma_f32_32x32x16_bf16 v[96:111], v[40:43], v[140:143], v[96:111]
    ds_read_b64_tr_b16 v[32:33], v11 offset:20480
    ds_read_b64_tr_b16 v[34:35], v11 offset:20992
    s_add_u32 m0, s26, 0x400
    s_add_u32 s28, s25, 0x10100
    buffer_load_dwordx4 v4, s[4:7], s28 offen lds
    s_waitcnt lgkmcnt(10)
    v_mfma_f32_32x32x16_bf16 v[112:127], v[44:47], v[140:143], v[112:127]
    ds_read_b64_tr_b16 v[36:37], v11 offset:20736
    ds_read_b64_tr_b16 v[38:39], v11 offset:21248
    s_add_u32 m0, s26, 0x800
    s_add_u32 s28, s25, 0x20100
    buffer_load_dwordx4 v4, s[4:7], s28 offen lds
    s_waitcnt lgkmcnt(10)
    v_mfma_f32_32x32x16_bf16 v[96:111], v[48:51], v[152:155], v[96:111]
    ds_read_b64_tr_b16 v[40:41], v11 offset:22528
    ds_read_b64_tr_b16 v[42:43], v11 offset:23040
    s_add_u32 m0, s26, 0xc00
    s_add_u32 s28, s25, 0x30100
    buffer_load_dwordx4 v4, s[4:7], s28 offen lds
    s_waitcnt lgkmcnt(10)
    v_mfma_f32_32x32x16_bf16 v[112:127], v[52:55], v[152:155], v[112:127]
    ds_read_b64_tr_b16 v[44:45], v11 offset:22784
    ds_read_b64_tr_b16 v[46:47], v11 offset:23296
    s_add_u32 m0, s26, 0x1000
    s_add_u32 s28, s25, 0x40100
    buffer_load_dwordx4 v4, s[4:7], s28 offen lds
    s_waitcnt lgkmcnt(10)
    v_mfma_f32_32x32x16_bf16 v[96:111], v[56:59], v[156:159], v[96:111]
    ds_read_b64_tr_b16 v[48:49], v11 offset:28672
    ds_read_b64_tr_b16 v[50:51], v11 offset:29184
    s_add_u32 m0, s26, 0x1400
    s_add_u32 s28, s25, 0x50100
    buffer_load_dwordx4 v4, s[4:7], s28 offen lds
    s_waitcnt lgkmcnt(10)
    v_mfma_f32_32x32x16_bf16 v[112:127], v[60:63], v[156:159], v[112:127]
    ds_read_b64_tr_b16 v[52:53], v11 offset:28928
    ds_read_b64_tr_b16 v[54:55], v11 offset:29440
    s_add_u32 m0, s26, 0x1800
    s_add_u32 s28, s25, 0x60100
    buffer_load_dwordx4 v4, s[4:7], s28 offen lds
    s_waitcnt lgkmcnt(10)
    v_mfma_f32_32x32x16_bf16 v[96:111], v[32:35], v[168:171], v[96:111]
    ds_read_b64_tr_b16 v[56:57], v11 offset:30720
    ds_read_b64_tr_b16 v[58:59], v11 offset:31232
    s_add_u32 m0, s26, 0x1c00
    s_add_u32 s28, s25, 0x70100
    buffer_load_dwordx4 v4, s[4:7], s28 offen lds
    s_waitcnt lgkmcnt(10)
    v_mfma_f32_32x32x16_bf16 v[112:127], v[36:39], v[168:171], v[112:127]
    ds_read_b64_tr_b16 v[60:61], v11 offset:30976
    ds_read_b64_tr_b16 v[62:63], v11 offset:31488
    s_waitcnt lgkmcnt(10)
    v_mfma_f32_32x32x16_bf16 v[96:111], v[40:43], v[172:175], v[96:111]
    ds_read_b64_tr_b16 v[32:33], v11 offset:36864
    ds_read_b64_tr_b16 v[34:35], v11 offset:37376
    v_cvt_pk_bf16_f32 v16, v64, v65
    v_cvt_pk_bf16_f32 v17, v66, v67
    v_cvt_pk_bf16_f32 v18, v68, v69
    v_cvt_pk_bf16_f32 v19, v70, v71
    s_waitcnt lgkmcnt(10)
    v_mfma_f32_32x32x16_bf16 v[112:127], v[44:47], v[172:175], v[112:127]
    ds_read_b64_tr_b16 v[36:37], v11 offset:37120
    ds_read_b64_tr_b16 v[38:39], v11 offset:37632
    s_add_u32 s28, s30, 0x0
    buffer_store_dwordx4 v[16:19], v3, s[12:15], s28 offen sc1
    s_waitcnt lgkmcnt(10)
    v_mfma_f32_32x32x16_bf16 v[96:111], v[48:51], v[184:187], v[96:111]
    ds_read_b64_tr_b16 v[40:41], v11 offset:38912
    ds_read_b64_tr_b16 v[42:43], v11 offset:39424
    s_waitcnt lgkmcnt(10)
    v_mfma_f32_32x32x16_bf16 v[112:127], v[52:55], v[184:187], v[112:127]
    ds_read_b64_tr_b16 v[44:45], v11 offset:39168
    ds_read_b64_tr_b16 v[46:47], v11 offset:39680
    v_cvt_pk_bf16_f32 v20, v72, v73
    v_cvt_pk_bf16_f32 v21, v74, v75
    v_cvt_pk_bf16_f32 v22, v76, v77
    v_cvt_pk_bf16_f32 v23, v78, v79
    s_waitcnt lgkmcnt(10)
    v_mfma_f32_32x32x16_bf16 v[96:111], v[56:59], v[188:191], v[96:111]
    ds_read_b64_tr_b16 v[48:49], v11 offset:45056
    ds_read_b64_tr_b16 v[50:51], v11 offset:45568
    s_add_u32 s28, s30, 0x400
    buffer_store_dwordx4 v[20:23], v3, s[12:15], s28 offen sc1
    s_waitcnt lgkmcnt(10)
    v_mfma_f32_32x32x16_bf16 v[112:127], v[60:63], v[188:191], v[112:127]
    ds_read_b64_tr_b16 v[52:53], v11 offset:45312
    ds_read_b64_tr_b16 v[54:55], v11 offset:45824
    s_waitcnt lgkmcnt(10)
    v_mfma_f32_32x32x16_bf16 v[96:111], v[32:35], v[200:203], v[96:111]
    ds_read_b64_tr_b16 v[56:57], v11 offset:47104
    ds_read_b64_tr_b16 v[58:59], v11 offset:47616
    v_cvt_pk_bf16_f32 v24, v80, v81
    v_cvt_pk_bf16_f32 v25, v82, v83
    v_cvt_pk_bf16_f32 v26, v84, v85
    v_cvt_pk_bf16_f32 v27, v86, v87
    s_waitcnt lgkmcnt(10)
    v_mfma_f32_32x32x16_bf16 v[112:127], v[36:39], v[200:203], v[112:127]
    ds_read_b64_tr_b16 v[60:61], v11 offset:47360
    ds_read_b64_tr_b16 v[62:63], v11 offset:47872
    s_add_u32 s28, s30, 0x800
    buffer_store_dwordx4 v[24:27], v3, s[12:15], s28 offen sc1
    s_waitcnt lgkmcnt(10)
    v_mfma_f32_32x32x16_bf16 v[96:111], v[40:43], v[204:207], v[96:111]
    ds_read_b64_tr_b16 v[32:33], v11 offset:53248
    ds_read_b64_tr_b16 v[34:35], v11 offset:53760
    s_waitcnt lgkmcnt(10)
    v_mfma_f32_32x32x16_bf16 v[112:127], v[44:47], v[204:207], v[112:127]
    ds_read_b64_tr_b16 v[36:37], v11 offset:53504
    ds_read_b64_tr_b16 v[38:39], v11 offset:54016
    v_cvt_pk_bf16_f32 v28, v88, v89
    v_cvt_pk_bf16_f32 v29, v90, v91
    v_cvt_pk_bf16_f32 v30, v92, v93
    v_cvt_pk_bf16_f32 v31, v94, v95
    s_waitcnt lgkmcnt(10)
    v_mfma_f32_32x32x16_bf16 v[96:111], v[48:51], v[216:219], v[96:111]
    ds_read_b64_tr_b16 v[40:41], v11 offset:55296
    ds_read_b64_tr_b16 v[42:43], v11 offset:55808
    s_add_u32 s28, s30, 0xc00
    buffer_store_dwordx4 v[28:31], v3, s[12:15], s28 offen sc1
    s_waitcnt lgkmcnt(10)
    v_mfma_f32_32x32x16_bf16 v[112:127], v[52:55], v[216:219], v[112:127]
    ds_read_b64_tr_b16 v[44:45], v11 offset:55552
    ds_read_b64_tr_b16 v[46:47], v11 offset:56064
    s_waitcnt vmcnt(17)
    s_waitcnt lgkmcnt(10)
    v_mfma_f32_32x32x16_bf16 v[96:111], v[56:59], v[220:223], v[96:111]
    ds_read_b64_tr_b16 v[48:49], v11 offset:61440
    ds_read_b64_tr_b16 v[50:51], v11 offset:61952
    v_lshlrev_b32 v64, 16, v6
    v_and_b32 v65, 0xffff0000, v6
    v_lshlrev_b32 v66, 16, v7
    v_and_b32 v67, 0xffff0000, v7
    s_waitcnt lgkmcnt(10)
    v_mfma_f32_32x32x16_bf16 v[112:127], v[60:63], v[220:223], v[112:127]
    ds_read_b64_tr_b16 v[52:53], v11 offset:61696
    ds_read_b64_tr_b16 v[54:55], v11 offset:62208
    v_lshlrev_b32 v68, 16, v8
    v_and_b32 v69, 0xffff0000, v8
    v_lshlrev_b32 v70, 16, v9
    s_waitcnt lgkmcnt(10)
    v_mfma_f32_32x32x16_bf16 v[96:111], v[32:35], v[232:235], v[96:111]
    ds_read_b64_tr_b16 v[56:57], v11 offset:63488
    ds_read_b64_tr_b16 v[58:59], v11 offset:64000
    v_and_b32 v71, 0xffff0000, v9
    v_add_f32 v72, v64, v65
    v_add_f32 v72, v72, v66
    v_add_f32 v72, v72, v67
    s_waitcnt lgkmcnt(10)
    v_mfma_f32_32x32x16_bf16 v[112:127], v[36:39], v[232:235], v[112:127]
    ds_read_b64_tr_b16 v[60:61], v11 offset:63744
    ds_read_b64_tr_b16 v[62:63], v11 offset:64256
    v_add_f32 v72, v72, v68
    v_add_f32 v72, v72, v69
    v_add_f32 v72, v72, v70
    s_waitcnt lgkmcnt(10)
    v_mfma_f32_32x32x16_bf16 v[96:111], v[40:43], v[236:239], v[96:111]
    v_add_f32 v72, v72, v71
    s_nop 1
    v_add_f32_dpp v72, v72, v72 quad_perm:[1,0,3,2] row_mask:0xf bank_mask:0xf
    s_nop 1
    v_add_f32_dpp v72, v72, v72 quad_perm:[2,3,0,1] row_mask:0xf bank_mask:0xf
    s_nop 1
    v_add_f32_dpp v72, v72, v72 row_half_mirror row_mask:0xf bank_mask:0xf
    s_waitcnt lgkmcnt(8)
    v_mfma_f32_32x32x16_bf16 v[112:127], v[44:47], v[236:239], v[112:127]
    s_waitcnt vmcnt(12)
    s_barrier
    ds_read_b64_tr_b16 v[32:33], v11 offset:0
    ds_read_b64_tr_b16 v[34:35], v11 offset:512
    ds_read_b64_tr_b16 v[36:37], v11 offset:256
    ds_read_b64_tr_b16 v[38:39], v11 offset:768
    ds_read_b64_tr_b16 v[40:41], v11 offset:2048
    ds_read_b64_tr_b16 v[42:43], v11 offset:2560
    ds_read_b64_tr_b16 v[44:45], v11 offset:2304
    ds_read_b64_tr_b16 v[46:47], v11 offset:2816
    v_add_f32_dpp v72, v72, v72 row_mirror row_mask:0xf bank_mask:0xf
    v_mov_b32 v74, v72
    s_nop 1
    v_permlane16_swap_b32 v72, v74
    s_waitcnt lgkmcnt(14)
    v_mfma_f32_32x32x16_bf16 v[96:111], v[48:51], v[248:251], v[96:111]
    v_add_f32 v72, v72, v74
    v_mov_b32 v74, v72
    s_nop 1
    v_permlane32_swap_b32 v72, v74
    v_add_f32 v72, v72, v74
    s_waitcnt lgkmcnt(12)
    v_mfma_f32_32x32x16_bf16 v[112:127], v[52:55], v[248:251], v[112:127]
    v_mul_f32 v72, 0x3b000000, v72
    v_sub_f32 v76, v64, v72
    v_sub_f32 v77, v65, v72
    s_waitcnt lgkmcnt(10)
    v_mfma_f32_32x32x16_bf16 v[96:111], v[56:59], v[252:255], v[96:111]
    ds_read_b64_tr_b16 v[48:49], v11 offset:8192
    ds_read_b64_tr_b16 v[50:51], v11 offset:8704
    v_sub_f32 v78, v66, v72
    v_sub_f32 v79, v67, v72
    v_sub_f32 v80, v68, v72
    v_sub_f32 v81, v69, v72
    s_waitcnt lgkmcnt(10)
    v_mfma_f32_32x32x16_bf16 v[112:127], v[60:63], v[252:255], v[112:127]
    ds_read_b64_tr_b16 v[52:53], v11 offset:8448
    ds_read_b64_tr_b16 v[54:55], v11 offset:8960
    buffer_load_dword v1, v13, s[72:75], s64 offen
    v_sub_f32 v82, v70, v72
    v_sub_f32 v83, v71, v72
    v_mul_f32 v73, v76, v76
    s_waitcnt lgkmcnt(10)
    v_mfma_f32_32x32x16_bf16 v[96:111], v[32:35], v[128:131], v[96:111]
    ds_read_b64_tr_b16 v[56:57], v11 offset:10240
    ds_read_b64_tr_b16 v[58:59], v11 offset:10752
    v_fmac_f32 v73, v77, v77
    v_fmac_f32 v73, v78, v78
    v_fmac_f32 v73, v79, v79
    v_fmac_f32 v73, v80, v80
    s_waitcnt lgkmcnt(10)
    v_mfma_f32_32x32x16_bf16 v[112:127], v[36:39], v[128:131], v[112:127]
    ds_read_b64_tr_b16 v[60:61], v11 offset:10496
    ds_read_b64_tr_b16 v[62:63], v11 offset:11008
    v_fmac_f32 v73, v81, v81
    v_fmac_f32 v73, v82, v82
    v_fmac_f32 v73, v83, v83
    s_waitcnt lgkmcnt(10)
    v_mfma_f32_32x32x16_bf16 v[96:111], v[40:43], v[132:135], v[96:111]
    ds_read_b64_tr_b16 v[32:33], v11 offset:16384
    ds_read_b64_tr_b16 v[34:35], v11 offset:16896
    v_add_f32_dpp v73, v73, v73 quad_perm:[1,0,3,2] row_mask:0xf bank_mask:0xf
    s_nop 1
    v_add_f32_dpp v73, v73, v73 quad_perm:[2,3,0,1] row_mask:0xf bank_mask:0xf
    s_nop 1
    v_add_f32_dpp v73, v73, v73 row_half_mirror row_mask:0xf bank_mask:0xf
    s_nop 1
    v_add_f32_dpp v73, v73, v73 row_mirror row_mask:0xf bank_mask:0xf
    s_waitcnt lgkmcnt(10)
    v_mfma_f32_32x32x16_bf16 v[112:127], v[44:47], v[132:135], v[112:127]
    ds_read_b64_tr_b16 v[36:37], v11 offset:16640
    ds_read_b64_tr_b16 v[38:39], v11 offset:17152
    v_mov_b32 v74, v73
    s_nop 1
    v_permlane16_swap_b32 v73, v74
    v_add_f32 v73, v73, v74
    s_waitcnt lgkmcnt(10)
    v_mfma_f32_32x32x16_bf16 v[96:111], v[48:51], v[144:147], v[96:111]
    ds_read_b64_tr_b16 v[40:41], v11 offset:18432
    ds_read_b64_tr_b16 v[42:43], v11 offset:18944
    v_mov_b32 v74, v73
    s_nop 1
    v_permlane32_swap_b32 v73, v74
    v_add_f32 v73, v73, v74
    v_mul_f32 v73, 0x3b000000, v73
    s_waitcnt lgkmcnt(10)
    v_mfma_f32_32x32x16_bf16 v[112:127], v[52:55], v[144:147], v[112:127]
    ds_read_b64_tr_b16 v[44:45], v11 offset:18688
    ds_read_b64_tr_b16 v[46:47], v11 offset:19200
    v_cvt_pk_bf16_f32 v74, v72, v73
    v_lshlrev_b32 v72, 16, v74
    v_and_b32 v73, 0xffff0000, v74
    s_waitcnt lgkmcnt(10)
    v_mfma_f32_32x32x16_bf16 v[96:111], v[56:59], v[148:151], v[96:111]
    ds_read_b64_tr_b16 v[48:49], v11 offset:24576
    ds_read_b64_tr_b16 v[50:51], v11 offset:25088
    v_add_f32 v73, 0x3727c5ac, v73
    v_cvt_pk_bf16_f32 v73, v73, v73
    v_and_b32 v73, 0xffff0000, v73
    v_sqrt_f32 v73, v73
    s_waitcnt lgkmcnt(10)
    v_mfma_f32_32x32x16_bf16 v[112:127], v[60:63], v[148:151], v[112:127]
    ds_read_b64_tr_b16 v[52:53], v11 offset:24832
    ds_read_b64_tr_b16 v[54:55], v11 offset:25344
    v_cvt_pk_bf16_f32 v73, v73, v73
    v_and_b32 v73, 0xffff0000, v73
    v_rcp_f32 v74, v73
    s_waitcnt lgkmcnt(10)
    v_mfma_f32_32x32x16_bf16 v[96:111], v[32:35], v[160:163], v[96:111]
    ds_read_b64_tr_b16 v[56:57], v11 offset:26624
    ds_read_b64_tr_b16 v[58:59], v11 offset:27136
    v_sub_f32 v64, v64, v72
    v_sub_f32 v65, v65, v72
    v_sub_f32 v66, v66, v72
    v_sub_f32 v67, v67, v72
    s_waitcnt lgkmcnt(10)
    v_mfma_f32_32x32x16_bf16 v[112:127], v[36:39], v[160:163], v[112:127]
    ds_read_b64_tr_b16 v[60:61], v11 offset:26880
    ds_read_b64_tr_b16 v[62:63], v11 offset:27392
    v_sub_f32 v68, v68, v72
    v_sub_f32 v69, v69, v72
    v_sub_f32 v70, v70, v72
    s_waitcnt lgkmcnt(10)
    v_mfma_f32_32x32x16_bf16 v[96:111], v[40:43], v[164:167], v[96:111]
    ds_read_b64_tr_b16 v[32:33], v11 offset:32768
    ds_read_b64_tr_b16 v[34:35], v11 offset:33280
    v_sub_f32 v71, v71, v72
    v_cvt_pk_bf16_f32 v6, v64, v65
    v_cvt_pk_bf16_f32 v7, v66, v67
    v_cvt_pk_bf16_f32 v8, v68, v69
    s_waitcnt lgkmcnt(10)
    v_mfma_f32_32x32x16_bf16 v[112:127], v[44:47], v[164:167], v[112:127]
    ds_read_b64_tr_b16 v[36:37], v11 offset:33024
    ds_read_b64_tr_b16 v[38:39], v11 offset:33536
    v_cvt_pk_bf16_f32 v9, v70, v71
    v_lshlrev_b32 v64, 16, v6
    v_and_b32 v65, 0xffff0000, v6
    s_waitcnt lgkmcnt(10)
    v_mfma_f32_32x32x16_bf16 v[96:111], v[48:51], v[176:179], v[96:111]
    ds_read_b64_tr_b16 v[40:41], v11 offset:34816
    ds_read_b64_tr_b16 v[42:43], v11 offset:35328
    v_lshlrev_b32 v66, 16, v7
    v_and_b32 v67, 0xffff0000, v7
    v_lshlrev_b32 v68, 16, v8
    v_and_b32 v69, 0xffff0000, v8
    s_waitcnt lgkmcnt(10)
    v_mfma_f32_32x32x16_bf16 v[112:127], v[52:55], v[176:179], v[112:127]
    ds_read_b64_tr_b16 v[44:45], v11 offset:35072
    ds_read_b64_tr_b16 v[46:47], v11 offset:35584
    v_lshlrev_b32 v70, 16, v9
    v_and_b32 v71, 0xffff0000, v9
    v_mul_f32 v76, v64, v74
    s_waitcnt lgkmcnt(10)
    v_mfma_f32_32x32x16_bf16 v[96:111], v[56:59], v[180:183], v[96:111]
    ds_read_b64_tr_b16 v[48:49], v11 offset:40960
    ds_read_b64_tr_b16 v[50:51], v11 offset:41472
    v_mul_f32 v77, v65, v74
    v_mul_f32 v78, v66, v74
    v_mul_f32 v79, v67, v74
    v_mul_f32 v80, v68, v74
    s_waitcnt lgkmcnt(10)
    v_mfma_f32_32x32x16_bf16 v[112:127], v[60:63], v[180:183], v[112:127]
    ds_read_b64_tr_b16 v[52:53], v11 offset:41216
    ds_read_b64_tr_b16 v[54:55], v11 offset:41728
    v_mul_f32 v81, v69, v74
    v_mul_f32 v82, v70, v74
    v_mul_f32 v83, v71, v74
    s_waitcnt lgkmcnt(10)
    v_mfma_f32_32x32x16_bf16 v[96:111], v[32:35], v[192:195], v[96:111]
    ds_read_b64_tr_b16 v[56:57], v11 offset:43008
    ds_read_b64_tr_b16 v[58:59], v11 offset:43520
    v_fma_f32 v84, -v76, v73, v64
    v_fma_f32 v85, -v77, v73, v65
    v_fma_f32 v86, -v78, v73, v66
    v_fma_f32 v87, -v79, v73, v67
    s_waitcnt lgkmcnt(10)
    v_mfma_f32_32x32x16_bf16 v[112:127], v[36:39], v[192:195], v[112:127]
    ds_read_b64_tr_b16 v[60:61], v11 offset:43264
    ds_read_b64_tr_b16 v[62:63], v11 offset:43776
    v_fma_f32 v88, -v80, v73, v68
    v_fma_f32 v89, -v81, v73, v69
    v_fma_f32 v90, -v82, v73, v70
    s_waitcnt lgkmcnt(10)
    v_mfma_f32_32x32x16_bf16 v[96:111], v[40:43], v[196:199], v[96:111]
    ds_read_b64_tr_b16 v[32:33], v11 offset:49152
    ds_read_b64_tr_b16 v[34:35], v11 offset:49664
    v_fma_f32 v91, -v83, v73, v71
    v_fmac_f32 v76, v84, v74
    v_fmac_f32 v77, v85, v74
    v_fmac_f32 v78, v86, v74
    s_waitcnt lgkmcnt(10)
    v_mfma_f32_32x32x16_bf16 v[112:127], v[44:47], v[196:199], v[112:127]
    ds_read_b64_tr_b16 v[36:37], v11 offset:49408
    ds_read_b64_tr_b16 v[38:39], v11 offset:49920
    v_fmac_f32 v79, v87, v74
    v_fmac_f32 v80, v88, v74
    v_fmac_f32 v81, v89, v74
    s_waitcnt lgkmcnt(10)
    v_mfma_f32_32x32x16_bf16 v[96:111], v[48:51], v[208:211], v[96:111]
    ds_read_b64_tr_b16 v[40:41], v11 offset:51200
    ds_read_b64_tr_b16 v[42:43], v11 offset:51712
    v_fmac_f32 v82, v90, v74
    v_fmac_f32 v83, v91, v74
    v_cvt_pk_bf16_f32 v6, v76, v77
    v_cvt_pk_bf16_f32 v7, v78, v79
    s_waitcnt lgkmcnt(10)
    v_mfma_f32_32x32x16_bf16 v[112:127], v[52:55], v[208:211], v[112:127]
    ds_read_b64_tr_b16 v[44:45], v11 offset:51456
    ds_read_b64_tr_b16 v[46:47], v11 offset:51968
    v_cvt_pk_bf16_f32 v8, v80, v81
    v_cvt_pk_bf16_f32 v9, v82, v83
    v_lshrrev_b32 v15, 3, v2
    s_waitcnt lgkmcnt(10)
    v_mfma_f32_32x32x16_bf16 v[96:111], v[56:59], v[212:215], v[96:111]
    ds_read_b64_tr_b16 v[48:49], v11 offset:57344
    ds_read_b64_tr_b16 v[50:51], v11 offset:57856
    v_lshlrev_b32 v15, 9, v15
    v_and_b32 v5, 7, v2
    v_lshl_add_u32 v15, v5, 4, v15
    s_lshr_b32 s70, s44, 5
    s_waitcnt lgkmcnt(10)
    v_mfma_f32_32x32x16_bf16 v[112:127], v[60:63], v[212:215], v[112:127]
    ds_read_b64_tr_b16 v[52:53], v11 offset:57600
    ds_read_b64_tr_b16 v[54:55], v11 offset:58112
    s_lshl_b32 s70, s70, 15
    s_and_b32 s71, s44, 24
    s_lshl_b32 s71, s71, 4
    s_waitcnt lgkmcnt(10)
    v_mfma_f32_32x32x16_bf16 v[96:111], v[32:35], v[224:227], v[96:111]
    ds_read_b64_tr_b16 v[56:57], v11 offset:59392
    ds_read_b64_tr_b16 v[58:59], v11 offset:59904
    s_add_u32 s70, s70, s71
    s_add_u32 s70, s70, s27
    s_lshl_b32 s71, s24, 4
    s_add_u32 s71, s71, 0x20000
    s_waitcnt lgkmcnt(10)
    v_mfma_f32_32x32x16_bf16 v[112:127], v[36:39], v[224:227], v[112:127]
    ds_read_b64_tr_b16 v[60:61], v11 offset:59648
    ds_read_b64_tr_b16 v[62:63], v11 offset:60160
    v_lshl_add_u32 v5, v2, 7, s71
    s_add_u32 s71, s67, 0x20000
    v_add_u32 v14, s71, v3
    s_waitcnt lgkmcnt(10)
    v_mfma_f32_32x32x16_bf16 v[96:111], v[40:43], v[228:231], v[96:111]
    ds_write_b128 v5, v[6:9]
    s_waitcnt lgkmcnt(9)
    v_mfma_f32_32x32x16_bf16 v[112:127], v[44:47], v[228:231], v[112:127]
    s_waitcnt vmcnt(5) lgkmcnt(0)
    s_barrier
    ds_read_b64_tr_b16 v[32:33], v10 offset:0
    ds_read_b64_tr_b16 v[34:35], v10 offset:512
    ds_read_b64_tr_b16 v[36:37], v10 offset:256
    ds_read_b64_tr_b16 v[38:39], v10 offset:768
    ds_read_b64_tr_b16 v[40:41], v10 offset:2048
    ds_read_b64_tr_b16 v[42:43], v10 offset:2560
    ds_read_b64_tr_b16 v[44:45], v10 offset:2304
    ds_read_b64_tr_b16 v[46:47], v10 offset:2816
    v_mfma_f32_32x32x16_bf16 v[96:111], v[48:51], v[240:243], v[96:111]
    v_mfma_f32_32x32x16_bf16 v[112:127], v[52:55], v[240:243], v[112:127]
    v_mfma_f32_32x32x16_bf16 v[96:111], v[56:59], v[244:247], v[96:111]
    ds_read_b64_tr_b16 v[48:49], v10 offset:4096
    ds_read_b64_tr_b16 v[50:51], v10 offset:4608
    v_mfma_f32_32x32x16_bf16 v[112:127], v[60:63], v[244:247], v[112:127]
    ds_read_b64_tr_b16 v[52:53], v10 offset:4352
    ds_read_b64_tr_b16 v[54:55], v10 offset:4864
    s_waitcnt lgkmcnt(10)
    v_mfma_f32_32x32x16_bf16 v[64:79], v[32:35], v[128:131], 0
    ds_read_b64_tr_b16 v[56:57], v10 offset:6144
    ds_read_b64_tr_b16 v[58:59], v10 offset:6656
    ds_read_b128 v[6:9], v14
    s_waitcnt lgkmcnt(11)
    v_mfma_f32_32x32x16_bf16 v[80:95], v[36:39], v[128:131], 0
    ds_read_b64_tr_b16 v[60:61], v10 offset:6400
    ds_read_b64_tr_b16 v[62:63], v10 offset:6912
    s_add_u32 m0, s26, 0x10000
    s_add_u32 s28, s25, 0x180
    buffer_load_dwordx4 v4, s[4:7], s28 offen lds
    s_waitcnt lgkmcnt(11)
    v_mfma_f32_32x32x16_bf16 v[64:79], v[40:43], v[132:135], v[64:79]
    ds_read_b64_tr_b16 v[32:33], v10 offset:8192
    ds_read_b64_tr_b16 v[34:35], v10 offset:8704
    s_add_u32 m0, s26, 0x10400
    s_add_u32 s28, s25, 0x10180
    buffer_load_dwordx4 v4, s[4:7], s28 offen lds
    s_waitcnt lgkmcnt(11)
    v_mfma_f32_32x32x16_bf16 v[80:95], v[44:47], v[132:135], v[80:95]
    ds_read_b64_tr_b16 v[36:37], v10 offset:8448
    ds_read_b64_tr_b16 v[38:39], v10 offset:8960
    s_add_u32 m0, s26, 0x10800
    s_add_u32 s28, s25, 0x20180
    buffer_load_dwordx4 v4, s[4:7], s28 offen lds
    s_waitcnt lgkmcnt(11)
    v_mfma_f32_32x32x16_bf16 v[64:79], v[48:51], v[136:139], v[64:79]
    ds_read_b64_tr_b16 v[40:41], v10 offset:10240
    ds_read_b64_tr_b16 v[42:43], v10 offset:10752
    s_add_u32 m0, s26, 0x10c00
    s_add_u32 s28, s25, 0x30180
    buffer_load_dwordx4 v4, s[4:7], s28 offen lds
    s_waitcnt lgkmcnt(11)
    v_mfma_f32_32x32x16_bf16 v[80:95], v[52:55], v[136:139], v[80:95]
    ds_read_b64_tr_b16 v[44:45], v10 offset:10496
    ds_read_b64_tr_b16 v[46:47], v10 offset:11008
    s_add_u32 m0, s26, 0x11000
    s_add_u32 s28, s25, 0x40180
    buffer_load_dwordx4 v4, s[4:7], s28 offen lds
    s_waitcnt lgkmcnt(10)
    buffer_store_dwordx4 v[6:9], v15, s[20:23], s70 offen sc1
    v_mfma_f32_32x32x16_bf16 v[64:79], v[56:59], v[140:143], v[64:79]
    ds_read_b64_tr_b16 v[48:49], v10 offset:12288
    ds_read_b64_tr_b16 v[50:51], v10 offset:12800
    s_add_u32 m0, s26, 0x11400
    s_add_u32 s28, s25, 0x50180
    buffer_load_dwordx4 v4, s[4:7], s28 offen lds
    s_waitcnt lgkmcnt(10)
    v_mfma_f32_32x32x16_bf16 v[80:95], v[60:63], v[140:143], v[80:95]
    ds_read_b64_tr_b16 v[52:53], v10 offset:12544
    ds_read_b64_tr_b16 v[54:55], v10 offset:13056
    s_add_u32 m0, s26, 0x11800
    s_add_u32 s28, s25, 0x60180
    buffer_load_dwordx4 v4, s[4:7], s28 offen lds
    s_waitcnt lgkmcnt(10)
    v_mfma_f32_32x32x16_bf16 v[64:79], v[32:35], v[144:147], v[64:79]
    ds_read_b64_tr_b16 v[56:57], v10 offset:14336
    ds_read_b64_tr_b16 v[58:59], v10 offset:14848
    s_add_u32 m0, s26, 0x11c00
    s_add_u32 s28, s25, 0x70180
    buffer_load_dwordx4 v4, s[4:7], s28 offen lds
    s_waitcnt lgkmcnt(10)
    v_mfma_f32_32x32x16_bf16 v[80:95], v[36:39], v[144:147], v[80:95]
    ds_read_b64_tr_b16 v[60:61], v10 offset:14592
    ds_read_b64_tr_b16 v[62:63], v10 offset:15104
    v_mov_b32 v14, 0
    s_cmp_lg_u32 s24, 0
    s_cselect_b32 s94, 0x4000, 0
    s_lshl_b32 s94, s94, 16
    v_add_u32 v14, s94, v14
    v_mov_b32 v15, 0
    buffer_load_dword v15, v14, s[88:91], 0 offen
    s_waitcnt lgkmcnt(10)
    v_mfma_f32_32x32x16_bf16 v[64:79], v[40:43], v[148:151], v[64:79]
    ds_read_b64_tr_b16 v[32:33], v10 offset:16384
    ds_read_b64_tr_b16 v[34:35], v10 offset:16896
    v_cvt_pk_bf16_f32 v16, v96, v97
    v_cvt_pk_bf16_f32 v17, v98, v99
    v_cvt_pk_bf16_f32 v18, v100, v101
    v_cvt_pk_bf16_f32 v19, v102, v103
    s_waitcnt lgkmcnt(10)
    v_mfma_f32_32x32x16_bf16 v[80:95], v[44:47], v[148:151], v[80:95]
    ds_read_b64_tr_b16 v[36:37], v10 offset:16640
    ds_read_b64_tr_b16 v[38:39], v10 offset:17152
    s_add_u32 s28, s30, 0x1000
    buffer_store_dwordx4 v[16:19], v3, s[12:15], s28 offen sc1
    s_waitcnt lgkmcnt(10)
    v_mfma_f32_32x32x16_bf16 v[64:79], v[48:51], v[152:155], v[64:79]
    ds_read_b64_tr_b16 v[40:41], v10 offset:18432
    ds_read_b64_tr_b16 v[42:43], v10 offset:18944
    s_waitcnt lgkmcnt(10)
    v_mfma_f32_32x32x16_bf16 v[80:95], v[52:55], v[152:155], v[80:95]
    ds_read_b64_tr_b16 v[44:45], v10 offset:18688
    ds_read_b64_tr_b16 v[46:47], v10 offset:19200
    v_cvt_pk_bf16_f32 v20, v104, v105
    v_cvt_pk_bf16_f32 v21, v106, v107
    v_cvt_pk_bf16_f32 v22, v108, v109
    v_cvt_pk_bf16_f32 v23, v110, v111
    s_waitcnt lgkmcnt(10)
    v_mfma_f32_32x32x16_bf16 v[64:79], v[56:59], v[156:159], v[64:79]
    ds_read_b64_tr_b16 v[48:49], v10 offset:20480
    ds_read_b64_tr_b16 v[50:51], v10 offset:20992
    s_add_u32 s28, s30, 0x1400
    buffer_store_dwordx4 v[20:23], v3, s[12:15], s28 offen sc1
    s_waitcnt lgkmcnt(10)
    v_mfma_f32_32x32x16_bf16 v[80:95], v[60:63], v[156:159], v[80:95]
    ds_read_b64_tr_b16 v[52:53], v10 offset:20736
    ds_read_b64_tr_b16 v[54:55], v10 offset:21248
    s_waitcnt lgkmcnt(10)
    v_mfma_f32_32x32x16_bf16 v[64:79], v[32:35], v[160:163], v[64:79]
    ds_read_b64_tr_b16 v[56:57], v10 offset:22528
    ds_read_b64_tr_b16 v[58:59], v10 offset:23040
    v_cvt_pk_bf16_f32 v24, v112, v113
    v_cvt_pk_bf16_f32 v25, v114, v115
    v_cvt_pk_bf16_f32 v26, v116, v117
    v_cvt_pk_bf16_f32 v27, v118, v119
    s_waitcnt lgkmcnt(10)
    v_mfma_f32_32x32x16_bf16 v[80:95], v[36:39], v[160:163], v[80:95]
    ds_read_b64_tr_b16 v[60:61], v10 offset:22784
    ds_read_b64_tr_b16 v[62:63], v10 offset:23296
    s_add_u32 s28, s30, 0x1800
    buffer_store_dwordx4 v[24:27], v3, s[12:15], s28 offen sc1
    s_waitcnt lgkmcnt(10)
    v_mfma_f32_32x32x16_bf16 v[64:79], v[40:43], v[164:167], v[64:79]
    ds_read_b64_tr_b16 v[32:33], v10 offset:24576
    ds_read_b64_tr_b16 v[34:35], v10 offset:25088
    s_waitcnt lgkmcnt(10)
    v_mfma_f32_32x32x16_bf16 v[80:95], v[44:47], v[164:167], v[80:95]
    ds_read_b64_tr_b16 v[36:37], v10 offset:24832
    ds_read_b64_tr_b16 v[38:39], v10 offset:25344
    v_cvt_pk_bf16_f32 v28, v120, v121
    v_cvt_pk_bf16_f32 v29, v122, v123
    v_cvt_pk_bf16_f32 v30, v124, v125
    v_cvt_pk_bf16_f32 v31, v126, v127
    s_waitcnt lgkmcnt(10)
    v_mfma_f32_32x32x16_bf16 v[64:79], v[48:51], v[168:171], v[64:79]
    ds_read_b64_tr_b16 v[40:41], v10 offset:26624
    ds_read_b64_tr_b16 v[42:43], v10 offset:27136
    s_add_u32 s28, s30, 0x1c00
    buffer_store_dwordx4 v[28:31], v3, s[12:15], s28 offen sc1
    s_waitcnt lgkmcnt(10)
    v_mfma_f32_32x32x16_bf16 v[80:95], v[52:55], v[168:171], v[80:95]
    ds_read_b64_tr_b16 v[44:45], v10 offset:26880
    ds_read_b64_tr_b16 v[46:47], v10 offset:27392
    s_waitcnt lgkmcnt(10)
    v_mfma_f32_32x32x16_bf16 v[64:79], v[56:59], v[172:175], v[64:79]
    ds_read_b64_tr_b16 v[48:49], v10 offset:28672
    ds_read_b64_tr_b16 v[50:51], v10 offset:29184
    s_waitcnt lgkmcnt(10)
    v_mfma_f32_32x32x16_bf16 v[80:95], v[60:63], v[172:175], v[80:95]
    ds_read_b64_tr_b16 v[52:53], v10 offset:28928
    ds_read_b64_tr_b16 v[54:55], v10 offset:29440
    s_waitcnt lgkmcnt(10)
    v_mfma_f32_32x32x16_bf16 v[64:79], v[32:35], v[176:179], v[64:79]
    ds_read_b64_tr_b16 v[56:57], v10 offset:30720
    ds_read_b64_tr_b16 v[58:59], v10 offset:31232
    s_waitcnt lgkmcnt(10)
    v_mfma_f32_32x32x16_bf16 v[80:95], v[36:39], v[176:179], v[80:95]
    ds_read_b64_tr_b16 v[60:61], v10 offset:30976
    ds_read_b64_tr_b16 v[62:63], v10 offset:31488
    s_waitcnt lgkmcnt(10)
    v_mfma_f32_32x32x16_bf16 v[64:79], v[40:43], v[180:183], v[64:79]
    ds_read_b64_tr_b16 v[32:33], v10 offset:32768
    ds_read_b64_tr_b16 v[34:35], v10 offset:33280
    s_waitcnt lgkmcnt(10)
    v_mfma_f32_32x32x16_bf16 v[80:95], v[44:47], v[180:183], v[80:95]
    ds_read_b64_tr_b16 v[36:37], v10 offset:33024
    ds_read_b64_tr_b16 v[38:39], v10 offset:33536
    s_waitcnt lgkmcnt(10)
    v_mfma_f32_32x32x16_bf16 v[64:79], v[48:51], v[184:187], v[64:79]
    ds_read_b64_tr_b16 v[40:41], v10 offset:34816
    ds_read_b64_tr_b16 v[42:43], v10 offset:35328
    s_waitcnt lgkmcnt(10)
    v_mfma_f32_32x32x16_bf16 v[80:95], v[52:55], v[184:187], v[80:95]
    ds_read_b64_tr_b16 v[44:45], v10 offset:35072
    ds_read_b64_tr_b16 v[46:47], v10 offset:35584
    s_waitcnt lgkmcnt(10)
    v_mfma_f32_32x32x16_bf16 v[64:79], v[56:59], v[188:191], v[64:79]
    ds_read_b64_tr_b16 v[48:49], v10 offset:36864
    ds_read_b64_tr_b16 v[50:51], v10 offset:37376
    buffer_load_dword v1, v13, s[76:79], s64 offen
    s_waitcnt lgkmcnt(10)
    v_mfma_f32_32x32x16_bf16 v[80:95], v[60:63], v[188:191], v[80:95]
    ds_read_b64_tr_b16 v[52:53], v10 offset:37120
    ds_read_b64_tr_b16 v[54:55], v10 offset:37632
    s_waitcnt lgkmcnt(10)
    v_mfma_f32_32x32x16_bf16 v[64:79], v[32:35], v[192:195], v[64:79]
    ds_read_b64_tr_b16 v[56:57], v10 offset:38912
    ds_read_b64_tr_b16 v[58:59], v10 offset:39424
    s_waitcnt lgkmcnt(10)
    v_mfma_f32_32x32x16_bf16 v[80:95], v[36:39], v[192:195], v[80:95]
    ds_read_b64_tr_b16 v[60:61], v10 offset:39168
    ds_read_b64_tr_b16 v[62:63], v10 offset:39680
    s_waitcnt lgkmcnt(10)
    v_mfma_f32_32x32x16_bf16 v[64:79], v[40:43], v[196:199], v[64:79]
    ds_read_b64_tr_b16 v[32:33], v10 offset:40960
    ds_read_b64_tr_b16 v[34:35], v10 offset:41472
    s_waitcnt lgkmcnt(10)
    v_mfma_f32_32x32x16_bf16 v[80:95], v[44:47], v[196:199], v[80:95]
    ds_read_b64_tr_b16 v[36:37], v10 offset:41216
    ds_read_b64_tr_b16 v[38:39], v10 offset:41728
    s_waitcnt lgkmcnt(10)
    v_mfma_f32_32x32x16_bf16 v[64:79], v[48:51], v[200:203], v[64:79]
    ds_read_b64_tr_b16 v[40:41], v10 offset:43008
    ds_read_b64_tr_b16 v[42:43], v10 offset:43520
    s_waitcnt lgkmcnt(10)
    v_mfma_f32_32x32x16_bf16 v[80:95], v[52:55], v[200:203], v[80:95]
    ds_read_b64_tr_b16 v[44:45], v10 offset:43264
    ds_read_b64_tr_b16 v[46:47], v10 offset:43776
    s_waitcnt lgkmcnt(10)
    v_mfma_f32_32x32x16_bf16 v[64:79], v[56:59], v[204:207], v[64:79]
    ds_read_b64_tr_b16 v[48:49], v10 offset:45056
    ds_read_b64_tr_b16 v[50:51], v10 offset:45568
    s_waitcnt lgkmcnt(10)
    v_mfma_f32_32x32x16_bf16 v[80:95], v[60:63], v[204:207], v[80:95]
    ds_read_b64_tr_b16 v[52:53], v10 offset:45312
    ds_read_b64_tr_b16 v[54:55], v10 offset:45824
    s_waitcnt lgkmcnt(10)
    v_mfma_f32_32x32x16_bf16 v[64:79], v[32:35], v[208:211], v[64:79]
    ds_read_b64_tr_b16 v[56:57], v10 offset:47104
    ds_read_b64_tr_b16 v[58:59], v10 offset:47616
    s_waitcnt lgkmcnt(10)
    v_mfma_f32_32x32x16_bf16 v[80:95], v[36:39], v[208:211], v[80:95]
    ds_read_b64_tr_b16 v[60:61], v10 offset:47360
    ds_read_b64_tr_b16 v[62:63], v10 offset:47872
    s_waitcnt lgkmcnt(10)
    v_mfma_f32_32x32x16_bf16 v[64:79], v[40:43], v[212:215], v[64:79]
    ds_read_b64_tr_b16 v[32:33], v10 offset:49152
    ds_read_b64_tr_b16 v[34:35], v10 offset:49664
    s_waitcnt lgkmcnt(10)
    v_mfma_f32_32x32x16_bf16 v[80:95], v[44:47], v[212:215], v[80:95]
    ds_read_b64_tr_b16 v[36:37], v10 offset:49408
    ds_read_b64_tr_b16 v[38:39], v10 offset:49920
    s_waitcnt lgkmcnt(10)
    v_mfma_f32_32x32x16_bf16 v[64:79], v[48:51], v[216:219], v[64:79]
    ds_read_b64_tr_b16 v[40:41], v10 offset:51200
    ds_read_b64_tr_b16 v[42:43], v10 offset:51712
    s_waitcnt lgkmcnt(10)
    v_mfma_f32_32x32x16_bf16 v[80:95], v[52:55], v[216:219], v[80:95]
    ds_read_b64_tr_b16 v[44:45], v10 offset:51456
    ds_read_b64_tr_b16 v[46:47], v10 offset:51968
    s_waitcnt lgkmcnt(10)
    v_mfma_f32_32x32x16_bf16 v[64:79], v[56:59], v[220:223], v[64:79]
    ds_read_b64_tr_b16 v[48:49], v10 offset:53248
    ds_read_b64_tr_b16 v[50:51], v10 offset:53760
    s_waitcnt lgkmcnt(10)
    v_mfma_f32_32x32x16_bf16 v[80:95], v[60:63], v[220:223], v[80:95]
    ds_read_b64_tr_b16 v[52:53], v10 offset:53504
    ds_read_b64_tr_b16 v[54:55], v10 offset:54016
    s_waitcnt lgkmcnt(10)
    v_mfma_f32_32x32x16_bf16 v[64:79], v[32:35], v[224:227], v[64:79]
    ds_read_b64_tr_b16 v[56:57], v10 offset:55296
    ds_read_b64_tr_b16 v[58:59], v10 offset:55808
    s_waitcnt lgkmcnt(10)
    v_mfma_f32_32x32x16_bf16 v[80:95], v[36:39], v[224:227], v[80:95]
    ds_read_b64_tr_b16 v[60:61], v10 offset:55552
    ds_read_b64_tr_b16 v[62:63], v10 offset:56064
    s_waitcnt lgkmcnt(10)
    v_mfma_f32_32x32x16_bf16 v[64:79], v[40:43], v[228:231], v[64:79]
    ds_read_b64_tr_b16 v[32:33], v10 offset:57344
    ds_read_b64_tr_b16 v[34:35], v10 offset:57856
    s_waitcnt lgkmcnt(10)
    v_mfma_f32_32x32x16_bf16 v[80:95], v[44:47], v[228:231], v[80:95]
    ds_read_b64_tr_b16 v[36:37], v10 offset:57600
    ds_read_b64_tr_b16 v[38:39], v10 offset:58112
    s_waitcnt lgkmcnt(10)
    v_mfma_f32_32x32x16_bf16 v[64:79], v[48:51], v[232:235], v[64:79]
    ds_read_b64_tr_b16 v[40:41], v10 offset:59392
    ds_read_b64_tr_b16 v[42:43], v10 offset:59904
    s_waitcnt lgkmcnt(10)
    v_mfma_f32_32x32x16_bf16 v[80:95], v[52:55], v[232:235], v[80:95]
    ds_read_b64_tr_b16 v[44:45], v10 offset:59648
    ds_read_b64_tr_b16 v[46:47], v10 offset:60160
    s_waitcnt lgkmcnt(10)
    v_mfma_f32_32x32x16_bf16 v[64:79], v[56:59], v[236:239], v[64:79]
    ds_read_b64_tr_b16 v[48:49], v10 offset:61440
    ds_read_b64_tr_b16 v[50:51], v10 offset:61952
    s_waitcnt lgkmcnt(10)
    v_mfma_f32_32x32x16_bf16 v[80:95], v[60:63], v[236:239], v[80:95]
    ds_read_b64_tr_b16 v[52:53], v10 offset:61696
    ds_read_b64_tr_b16 v[54:55], v10 offset:62208
    s_waitcnt lgkmcnt(10)
    v_mfma_f32_32x32x16_bf16 v[64:79], v[32:35], v[240:243], v[64:79]
    ds_read_b64_tr_b16 v[56:57], v10 offset:63488
    ds_read_b64_tr_b16 v[58:59], v10 offset:64000
    s_waitcnt lgkmcnt(10)
    v_mfma_f32_32x32x16_bf16 v[80:95], v[36:39], v[240:243], v[80:95]
    ds_read_b64_tr_b16 v[60:61], v10 offset:63744
    ds_read_b64_tr_b16 v[62:63], v10 offset:64256
    s_waitcnt lgkmcnt(10)
    v_mfma_f32_32x32x16_bf16 v[64:79], v[40:43], v[244:247], v[64:79]
    s_waitcnt lgkmcnt(8)
    v_mfma_f32_32x32x16_bf16 v[80:95], v[44:47], v[244:247], v[80:95]
    s_waitcnt vmcnt(6) lgkmcnt(0)
    s_waitcnt vmcnt(4)
    s_barrier
    ds_read_b64_tr_b16 v[32:33], v11 offset:0
    ds_read_b64_tr_b16 v[34:35], v11 offset:512
    ds_read_b64_tr_b16 v[36:37], v11 offset:256
    ds_read_b64_tr_b16 v[38:39], v11 offset:768
    ds_read_b64_tr_b16 v[40:41], v11 offset:2048
    ds_read_b64_tr_b16 v[42:43], v11 offset:2560
    ds_read_b64_tr_b16 v[44:45], v11 offset:2304
    ds_read_b64_tr_b16 v[46:47], v11 offset:2816
    v_mfma_f32_32x32x16_bf16 v[64:79], v[48:51], v[248:251], v[64:79]
    s_waitcnt vmcnt(5)
    s_cmp_lg_u32 s24, 0
    s_cbranch_scc1 .Lkvproj_kernel_chk_3
    v_cmp_ne_u32 vcc, 1, v15
    s_cbranch_vccz .Lkvproj_kernel_cok_4
    s_mov_b32 s48, 0x40000
.Lkvproj_kernel_poll_5:
    buffer_load_dword v15, v14, s[88:91], 0 offen sc1
    s_waitcnt vmcnt(0)
    v_cmp_ne_u32 vcc, 1, v15
    s_cbranch_vccz .Lkvproj_kernel_pdone_6
    s_sub_u32 s48, s48, 1
    s_sleep 2
    s_cmp_lg_u32 s48, 0
    s_cbranch_scc1 .Lkvproj_kernel_poll_5
.Lkvproj_kernel_pdone_6:
.Lkvproj_kernel_cok_4:
    s_waitcnt vmcnt(63)
    s_lshl_b32 s48, s2, 8
    s_add_u32 s48, s48, 0x0
    v_mov_b32 v5, s48
    v_mov_b32 v6, 1
    s_mov_b64 exec, 1
    buffer_store_dword v6, v5, s[84:87], 0 offen sc1
    s_mov_b64 exec, -1
.Lkvproj_kernel_chk_3:
    v_mfma_f32_32x32x16_bf16 v[80:95], v[52:55], v[248:251], v[80:95]
    v_mfma_f32_32x32x16_bf16 v[64:79], v[56:59], v[252:255], v[64:79]
    ds_read_b64_tr_b16 v[48:49], v11 offset:4096
    ds_read_b64_tr_b16 v[50:51], v11 offset:4608
    v_mfma_f32_32x32x16_bf16 v[80:95], v[60:63], v[252:255], v[80:95]
    ds_read_b64_tr_b16 v[52:53], v11 offset:4352
    ds_read_b64_tr_b16 v[54:55], v11 offset:4864
    s_waitcnt lgkmcnt(10)
    v_mfma_f32_32x32x16_bf16 v[96:111], v[32:35], v[128:131], 0
    ds_read_b64_tr_b16 v[56:57], v11 offset:6144
    ds_read_b64_tr_b16 v[58:59], v11 offset:6656
    s_waitcnt lgkmcnt(10)
    v_mfma_f32_32x32x16_bf16 v[112:127], v[36:39], v[128:131], 0
    ds_read_b64_tr_b16 v[60:61], v11 offset:6400
    ds_read_b64_tr_b16 v[62:63], v11 offset:6912
    s_waitcnt lgkmcnt(10)
    v_mfma_f32_32x32x16_bf16 v[96:111], v[40:43], v[132:135], v[96:111]
    ds_read_b64_tr_b16 v[32:33], v11 offset:8192
    ds_read_b64_tr_b16 v[34:35], v11 offset:8704
    v_lshrrev_b32 v5, 1, v2
    v_and_b32 v13, 1, v2
    v_lshlrev_b32 v13, 7, v13
    v_lshl_add_u32 v13, v5, 13, v13
    v_mov_b32 v5, 0x40000000
    v_cmp_gt_u32 vcc, 16, v2
    s_nop 1
    v_cndmask_b32 v13, v5, v13, vcc
    buffer_load_dword v1, v13, s[60:63], s80 offen
    s_waitcnt lgkmcnt(10)
    v_mfma_f32_32x32x16_bf16 v[112:127], v[44:47], v[132:135], v[112:127]
    ds_read_b64_tr_b16 v[36:37], v11 offset:8448
    ds_read_b64_tr_b16 v[38:39], v11 offset:8960
    s_waitcnt lgkmcnt(10)
    v_mfma_f32_32x32x16_bf16 v[96:111], v[48:51], v[136:139], v[96:111]
    ds_read_b64_tr_b16 v[40:41], v11 offset:10240
    ds_read_b64_tr_b16 v[42:43], v11 offset:10752
    s_waitcnt lgkmcnt(10)
    v_mfma_f32_32x32x16_bf16 v[112:127], v[52:55], v[136:139], v[112:127]
    ds_read_b64_tr_b16 v[44:45], v11 offset:10496
    ds_read_b64_tr_b16 v[46:47], v11 offset:11008
    s_waitcnt lgkmcnt(10)
    v_mfma_f32_32x32x16_bf16 v[96:111], v[56:59], v[140:143], v[96:111]
    ds_read_b64_tr_b16 v[48:49], v11 offset:12288
    ds_read_b64_tr_b16 v[50:51], v11 offset:12800
    s_waitcnt lgkmcnt(10)
    v_mfma_f32_32x32x16_bf16 v[112:127], v[60:63], v[140:143], v[112:127]
    ds_read_b64_tr_b16 v[52:53], v11 offset:12544
    ds_read_b64_tr_b16 v[54:55], v11 offset:13056
    s_waitcnt lgkmcnt(10)
    v_mfma_f32_32x32x16_bf16 v[96:111], v[32:35], v[144:147], v[96:111]
    ds_read_b64_tr_b16 v[56:57], v11 offset:14336
    ds_read_b64_tr_b16 v[58:59], v11 offset:14848
    s_waitcnt lgkmcnt(10)
    v_mfma_f32_32x32x16_bf16 v[112:127], v[36:39], v[144:147], v[112:127]
    ds_read_b64_tr_b16 v[60:61], v11 offset:14592
    ds_read_b64_tr_b16 v[62:63], v11 offset:15104
    s_waitcnt lgkmcnt(10)
    v_mfma_f32_32x32x16_bf16 v[96:111], v[40:43], v[148:151], v[96:111]
    ds_read_b64_tr_b16 v[32:33], v11 offset:16384
    ds_read_b64_tr_b16 v[34:35], v11 offset:16896
    v_cvt_pk_bf16_f32 v16, v64, v65
    v_cvt_pk_bf16_f32 v17, v66, v67
    v_cvt_pk_bf16_f32 v18, v68, v69
    v_cvt_pk_bf16_f32 v19, v70, v71
    s_waitcnt lgkmcnt(10)
    v_mfma_f32_32x32x16_bf16 v[112:127], v[44:47], v[148:151], v[112:127]
    ds_read_b64_tr_b16 v[36:37], v11 offset:16640
    ds_read_b64_tr_b16 v[38:39], v11 offset:17152
    s_add_u32 s28, s30, 0x100000
    buffer_store_dwordx4 v[16:19], v3, s[12:15], s28 offen sc1
    s_waitcnt lgkmcnt(10)
    v_mfma_f32_32x32x16_bf16 v[96:111], v[48:51], v[152:155], v[96:111]
    ds_read_b64_tr_b16 v[40:41], v11 offset:18432
    ds_read_b64_tr_b16 v[42:43], v11 offset:18944
    s_waitcnt lgkmcnt(10)
    v_mfma_f32_32x32x16_bf16 v[112:127], v[52:55], v[152:155], v[112:127]
    ds_read_b64_tr_b16 v[44:45], v11 offset:18688
    ds_read_b64_tr_b16 v[46:47], v11 offset:19200
    v_cvt_pk_bf16_f32 v20, v72, v73
    v_cvt_pk_bf16_f32 v21, v74, v75
    v_cvt_pk_bf16_f32 v22, v76, v77
    v_cvt_pk_bf16_f32 v23, v78, v79
    s_waitcnt lgkmcnt(10)
    v_mfma_f32_32x32x16_bf16 v[96:111], v[56:59], v[156:159], v[96:111]
    ds_read_b64_tr_b16 v[48:49], v11 offset:20480
    ds_read_b64_tr_b16 v[50:51], v11 offset:20992
    s_add_u32 s28, s30, 0x100400
    buffer_store_dwordx4 v[20:23], v3, s[12:15], s28 offen sc1
    s_waitcnt lgkmcnt(10)
    v_mfma_f32_32x32x16_bf16 v[112:127], v[60:63], v[156:159], v[112:127]
    ds_read_b64_tr_b16 v[52:53], v11 offset:20736
    ds_read_b64_tr_b16 v[54:55], v11 offset:21248
    s_waitcnt lgkmcnt(10)
    v_mfma_f32_32x32x16_bf16 v[96:111], v[32:35], v[160:163], v[96:111]
    ds_read_b64_tr_b16 v[56:57], v11 offset:22528
    ds_read_b64_tr_b16 v[58:59], v11 offset:23040
    v_cvt_pk_bf16_f32 v24, v80, v81
    v_cvt_pk_bf16_f32 v25, v82, v83
    v_cvt_pk_bf16_f32 v26, v84, v85
    v_cvt_pk_bf16_f32 v27, v86, v87
    s_waitcnt lgkmcnt(10)
    v_mfma_f32_32x32x16_bf16 v[112:127], v[36:39], v[160:163], v[112:127]
    ds_read_b64_tr_b16 v[60:61], v11 offset:22784
    ds_read_b64_tr_b16 v[62:63], v11 offset:23296
    s_add_u32 s28, s30, 0x100800
    buffer_store_dwordx4 v[24:27], v3, s[12:15], s28 offen sc1
    s_waitcnt lgkmcnt(10)
    v_mfma_f32_32x32x16_bf16 v[96:111], v[40:43], v[164:167], v[96:111]
    ds_read_b64_tr_b16 v[32:33], v11 offset:24576
    ds_read_b64_tr_b16 v[34:35], v11 offset:25088
    s_waitcnt lgkmcnt(10)
    v_mfma_f32_32x32x16_bf16 v[112:127], v[44:47], v[164:167], v[112:127]
    ds_read_b64_tr_b16 v[36:37], v11 offset:24832
    ds_read_b64_tr_b16 v[38:39], v11 offset:25344
    v_cvt_pk_bf16_f32 v28, v88, v89
    v_cvt_pk_bf16_f32 v29, v90, v91
    v_cvt_pk_bf16_f32 v30, v92, v93
    v_cvt_pk_bf16_f32 v31, v94, v95
    s_waitcnt lgkmcnt(10)
    v_mfma_f32_32x32x16_bf16 v[96:111], v[48:51], v[168:171], v[96:111]
    ds_read_b64_tr_b16 v[40:41], v11 offset:26624
    ds_read_b64_tr_b16 v[42:43], v11 offset:27136
    s_add_u32 s28, s30, 0x100c00
    buffer_store_dwordx4 v[28:31], v3, s[12:15], s28 offen sc1
    s_waitcnt lgkmcnt(10)
    v_mfma_f32_32x32x16_bf16 v[112:127], v[52:55], v[168:171], v[112:127]
    ds_read_b64_tr_b16 v[44:45], v11 offset:26880
    ds_read_b64_tr_b16 v[46:47], v11 offset:27392
    s_waitcnt lgkmcnt(10)
    v_mfma_f32_32x32x16_bf16 v[96:111], v[56:59], v[172:175], v[96:111]
    ds_read_b64_tr_b16 v[48:49], v11 offset:28672
    ds_read_b64_tr_b16 v[50:51], v11 offset:29184
    s_waitcnt lgkmcnt(10)
    v_mfma_f32_32x32x16_bf16 v[112:127], v[60:63], v[172:175], v[112:127]
    ds_read_b64_tr_b16 v[52:53], v11 offset:28928
    ds_read_b64_tr_b16 v[54:55], v11 offset:29440
    s_waitcnt lgkmcnt(10)
    v_mfma_f32_32x32x16_bf16 v[96:111], v[32:35], v[176:179], v[96:111]
    ds_read_b64_tr_b16 v[56:57], v11 offset:30720
    ds_read_b64_tr_b16 v[58:59], v11 offset:31232
    s_waitcnt lgkmcnt(10)
    v_mfma_f32_32x32x16_bf16 v[112:127], v[36:39], v[176:179], v[112:127]
    ds_read_b64_tr_b16 v[60:61], v11 offset:30976
    ds_read_b64_tr_b16 v[62:63], v11 offset:31488
    s_waitcnt lgkmcnt(10)
    v_mfma_f32_32x32x16_bf16 v[96:111], v[40:43], v[180:183], v[96:111]
    ds_read_b64_tr_b16 v[32:33], v11 offset:32768
    ds_read_b64_tr_b16 v[34:35], v11 offset:33280
    s_waitcnt lgkmcnt(10)
    v_mfma_f32_32x32x16_bf16 v[112:127], v[44:47], v[180:183], v[112:127]
    ds_read_b64_tr_b16 v[36:37], v11 offset:33024
    ds_read_b64_tr_b16 v[38:39], v11 offset:33536
    s_waitcnt lgkmcnt(10)
    v_mfma_f32_32x32x16_bf16 v[96:111], v[48:51], v[184:187], v[96:111]
    ds_read_b64_tr_b16 v[40:41], v11 offset:34816
    ds_read_b64_tr_b16 v[42:43], v11 offset:35328
    s_waitcnt lgkmcnt(10)
    v_mfma_f32_32x32x16_bf16 v[112:127], v[52:55], v[184:187], v[112:127]
    ds_read_b64_tr_b16 v[44:45], v11 offset:35072
    ds_read_b64_tr_b16 v[46:47], v11 offset:35584
    s_waitcnt lgkmcnt(10)
    v_mfma_f32_32x32x16_bf16 v[96:111], v[56:59], v[188:191], v[96:111]
    ds_read_b64_tr_b16 v[48:49], v11 offset:36864
    ds_read_b64_tr_b16 v[50:51], v11 offset:37376
    s_waitcnt lgkmcnt(10)
    v_mfma_f32_32x32x16_bf16 v[112:127], v[60:63], v[188:191], v[112:127]
    ds_read_b64_tr_b16 v[52:53], v11 offset:37120
    ds_read_b64_tr_b16 v[54:55], v11 offset:37632
    s_waitcnt lgkmcnt(10)
    v_mfma_f32_32x32x16_bf16 v[96:111], v[32:35], v[192:195], v[96:111]
    ds_read_b64_tr_b16 v[56:57], v11 offset:38912
    ds_read_b64_tr_b16 v[58:59], v11 offset:39424
    s_waitcnt lgkmcnt(10)
    v_mfma_f32_32x32x16_bf16 v[112:127], v[36:39], v[192:195], v[112:127]
    ds_read_b64_tr_b16 v[60:61], v11 offset:39168
    ds_read_b64_tr_b16 v[62:63], v11 offset:39680
    s_waitcnt lgkmcnt(10)
    v_mfma_f32_32x32x16_bf16 v[96:111], v[40:43], v[196:199], v[96:111]
    ds_read_b64_tr_b16 v[32:33], v11 offset:40960
    ds_read_b64_tr_b16 v[34:35], v11 offset:41472
    s_waitcnt lgkmcnt(10)
    v_mfma_f32_32x32x16_bf16 v[112:127], v[44:47], v[196:199], v[112:127]
    ds_read_b64_tr_b16 v[36:37], v11 offset:41216
    ds_read_b64_tr_b16 v[38:39], v11 offset:41728
    s_waitcnt lgkmcnt(10)
    v_mfma_f32_32x32x16_bf16 v[96:111], v[48:51], v[200:203], v[96:111]
    ds_read_b64_tr_b16 v[40:41], v11 offset:43008
    ds_read_b64_tr_b16 v[42:43], v11 offset:43520
    s_waitcnt lgkmcnt(10)
    v_mfma_f32_32x32x16_bf16 v[112:127], v[52:55], v[200:203], v[112:127]
    ds_read_b64_tr_b16 v[44:45], v11 offset:43264
    ds_read_b64_tr_b16 v[46:47], v11 offset:43776
    s_waitcnt lgkmcnt(10)
    v_mfma_f32_32x32x16_bf16 v[96:111], v[56:59], v[204:207], v[96:111]
    ds_read_b64_tr_b16 v[48:49], v11 offset:45056
    ds_read_b64_tr_b16 v[50:51], v11 offset:45568
    s_waitcnt lgkmcnt(10)
    v_mfma_f32_32x32x16_bf16 v[112:127], v[60:63], v[204:207], v[112:127]
    ds_read_b64_tr_b16 v[52:53], v11 offset:45312
    ds_read_b64_tr_b16 v[54:55], v11 offset:45824
    s_waitcnt lgkmcnt(10)
    v_mfma_f32_32x32x16_bf16 v[96:111], v[32:35], v[208:211], v[96:111]
    ds_read_b64_tr_b16 v[56:57], v11 offset:47104
    ds_read_b64_tr_b16 v[58:59], v11 offset:47616
    s_waitcnt lgkmcnt(10)
    v_mfma_f32_32x32x16_bf16 v[112:127], v[36:39], v[208:211], v[112:127]
    ds_read_b64_tr_b16 v[60:61], v11 offset:47360
    ds_read_b64_tr_b16 v[62:63], v11 offset:47872
    s_waitcnt lgkmcnt(10)
    v_mfma_f32_32x32x16_bf16 v[96:111], v[40:43], v[212:215], v[96:111]
    ds_read_b64_tr_b16 v[32:33], v11 offset:49152
    ds_read_b64_tr_b16 v[34:35], v11 offset:49664
    s_waitcnt lgkmcnt(10)
    v_mfma_f32_32x32x16_bf16 v[112:127], v[44:47], v[212:215], v[112:127]
    ds_read_b64_tr_b16 v[36:37], v11 offset:49408
    ds_read_b64_tr_b16 v[38:39], v11 offset:49920
    s_waitcnt lgkmcnt(10)
    v_mfma_f32_32x32x16_bf16 v[96:111], v[48:51], v[216:219], v[96:111]
    ds_read_b64_tr_b16 v[40:41], v11 offset:51200
    ds_read_b64_tr_b16 v[42:43], v11 offset:51712
    v_and_b32 v14, 15, v2
    s_lshl_b32 s48, s42, 12
    v_lshl_add_u32 v14, v14, 8, s48
    v_xor_b32 v5, 0xf000, v14
    v_cmp_gt_u32 vcc, 32, v2
    s_nop 1
    v_cndmask_b32 v14, v5, v14, vcc
    s_cmp_lg_u32 s24, 0
    s_cselect_b32 s94, 0x4000, 0
    s_lshl_b32 s94, s94, 16
    v_add_u32 v14, s94, v14
    v_mov_b32 v15, 0
    buffer_load_dword v15, v14, s[84:87], 0 offen sc1
    s_waitcnt lgkmcnt(10)
    v_mfma_f32_32x32x16_bf16 v[112:127], v[52:55], v[216:219], v[112:127]
    ds_read_b64_tr_b16 v[44:45], v11 offset:51456
    ds_read_b64_tr_b16 v[46:47], v11 offset:51968
    s_waitcnt lgkmcnt(10)
    v_mfma_f32_32x32x16_bf16 v[96:111], v[56:59], v[220:223], v[96:111]
    ds_read_b64_tr_b16 v[48:49], v11 offset:53248
    ds_read_b64_tr_b16 v[50:51], v11 offset:53760
    s_waitcnt lgkmcnt(10)
    v_mfma_f32_32x32x16_bf16 v[112:127], v[60:63], v[220:223], v[112:127]
    ds_read_b64_tr_b16 v[52:53], v11 offset:53504
    ds_read_b64_tr_b16 v[54:55], v11 offset:54016
    s_waitcnt lgkmcnt(10)
    v_mfma_f32_32x32x16_bf16 v[96:111], v[32:35], v[224:227], v[96:111]
    ds_read_b64_tr_b16 v[56:57], v11 offset:55296
    ds_read_b64_tr_b16 v[58:59], v11 offset:55808
    s_waitcnt lgkmcnt(10)
    v_mfma_f32_32x32x16_bf16 v[112:127], v[36:39], v[224:227], v[112:127]
    ds_read_b64_tr_b16 v[60:61], v11 offset:55552
    ds_read_b64_tr_b16 v[62:63], v11 offset:56064
    s_waitcnt lgkmcnt(10)
    v_mfma_f32_32x32x16_bf16 v[96:111], v[40:43], v[228:231], v[96:111]
    ds_read_b64_tr_b16 v[32:33], v11 offset:57344
    ds_read_b64_tr_b16 v[34:35], v11 offset:57856
    s_waitcnt lgkmcnt(10)
    v_mfma_f32_32x32x16_bf16 v[112:127], v[44:47], v[228:231], v[112:127]
    ds_read_b64_tr_b16 v[36:37], v11 offset:57600
    ds_read_b64_tr_b16 v[38:39], v11 offset:58112
    s_waitcnt lgkmcnt(10)
    v_mfma_f32_32x32x16_bf16 v[96:111], v[48:51], v[232:235], v[96:111]
    ds_read_b64_tr_b16 v[40:41], v11 offset:59392
    ds_read_b64_tr_b16 v[42:43], v11 offset:59904
    s_waitcnt lgkmcnt(10)
    v_mfma_f32_32x32x16_bf16 v[112:127], v[52:55], v[232:235], v[112:127]
    ds_read_b64_tr_b16 v[44:45], v11 offset:59648
    ds_read_b64_tr_b16 v[46:47], v11 offset:60160
    s_waitcnt lgkmcnt(10)
    v_mfma_f32_32x32x16_bf16 v[96:111], v[56:59], v[236:239], v[96:111]
    ds_read_b64_tr_b16 v[48:49], v11 offset:61440
    ds_read_b64_tr_b16 v[50:51], v11 offset:61952
    s_waitcnt lgkmcnt(10)
    v_mfma_f32_32x32x16_bf16 v[112:127], v[60:63], v[236:239], v[112:127]
    ds_read_b64_tr_b16 v[52:53], v11 offset:61696
    ds_read_b64_tr_b16 v[54:55], v11 offset:62208
    s_waitcnt lgkmcnt(10)
    v_mfma_f32_32x32x16_bf16 v[96:111], v[32:35], v[240:243], v[96:111]
    ds_read_b64_tr_b16 v[56:57], v11 offset:63488
    ds_read_b64_tr_b16 v[58:59], v11 offset:64000
    s_waitcnt lgkmcnt(10)
    v_mfma_f32_32x32x16_bf16 v[112:127], v[36:39], v[240:243], v[112:127]
    ds_read_b64_tr_b16 v[60:61], v11 offset:63744
    ds_read_b64_tr_b16 v[62:63], v11 offset:64256
    s_waitcnt lgkmcnt(10)
    v_mfma_f32_32x32x16_bf16 v[96:111], v[40:43], v[244:247], v[96:111]
    s_waitcnt lgkmcnt(8)
    v_mfma_f32_32x32x16_bf16 v[112:127], v[44:47], v[244:247], v[112:127]
    s_waitcnt lgkmcnt(6)
    v_mfma_f32_32x32x16_bf16 v[96:111], v[48:51], v[248:251], v[96:111]
    s_waitcnt lgkmcnt(4)
    v_mfma_f32_32x32x16_bf16 v[112:127], v[52:55], v[248:251], v[112:127]
    s_waitcnt lgkmcnt(2)
    v_mfma_f32_32x32x16_bf16 v[96:111], v[56:59], v[252:255], v[96:111]
    s_waitcnt lgkmcnt(0)
    v_mfma_f32_32x32x16_bf16 v[112:127], v[60:63], v[252:255], v[112:127]
    s_nop 7
    s_nop 1
    v_cvt_pk_bf16_f32 v16, v96, v97
    v_cvt_pk_bf16_f32 v17, v98, v99
    v_cvt_pk_bf16_f32 v18, v100, v101
    v_cvt_pk_bf16_f32 v19, v102, v103
    s_add_u32 s28, s30, 0x101000
    buffer_store_dwordx4 v[16:19], v3, s[12:15], s28 offen sc1
    v_cvt_pk_bf16_f32 v20, v104, v105
    v_cvt_pk_bf16_f32 v21, v106, v107
    v_cvt_pk_bf16_f32 v22, v108, v109
    v_cvt_pk_bf16_f32 v23, v110, v111
    s_add_u32 s28, s30, 0x101400
    buffer_store_dwordx4 v[20:23], v3, s[12:15], s28 offen sc1
    v_cvt_pk_bf16_f32 v24, v112, v113
    v_cvt_pk_bf16_f32 v25, v114, v115
    v_cvt_pk_bf16_f32 v26, v116, v117
    v_cvt_pk_bf16_f32 v27, v118, v119
    s_add_u32 s28, s30, 0x101800
    buffer_store_dwordx4 v[24:27], v3, s[12:15], s28 offen sc1
    v_cvt_pk_bf16_f32 v28, v120, v121
    v_cvt_pk_bf16_f32 v29, v122, v123
    v_cvt_pk_bf16_f32 v30, v124, v125
    v_cvt_pk_bf16_f32 v31, v126, v127
    s_add_u32 s28, s30, 0x101c00
    buffer_store_dwordx4 v[28:31], v3, s[12:15], s28 offen sc1
    s_waitcnt vmcnt(4)
    s_cmp_lg_u32 s24, 0
    s_cbranch_scc1 .Lkvproj_kernel_chk_7
    v_cmp_ne_u32 vcc, 1, v15
    s_cbranch_vccz .Lkvproj_kernel_cok_8
    s_mov_b32 s48, 0x40000
.Lkvproj_kernel_poll_9:
    buffer_load_dword v15, v14, s[84:87], 0 offen sc1
    s_waitcnt vmcnt(0)
    v_cmp_ne_u32 vcc, 1, v15
    s_cbranch_vccz .Lkvproj_kernel_pdone_10
    s_sub_u32 s48, s48, 1
    s_sleep 2
    s_cmp_lg_u32 s48, 0
    s_cbranch_scc1 .Lkvproj_kernel_poll_9
.Lkvproj_kernel_pdone_10:
.Lkvproj_kernel_cok_8:
.Lkvproj_kernel_chk_7:
    s_branch .Lk2_begin
.Lk1_v:
    ds_read_b64_tr_b16 v[32:33], v10 offset:0
    ds_read_b64_tr_b16 v[34:35], v10 offset:512
    ds_read_b64_tr_b16 v[36:37], v10 offset:256
    ds_read_b64_tr_b16 v[38:39], v10 offset:768
    ds_read_b64_tr_b16 v[40:41], v10 offset:2048
    ds_read_b64_tr_b16 v[42:43], v10 offset:2560
    ds_read_b64_tr_b16 v[44:45], v10 offset:2304
    ds_read_b64_tr_b16 v[46:47], v10 offset:2816
    ds_read_b64_tr_b16 v[48:49], v10 offset:4096
    ds_read_b64_tr_b16 v[50:51], v10 offset:4608
    ds_read_b64_tr_b16 v[52:53], v10 offset:4352
    ds_read_b64_tr_b16 v[54:55], v10 offset:4864
    s_waitcnt vmcnt(10)
    ds_read_b128 v[128:131], v100 offset:0
    ds_read_b128 v[132:135], v101 offset:0
    ds_read_b128 v[136:139], v102 offset:0
    ds_read_b128 v[140:143], v103 offset:0
    s_waitcnt lgkmcnt(3)
    v_mfma_f32_32x32x16_bf16 v[64:79], v[128:131], v[32:35], 0
    ds_read_b64_tr_b16 v[56:57], v10 offset:6144
    ds_read_b64_tr_b16 v[58:59], v10 offset:6656
    v_mfma_f32_32x32x16_bf16 v[80:95], v[128:131], v[36:39], 0
    ds_read_b64_tr_b16 v[60:61], v10 offset:6400
    ds_read_b64_tr_b16 v[62:63], v10 offset:6912
    s_waitcnt lgkmcnt(4)
    s_add_u32 s68, s65, 3
    s_and_b32 s68, s68, 7
    s_lshl_b32 s68, s68, 7
    s_add_u32 s68, s68, s29
    s_add_u32 m0, s27, 0x20000
    s_add_u32 s28, s68, 0x0
    buffer_load_dwordx4 v8, s[8:11], s28 offen lds
    s_add_u32 m0, s27, 0x20400
    s_add_u32 s28, s68, 0x2000
    buffer_load_dwordx4 v9, s[8:11], s28 offen lds
    s_add_u32 m0, s27, 0x20800
    s_add_u32 s28, s68, 0x4000
    buffer_load_dwordx4 v8, s[8:11], s28 offen lds
    s_add_u32 m0, s27, 0x20c00
    s_add_u32 s28, s68, 0x6000
    buffer_load_dwordx4 v9, s[8:11], s28 offen lds
    v_mfma_f32_32x32x16_bf16 v[64:79], v[132:135], v[40:43], v[64:79]
    ds_read_b64_tr_b16 v[32:33], v10 offset:8192
    ds_read_b64_tr_b16 v[34:35], v10 offset:8704
    s_waitcnt vmcnt(10)
    ds_read_b128 v[144:147], v96 offset:0
    ds_read_b128 v[148:151], v97 offset:0
    ds_read_b128 v[152:155], v98 offset:0
    ds_read_b128 v[156:159], v99 offset:0
    v_mfma_f32_32x32x16_bf16 v[80:95], v[132:135], v[44:47], v[80:95]
    ds_read_b64_tr_b16 v[36:37], v10 offset:8448
    ds_read_b64_tr_b16 v[38:39], v10 offset:8960
    v_mfma_f32_32x32x16_bf16 v[64:79], v[136:139], v[48:51], v[64:79]
    ds_read_b64_tr_b16 v[40:41], v10 offset:10240
    ds_read_b64_tr_b16 v[42:43], v10 offset:10752
    v_mfma_f32_32x32x16_bf16 v[80:95], v[136:139], v[52:55], v[80:95]
    ds_read_b64_tr_b16 v[44:45], v10 offset:10496
    ds_read_b64_tr_b16 v[46:47], v10 offset:11008
    s_waitcnt lgkmcnt(6)
    s_add_u32 s68, s65, 4
    s_and_b32 s68, s68, 7
    s_lshl_b32 s68, s68, 7
    s_add_u32 s68, s68, s29
    s_add_u32 m0, s26, 0x10000
    s_add_u32 s28, s68, 0x0
    buffer_load_dwordx4 v8, s[8:11], s28 offen lds
    s_add_u32 m0, s26, 0x10400
    s_add_u32 s28, s68, 0x2000
    buffer_load_dwordx4 v9, s[8:11], s28 offen lds
    s_add_u32 m0, s26, 0x10800
    s_add_u32 s28, s68, 0x4000
    buffer_load_dwordx4 v8, s[8:11], s28 offen lds
    s_add_u32 m0, s26, 0x10c00
    s_add_u32 s28, s68, 0x6000
    buffer_load_dwordx4 v9, s[8:11], s28 offen lds
    v_mfma_f32_32x32x16_bf16 v[64:79], v[140:143], v[56:59], v[64:79]
    ds_read_b64_tr_b16 v[48:49], v10 offset:12288
    ds_read_b64_tr_b16 v[50:51], v10 offset:12800
    s_add_u32 m0, s67, 0x8000
    s_add_u32 s28, s65, 4
    s_and_b32 s28, s28, 7
    s_lshl_b32 s28, s28, 19
    s_add_u32 s28, s28, s66
    buffer_load_dwordx4 v4, s[4:7], s28 offen lds
    s_add_u32 m0, s67, 0xa000
    s_add_u32 s28, s65, 5
    s_and_b32 s28, s28, 7
    s_lshl_b32 s28, s28, 19
    s_add_u32 s28, s28, s66
    buffer_load_dwordx4 v4, s[4:7], s28 offen lds
    v_mfma_f32_32x32x16_bf16 v[80:95], v[140:143], v[60:63], v[80:95]
    ds_read_b64_tr_b16 v[52:53], v10 offset:12544
    ds_read_b64_tr_b16 v[54:55], v10 offset:13056
    v_mfma_f32_32x32x16_bf16 v[64:79], v[144:147], v[32:35], v[64:79]
    ds_read_b64_tr_b16 v[56:57], v10 offset:14336
    ds_read_b64_tr_b16 v[58:59], v10 offset:14848
    s_waitcnt lgkmcnt(10)
    v_mfma_f32_32x32x16_bf16 v[80:95], v[144:147], v[36:39], v[80:95]
    ds_read_b64_tr_b16 v[60:61], v10 offset:14592
    ds_read_b64_tr_b16 v[62:63], v10 offset:15104
    s_waitcnt lgkmcnt(10)
    v_mfma_f32_32x32x16_bf16 v[64:79], v[148:151], v[40:43], v[64:79]
    s_waitcnt vmcnt(10)
    ds_read_b128 v[160:163], v96 offset:4096
    ds_read_b128 v[164:167], v97 offset:4096
    ds_read_b128 v[168:171], v98 offset:4096
    ds_read_b128 v[172:175], v99 offset:4096
    s_waitcnt lgkmcnt(12)
    v_mfma_f32_32x32x16_bf16 v[80:95], v[148:151], v[44:47], v[80:95]
    s_barrier
    ds_read_b64_tr_b16 v[32:33], v10 offset:16384
    ds_read_b64_tr_b16 v[34:35], v10 offset:16896
    ds_read_b64_tr_b16 v[36:37], v10 offset:16640
    ds_read_b64_tr_b16 v[38:39], v10 offset:17152
    ds_read_b64_tr_b16 v[40:41], v10 offset:18432
    ds_read_b64_tr_b16 v[42:43], v10 offset:18944
    ds_read_b64_tr_b16 v[44:45], v10 offset:18688
    ds_read_b64_tr_b16 v[46:47], v10 offset:19200
    s_waitcnt lgkmcnt(15)
    v_mfma_f32_32x32x16_bf16 v[64:79], v[152:155], v[48:51], v[64:79]
    v_mfma_f32_32x32x16_bf16 v[80:95], v[152:155], v[52:55], v[80:95]
    s_waitcnt lgkmcnt(8)
    s_add_u32 s68, s65, 5
    s_and_b32 s68, s68, 7
    s_lshl_b32 s68, s68, 7
    s_add_u32 s68, s68, s29
    s_add_u32 m0, s26, 0x11000
    s_add_u32 s28, s68, 0x0
    buffer_load_dwordx4 v8, s[8:11], s28 offen lds
    s_add_u32 m0, s26, 0x11400
    s_add_u32 s28, s68, 0x2000
    buffer_load_dwordx4 v9, s[8:11], s28 offen lds
    s_add_u32 m0, s26, 0x11800
    s_add_u32 s28, s68, 0x4000
    buffer_load_dwordx4 v8, s[8:11], s28 offen lds
    s_add_u32 m0, s26, 0x11c00
    s_add_u32 s28, s68, 0x6000
    buffer_load_dwordx4 v9, s[8:11], s28 offen lds
    s_cmp_lg_u32 s81, 1
    s_cbranch_scc1 .Lkvproj_kernel_zs_11
.Lkvproj_kernel_wb_12:
    s_waitcnt vmcnt(0)
    s_lshl_b32 s48, s2, 8
    s_add_u32 s48, s48, 0x0
    v_mov_b32 v5, s48
    v_mov_b32 v6, 1
    s_mov_b64 exec, 1
    buffer_store_dword v6, v5, s[88:91], 0 offen sc1
    s_mov_b64 exec, -1
.Lkvproj_kernel_zs_11:
    v_mfma_f32_32x32x16_bf16 v[64:79], v[156:159], v[56:59], v[64:79]
    ds_read_b64_tr_b16 v[48:49], v10 offset:20480
    ds_read_b64_tr_b16 v[50:51], v10 offset:20992
    buffer_load_dword v1, v14, s[4:7], s69 offen
    v_mfma_f32_32x32x16_bf16 v[80:95], v[156:159], v[60:63], v[80:95]
    ds_read_b64_tr_b16 v[52:53], v10 offset:20736
    ds_read_b64_tr_b16 v[54:55], v10 offset:21248
    s_waitcnt lgkmcnt(10)
    v_mfma_f32_32x32x16_bf16 v[64:79], v[160:163], v[32:35], v[64:79]
    ds_read_b64_tr_b16 v[56:57], v10 offset:22528
    ds_read_b64_tr_b16 v[58:59], v10 offset:23040
    s_waitcnt lgkmcnt(10)
    v_mfma_f32_32x32x16_bf16 v[80:95], v[160:163], v[36:39], v[80:95]
    ds_read_b64_tr_b16 v[60:61], v10 offset:22784
    ds_read_b64_tr_b16 v[62:63], v10 offset:23296
    s_waitcnt lgkmcnt(10)
    v_mfma_f32_32x32x16_bf16 v[64:79], v[164:167], v[40:43], v[64:79]
    ds_read_b64_tr_b16 v[32:33], v10 offset:24576
    ds_read_b64_tr_b16 v[34:35], v10 offset:25088
    s_waitcnt vmcnt(11)
    ds_read_b128 v[176:179], v100 offset:0
    ds_read_b128 v[180:183], v101 offset:0
    ds_read_b128 v[184:187], v102 offset:0
    ds_read_b128 v[188:191], v103 offset:0
    s_waitcnt lgkmcnt(14)
    v_mfma_f32_32x32x16_bf16 v[80:95], v[164:167], v[44:47], v[80:95]
    ds_read_b64_tr_b16 v[36:37], v10 offset:24832
    ds_read_b64_tr_b16 v[38:39], v10 offset:25344
    s_waitcnt lgkmcnt(14)
    v_mfma_f32_32x32x16_bf16 v[64:79], v[168:171], v[48:51], v[64:79]
    ds_read_b64_tr_b16 v[40:41], v10 offset:26624
    ds_read_b64_tr_b16 v[42:43], v10 offset:27136
    s_waitcnt lgkmcnt(14)
    v_mfma_f32_32x32x16_bf16 v[80:95], v[168:171], v[52:55], v[80:95]
    ds_read_b64_tr_b16 v[44:45], v10 offset:26880
    ds_read_b64_tr_b16 v[46:47], v10 offset:27392
    s_waitcnt lgkmcnt(6)
    s_add_u32 s68, s65, 6
    s_and_b32 s68, s68, 7
    s_lshl_b32 s68, s68, 7
    s_add_u32 s68, s68, s29
    s_add_u32 m0, s27, 0x20000
    s_add_u32 s28, s68, 0x0
    buffer_load_dwordx4 v8, s[8:11], s28 offen lds
    s_add_u32 m0, s27, 0x20400
    s_add_u32 s28, s68, 0x2000
    buffer_load_dwordx4 v9, s[8:11], s28 offen lds
    s_add_u32 m0, s27, 0x20800
    s_add_u32 s28, s68, 0x4000
    buffer_load_dwordx4 v8, s[8:11], s28 offen lds
    s_add_u32 m0, s27, 0x20c00
    s_add_u32 s28, s68, 0x6000
    buffer_load_dwordx4 v9, s[8:11], s28 offen lds
    v_mfma_f32_32x32x16_bf16 v[64:79], v[172:175], v[56:59], v[64:79]
    ds_read_b64_tr_b16 v[48:49], v10 offset:28672
    ds_read_b64_tr_b16 v[50:51], v10 offset:29184
    s_add_u32 m0, s67, 0xc000
    s_add_u32 s28, s65, 6
    s_and_b32 s28, s28, 7
    s_lshl_b32 s28, s28, 19
    s_add_u32 s28, s28, s66
    buffer_load_dwordx4 v4, s[4:7], s28 offen lds
    s_add_u32 m0, s67, 0xe000
    s_add_u32 s28, s65, 7
    s_and_b32 s28, s28, 7
    s_lshl_b32 s28, s28, 19
    s_add_u32 s28, s28, s66
    buffer_load_dwordx4 v4, s[4:7], s28 offen lds
    v_mfma_f32_32x32x16_bf16 v[80:95], v[172:175], v[60:63], v[80:95]
    ds_read_b64_tr_b16 v[52:53], v10 offset:28928
    ds_read_b64_tr_b16 v[54:55], v10 offset:29440
    v_mfma_f32_32x32x16_bf16 v[64:79], v[176:179], v[32:35], v[64:79]
    ds_read_b64_tr_b16 v[56:57], v10 offset:30720
    ds_read_b64_tr_b16 v[58:59], v10 offset:31232
    s_waitcnt lgkmcnt(10)
    v_mfma_f32_32x32x16_bf16 v[80:95], v[176:179], v[36:39], v[80:95]
    ds_read_b64_tr_b16 v[60:61], v10 offset:30976
    ds_read_b64_tr_b16 v[62:63], v10 offset:31488
    s_waitcnt lgkmcnt(10)
    v_mfma_f32_32x32x16_bf16 v[64:79], v[180:183], v[40:43], v[64:79]
    s_waitcnt vmcnt(13)
    ds_read_b128 v[192:195], v96 offset:0
    ds_read_b128 v[196:199], v97 offset:0
    ds_read_b128 v[200:203], v98 offset:0
    ds_read_b128 v[204:207], v99 offset:0
    s_waitcnt lgkmcnt(12)
    v_mfma_f32_32x32x16_bf16 v[80:95], v[180:183], v[44:47], v[80:95]
    s_waitcnt vmcnt(11)
    s_barrier
    ds_read_b64_tr_b16 v[32:33], v10 offset:32768
    ds_read_b64_tr_b16 v[34:35], v10 offset:33280
    ds_read_b64_tr_b16 v[36:37], v10 offset:33024
    ds_read_b64_tr_b16 v[38:39], v10 offset:33536
    ds_read_b64_tr_b16 v[40:41], v10 offset:34816
    ds_read_b64_tr_b16 v[42:43], v10 offset:35328
    ds_read_b64_tr_b16 v[44:45], v10 offset:35072
    ds_read_b64_tr_b16 v[46:47], v10 offset:35584
    s_waitcnt lgkmcnt(15)
    v_mfma_f32_32x32x16_bf16 v[64:79], v[184:187], v[48:51], v[64:79]
    v_mfma_f32_32x32x16_bf16 v[80:95], v[184:187], v[52:55], v[80:95]
    s_waitcnt lgkmcnt(8)
    s_add_u32 s68, s65, 7
    s_and_b32 s68, s68, 7
    s_lshl_b32 s68, s68, 7
    s_add_u32 s68, s68, s29
    s_add_u32 m0, s26, 0x10000
    s_add_u32 s28, s68, 0x0
    buffer_load_dwordx4 v8, s[8:11], s28 offen lds
    s_add_u32 m0, s26, 0x10400
    s_add_u32 s28, s68, 0x2000
    buffer_load_dwordx4 v9, s[8:11], s28 offen lds
    s_add_u32 m0, s26, 0x10800
    s_add_u32 s28, s68, 0x4000
    buffer_load_dwordx4 v8, s[8:11], s28 offen lds
    s_add_u32 m0, s26, 0x10c00
    s_add_u32 s28, s68, 0x6000
    buffer_load_dwordx4 v9, s[8:11], s28 offen lds
    v_mfma_f32_32x32x16_bf16 v[64:79], v[188:191], v[56:59], v[64:79]
    ds_read_b64_tr_b16 v[48:49], v10 offset:36864
    ds_read_b64_tr_b16 v[50:51], v10 offset:37376
    buffer_load_dword v1, v14, s[4:7], s69 offen offset:128
    v_mfma_f32_32x32x16_bf16 v[80:95], v[188:191], v[60:63], v[80:95]
    ds_read_b64_tr_b16 v[52:53], v10 offset:37120
    ds_read_b64_tr_b16 v[54:55], v10 offset:37632
    s_waitcnt lgkmcnt(10)
    v_mfma_f32_32x32x16_bf16 v[64:79], v[192:195], v[32:35], v[64:79]
    ds_read_b64_tr_b16 v[56:57], v10 offset:38912
    ds_read_b64_tr_b16 v[58:59], v10 offset:39424
    s_waitcnt lgkmcnt(10)
    v_mfma_f32_32x32x16_bf16 v[80:95], v[192:195], v[36:39], v[80:95]
    ds_read_b64_tr_b16 v[60:61], v10 offset:39168
    ds_read_b64_tr_b16 v[62:63], v10 offset:39680
    s_waitcnt lgkmcnt(10)
    v_mfma_f32_32x32x16_bf16 v[64:79], v[196:199], v[40:43], v[64:79]
    ds_read_b64_tr_b16 v[32:33], v10 offset:40960
    ds_read_b64_tr_b16 v[34:35], v10 offset:41472
    s_waitcnt vmcnt(12)
    ds_read_b128 v[208:211], v96 offset:4096
    ds_read_b128 v[212:215], v97 offset:4096
    ds_read_b128 v[216:219], v98 offset:4096
    ds_read_b128 v[220:223], v99 offset:4096
    s_waitcnt lgkmcnt(14)
    v_mfma_f32_32x32x16_bf16 v[80:95], v[196:199], v[44:47], v[80:95]
    ds_read_b64_tr_b16 v[36:37], v10 offset:41216
    ds_read_b64_tr_b16 v[38:39], v10 offset:41728
    s_waitcnt lgkmcnt(14)
    v_mfma_f32_32x32x16_bf16 v[64:79], v[200:203], v[48:51], v[64:79]
    ds_read_b64_tr_b16 v[40:41], v10 offset:43008
    ds_read_b64_tr_b16 v[42:43], v10 offset:43520
    s_waitcnt lgkmcnt(14)
    v_mfma_f32_32x32x16_bf16 v[80:95], v[200:203], v[52:55], v[80:95]
    ds_read_b64_tr_b16 v[44:45], v10 offset:43264
    ds_read_b64_tr_b16 v[46:47], v10 offset:43776
    s_waitcnt lgkmcnt(6)
    s_add_u32 m0, s26, 0x11000
    s_add_u32 s28, s25, 0x40080
    buffer_load_dwordx4 v4, s[4:7], s28 offen lds
    s_add_u32 m0, s26, 0x11400
    s_add_u32 s28, s25, 0x50080
    buffer_load_dwordx4 v4, s[4:7], s28 offen lds
    s_add_u32 m0, s26, 0x11800
    s_add_u32 s28, s25, 0x60080
    buffer_load_dwordx4 v4, s[4:7], s28 offen lds
    s_add_u32 m0, s26, 0x11c00
    s_add_u32 s28, s25, 0x70080
    buffer_load_dwordx4 v4, s[4:7], s28 offen lds
    v_mfma_f32_32x32x16_bf16 v[64:79], v[204:207], v[56:59], v[64:79]
    ds_read_b64_tr_b16 v[48:49], v10 offset:45056
    ds_read_b64_tr_b16 v[50:51], v10 offset:45568
    v_mfma_f32_32x32x16_bf16 v[80:95], v[204:207], v[60:63], v[80:95]
    ds_read_b64_tr_b16 v[52:53], v10 offset:45312
    ds_read_b64_tr_b16 v[54:55], v10 offset:45824
    v_mfma_f32_32x32x16_bf16 v[64:79], v[208:211], v[32:35], v[64:79]
    ds_read_b64_tr_b16 v[56:57], v10 offset:47104
    ds_read_b64_tr_b16 v[58:59], v10 offset:47616
    buffer_load_dwordx4 v[6:9], v3, s[16:19], s45 offen
    s_waitcnt lgkmcnt(10)
    v_mfma_f32_32x32x16_bf16 v[80:95], v[208:211], v[36:39], v[80:95]
    ds_read_b64_tr_b16 v[60:61], v10 offset:47360
    ds_read_b64_tr_b16 v[62:63], v10 offset:47872
    s_waitcnt lgkmcnt(10)
    v_mfma_f32_32x32x16_bf16 v[64:79], v[212:215], v[40:43], v[64:79]
    s_waitcnt vmcnt(12)
    ds_read_b128 v[224:227], v100 offset:0
    ds_read_b128 v[228:231], v101 offset:0
    ds_read_b128 v[232:235], v102 offset:0
    ds_read_b128 v[236:239], v103 offset:0
    s_waitcnt lgkmcnt(12)
    v_mfma_f32_32x32x16_bf16 v[80:95], v[212:215], v[44:47], v[80:95]
    s_waitcnt vmcnt(10)
    s_barrier
    ds_read_b64_tr_b16 v[32:33], v10 offset:49152
    ds_read_b64_tr_b16 v[34:35], v10 offset:49664
    ds_read_b64_tr_b16 v[36:37], v10 offset:49408
    ds_read_b64_tr_b16 v[38:39], v10 offset:49920
    ds_read_b64_tr_b16 v[40:41], v10 offset:51200
    ds_read_b64_tr_b16 v[42:43], v10 offset:51712
    ds_read_b64_tr_b16 v[44:45], v10 offset:51456
    ds_read_b64_tr_b16 v[46:47], v10 offset:51968
    s_waitcnt lgkmcnt(15)
    v_mfma_f32_32x32x16_bf16 v[64:79], v[216:219], v[48:51], v[64:79]
    v_mfma_f32_32x32x16_bf16 v[80:95], v[216:219], v[52:55], v[80:95]
    s_waitcnt lgkmcnt(8)
    v_mfma_f32_32x32x16_bf16 v[64:79], v[220:223], v[56:59], v[64:79]
    ds_read_b64_tr_b16 v[48:49], v10 offset:53248
    ds_read_b64_tr_b16 v[50:51], v10 offset:53760
    buffer_load_dword v1, v14, s[4:7], s69 offen offset:256
    v_mfma_f32_32x32x16_bf16 v[80:95], v[220:223], v[60:63], v[80:95]
    ds_read_b64_tr_b16 v[52:53], v10 offset:53504
    ds_read_b64_tr_b16 v[54:55], v10 offset:54016
    s_waitcnt lgkmcnt(10)
    v_mfma_f32_32x32x16_bf16 v[64:79], v[224:227], v[32:35], v[64:79]
    ds_read_b64_tr_b16 v[56:57], v10 offset:55296
    ds_read_b64_tr_b16 v[58:59], v10 offset:55808
    s_waitcnt lgkmcnt(10)
    v_mfma_f32_32x32x16_bf16 v[80:95], v[224:227], v[36:39], v[80:95]
    ds_read_b64_tr_b16 v[60:61], v10 offset:55552
    ds_read_b64_tr_b16 v[62:63], v10 offset:56064
    s_waitcnt lgkmcnt(10)
    v_mfma_f32_32x32x16_bf16 v[64:79], v[228:231], v[40:43], v[64:79]
    ds_read_b64_tr_b16 v[32:33], v10 offset:57344
    ds_read_b64_tr_b16 v[34:35], v10 offset:57856
    s_waitcnt vmcnt(7)
    ds_read_b128 v[240:243], v96 offset:0
    ds_read_b128 v[244:247], v97 offset:0
    ds_read_b128 v[248:251], v98 offset:0
    ds_read_b128 v[252:255], v99 offset:0
    s_waitcnt lgkmcnt(14)
    v_mfma_f32_32x32x16_bf16 v[80:95], v[228:231], v[44:47], v[80:95]
    ds_read_b64_tr_b16 v[36:37], v10 offset:57600
    ds_read_b64_tr_b16 v[38:39], v10 offset:58112
    s_waitcnt lgkmcnt(14)
    v_mfma_f32_32x32x16_bf16 v[64:79], v[232:235], v[48:51], v[64:79]
    ds_read_b64_tr_b16 v[40:41], v10 offset:59392
    ds_read_b64_tr_b16 v[42:43], v10 offset:59904
    s_waitcnt lgkmcnt(14)
    v_mfma_f32_32x32x16_bf16 v[80:95], v[232:235], v[52:55], v[80:95]
    ds_read_b64_tr_b16 v[44:45], v10 offset:59648
    ds_read_b64_tr_b16 v[46:47], v10 offset:60160
    s_waitcnt lgkmcnt(6)
    s_add_u32 m0, s26, 0x10000
    s_add_u32 s28, s25, 0x80
    buffer_load_dwordx4 v4, s[4:7], s28 offen lds
    s_add_u32 m0, s26, 0x10400
    s_add_u32 s28, s25, 0x10080
    buffer_load_dwordx4 v4, s[4:7], s28 offen lds
    s_add_u32 m0, s26, 0x10800
    s_add_u32 s28, s25, 0x20080
    buffer_load_dwordx4 v4, s[4:7], s28 offen lds
    s_add_u32 m0, s26, 0x10c00
    s_add_u32 s28, s25, 0x30080
    buffer_load_dwordx4 v4, s[4:7], s28 offen lds
    v_mfma_f32_32x32x16_bf16 v[64:79], v[236:239], v[56:59], v[64:79]
    ds_read_b64_tr_b16 v[48:49], v10 offset:61440
    ds_read_b64_tr_b16 v[50:51], v10 offset:61952
    v_mfma_f32_32x32x16_bf16 v[80:95], v[236:239], v[60:63], v[80:95]
    ds_read_b64_tr_b16 v[52:53], v10 offset:61696
    ds_read_b64_tr_b16 v[54:55], v10 offset:62208
    v_mfma_f32_32x32x16_bf16 v[64:79], v[240:243], v[32:35], v[64:79]
    ds_read_b64_tr_b16 v[56:57], v10 offset:63488
    ds_read_b64_tr_b16 v[58:59], v10 offset:64000
    s_waitcnt lgkmcnt(10)
    v_mfma_f32_32x32x16_bf16 v[80:95], v[240:243], v[36:39], v[80:95]
    ds_read_b64_tr_b16 v[60:61], v10 offset:63744
    ds_read_b64_tr_b16 v[62:63], v10 offset:64256
    s_waitcnt lgkmcnt(10)
    v_mfma_f32_32x32x16_bf16 v[64:79], v[244:247], v[40:43], v[64:79]
    s_waitcnt lgkmcnt(8)
    v_mfma_f32_32x32x16_bf16 v[80:95], v[244:247], v[44:47], v[80:95]
    s_waitcnt vmcnt(6) lgkmcnt(0)
    s_barrier
    ds_read_b64_tr_b16 v[32:33], v11 offset:4096
    ds_read_b64_tr_b16 v[34:35], v11 offset:4608
    ds_read_b64_tr_b16 v[36:37], v11 offset:4352
    ds_read_b64_tr_b16 v[38:39], v11 offset:4864
    ds_read_b64_tr_b16 v[40:41], v11 offset:6144
    ds_read_b64_tr_b16 v[42:43], v11 offset:6656
    ds_read_b64_tr_b16 v[44:45], v11 offset:6400
    ds_read_b64_tr_b16 v[46:47], v11 offset:6912
    v_mfma_f32_32x32x16_bf16 v[64:79], v[248:251], v[48:51], v[64:79]
    v_mfma_f32_32x32x16_bf16 v[80:95], v[248:251], v[52:55], v[80:95]
    v_mfma_f32_32x32x16_bf16 v[64:79], v[252:255], v[56:59], v[64:79]
    ds_read_b64_tr_b16 v[48:49], v11 offset:12288
    ds_read_b64_tr_b16 v[50:51], v11 offset:12800
    v_mfma_f32_32x32x16_bf16 v[80:95], v[252:255], v[60:63], v[80:95]
    ds_read_b64_tr_b16 v[52:53], v11 offset:12544
    ds_read_b64_tr_b16 v[54:55], v11 offset:13056
    s_waitcnt lgkmcnt(10)
    v_mfma_f32_32x32x16_bf16 v[96:111], v[136:139], v[32:35], 0
    ds_read_b64_tr_b16 v[56:57], v11 offset:14336
    ds_read_b64_tr_b16 v[58:59], v11 offset:14848
    s_waitcnt lgkmcnt(10)
    v_mfma_f32_32x32x16_bf16 v[112:127], v[136:139], v[36:39], 0
    ds_read_b64_tr_b16 v[60:61], v11 offset:14592
    ds_read_b64_tr_b16 v[62:63], v11 offset:15104
    s_add_u32 m0, s26, 0x0
    s_add_u32 s28, s25, 0x100
    buffer_load_dwordx4 v4, s[4:7], s28 offen lds
    s_waitcnt lgkmcnt(10)
    v_mfma_f32_32x32x16_bf16 v[96:111], v[140:143], v[40:43], v[96:111]
    ds_read_b64_tr_b16 v[32:33], v11 offset:20480
    ds_read_b64_tr_b16 v[34:35], v11 offset:20992
    s_add_u32 m0, s26, 0x400
    s_add_u32 s28, s25, 0x10100
    buffer_load_dwordx4 v4, s[4:7], s28 offen lds
    s_waitcnt lgkmcnt(10)
    v_mfma_f32_32x32x16_bf16 v[112:127], v[140:143], v[44:47], v[112:127]
    ds_read_b64_tr_b16 v[36:37], v11 offset:20736
    ds_read_b64_tr_b16 v[38:39], v11 offset:21248
    s_add_u32 m0, s26, 0x800
    s_add_u32 s28, s25, 0x20100
    buffer_load_dwordx4 v4, s[4:7], s28 offen lds
    s_waitcnt lgkmcnt(10)
    v_mfma_f32_32x32x16_bf16 v[96:111], v[152:155], v[48:51], v[96:111]
    ds_read_b64_tr_b16 v[40:41], v11 offset:22528
    ds_read_b64_tr_b16 v[42:43], v11 offset:23040
    s_add_u32 m0, s26, 0xc00
    s_add_u32 s28, s25, 0x30100
    buffer_load_dwordx4 v4, s[4:7], s28 offen lds
    s_waitcnt lgkmcnt(10)
    v_mfma_f32_32x32x16_bf16 v[112:127], v[152:155], v[52:55], v[112:127]
    ds_read_b64_tr_b16 v[44:45], v11 offset:22784
    ds_read_b64_tr_b16 v[46:47], v11 offset:23296
    s_add_u32 m0, s26, 0x1000
    s_add_u32 s28, s25, 0x40100
    buffer_load_dwordx4 v4, s[4:7], s28 offen lds
    s_waitcnt lgkmcnt(10)
    v_mfma_f32_32x32x16_bf16 v[96:111], v[156:159], v[56:59], v[96:111]
    ds_read_b64_tr_b16 v[48:49], v11 offset:28672
    ds_read_b64_tr_b16 v[50:51], v11 offset:29184
    s_add_u32 m0, s26, 0x1400
    s_add_u32 s28, s25, 0x50100
    buffer_load_dwordx4 v4, s[4:7], s28 offen lds
    s_waitcnt lgkmcnt(10)
    v_mfma_f32_32x32x16_bf16 v[112:127], v[156:159], v[60:63], v[112:127]
    ds_read_b64_tr_b16 v[52:53], v11 offset:28928
    ds_read_b64_tr_b16 v[54:55], v11 offset:29440
    s_add_u32 m0, s26, 0x1800
    s_add_u32 s28, s25, 0x60100
    buffer_load_dwordx4 v4, s[4:7], s28 offen lds
    s_waitcnt lgkmcnt(10)
    v_mfma_f32_32x32x16_bf16 v[96:111], v[168:171], v[32:35], v[96:111]
    ds_read_b64_tr_b16 v[56:57], v11 offset:30720
    ds_read_b64_tr_b16 v[58:59], v11 offset:31232
    s_add_u32 m0, s26, 0x1c00
    s_add_u32 s28, s25, 0x70100
    buffer_load_dwordx4 v4, s[4:7], s28 offen lds
    s_waitcnt lgkmcnt(10)
    v_mfma_f32_32x32x16_bf16 v[112:127], v[168:171], v[36:39], v[112:127]
    ds_read_b64_tr_b16 v[60:61], v11 offset:30976
    ds_read_b64_tr_b16 v[62:63], v11 offset:31488
    s_waitcnt lgkmcnt(10)
    v_mfma_f32_32x32x16_bf16 v[96:111], v[172:175], v[40:43], v[96:111]
    ds_read_b64_tr_b16 v[32:33], v11 offset:36864
    ds_read_b64_tr_b16 v[34:35], v11 offset:37376
    v_cvt_pk_bf16_f32 v16, v64, v65
    v_cvt_pk_bf16_f32 v17, v66, v67
    v_cvt_pk_bf16_f32 v18, v68, v69
    v_cvt_pk_bf16_f32 v19, v70, v71
    s_waitcnt lgkmcnt(10)
    v_mfma_f32_32x32x16_bf16 v[112:127], v[172:175], v[44:47], v[112:127]
    ds_read_b64_tr_b16 v[36:37], v11 offset:37120
    ds_read_b64_tr_b16 v[38:39], v11 offset:37632
    s_add_u32 s28, s30, 0x4000
    buffer_store_dwordx4 v[16:19], v3, s[12:15], s28 offen sc1
    s_waitcnt lgkmcnt(10)
    v_mfma_f32_32x32x16_bf16 v[96:111], v[184:187], v[48:51], v[96:111]
    ds_read_b64_tr_b16 v[40:41], v11 offset:38912
    ds_read_b64_tr_b16 v[42:43], v11 offset:39424
    s_waitcnt lgkmcnt(10)
    v_mfma_f32_32x32x16_bf16 v[112:127], v[184:187], v[52:55], v[112:127]
    ds_read_b64_tr_b16 v[44:45], v11 offset:39168
    ds_read_b64_tr_b16 v[46:47], v11 offset:39680
    v_cvt_pk_bf16_f32 v20, v72, v73
    v_cvt_pk_bf16_f32 v21, v74, v75
    v_cvt_pk_bf16_f32 v22, v76, v77
    v_cvt_pk_bf16_f32 v23, v78, v79
    s_waitcnt lgkmcnt(10)
    v_mfma_f32_32x32x16_bf16 v[96:111], v[188:191], v[56:59], v[96:111]
    ds_read_b64_tr_b16 v[48:49], v11 offset:45056
    ds_read_b64_tr_b16 v[50:51], v11 offset:45568
    s_add_u32 s28, s30, 0x5000
    buffer_store_dwordx4 v[20:23], v3, s[12:15], s28 offen sc1
    s_waitcnt lgkmcnt(10)
    v_mfma_f32_32x32x16_bf16 v[112:127], v[188:191], v[60:63], v[112:127]
    ds_read_b64_tr_b16 v[52:53], v11 offset:45312
    ds_read_b64_tr_b16 v[54:55], v11 offset:45824
    s_waitcnt lgkmcnt(10)
    v_mfma_f32_32x32x16_bf16 v[96:111], v[200:203], v[32:35], v[96:111]
    ds_read_b64_tr_b16 v[56:57], v11 offset:47104
    ds_read_b64_tr_b16 v[58:59], v11 offset:47616
    v_cvt_pk_bf16_f32 v24, v80, v81
    v_cvt_pk_bf16_f32 v25, v82, v83
    v_cvt_pk_bf16_f32 v26, v84, v85
    v_cvt_pk_bf16_f32 v27, v86, v87
    s_waitcnt lgkmcnt(10)
    v_mfma_f32_32x32x16_bf16 v[112:127], v[200:203], v[36:39], v[112:127]
    ds_read_b64_tr_b16 v[60:61], v11 offset:47360
    ds_read_b64_tr_b16 v[62:63], v11 offset:47872
    s_add_u32 s28, s30, 0x4400
    buffer_store_dwordx4 v[24:27], v3, s[12:15], s28 offen sc1
    s_waitcnt lgkmcnt(10)
    v_mfma_f32_32x32x16_bf16 v[96:111], v[204:207], v[40:43], v[96:111]
    ds_read_b64_tr_b16 v[32:33], v11 offset:53248
    ds_read_b64_tr_b16 v[34:35], v11 offset:53760
    s_waitcnt lgkmcnt(10)
    v_mfma_f32_32x32x16_bf16 v[112:127], v[204:207], v[44:47], v[112:127]
    ds_read_b64_tr_b16 v[36:37], v11 offset:53504
    ds_read_b64_tr_b16 v[38:39], v11 offset:54016
    v_cvt_pk_bf16_f32 v28, v88, v89
    v_cvt_pk_bf16_f32 v29, v90, v91
    v_cvt_pk_bf16_f32 v30, v92, v93
    v_cvt_pk_bf16_f32 v31, v94, v95
    s_waitcnt lgkmcnt(10)
    v_mfma_f32_32x32x16_bf16 v[96:111], v[216:219], v[48:51], v[96:111]
    ds_read_b64_tr_b16 v[40:41], v11 offset:55296
    ds_read_b64_tr_b16 v[42:43], v11 offset:55808
    s_add_u32 s28, s30, 0x5400
    buffer_store_dwordx4 v[28:31], v3, s[12:15], s28 offen sc1
    s_waitcnt lgkmcnt(10)
    v_mfma_f32_32x32x16_bf16 v[112:127], v[216:219], v[52:55], v[112:127]
    ds_read_b64_tr_b16 v[44:45], v11 offset:55552
    ds_read_b64_tr_b16 v[46:47], v11 offset:56064
    s_waitcnt vmcnt(17)
    s_waitcnt lgkmcnt(10)
    v_mfma_f32_32x32x16_bf16 v[96:111], v[220:223], v[56:59], v[96:111]
    ds_read_b64_tr_b16 v[48:49], v11 offset:61440
    ds_read_b64_tr_b16 v[50:51], v11 offset:61952
    v_lshlrev_b32 v64, 16, v6
    v_and_b32 v65, 0xffff0000, v6
    v_lshlrev_b32 v66, 16, v7
    v_and_b32 v67, 0xffff0000, v7
    s_waitcnt lgkmcnt(10)
    v_mfma_f32_32x32x16_bf16 v[112:127], v[220:223], v[60:63], v[112:127]
    ds_read_b64_tr_b16 v[52:53], v11 offset:61696
    ds_read_b64_tr_b16 v[54:55], v11 offset:62208
    v_lshlrev_b32 v68, 16, v8
    v_and_b32 v69, 0xffff0000, v8
    v_lshlrev_b32 v70, 16, v9
    s_waitcnt lgkmcnt(10)
    v_mfma_f32_32x32x16_bf16 v[96:111], v[232:235], v[32:35], v[96:111]
    ds_read_b64_tr_b16 v[56:57], v11 offset:63488
    ds_read_b64_tr_b16 v[58:59], v11 offset:64000
    v_and_b32 v71, 0xffff0000, v9
    v_add_f32 v72, v64, v65
    v_add_f32 v72, v72, v66
    v_add_f32 v72, v72, v67
    s_waitcnt lgkmcnt(10)
    v_mfma_f32_32x32x16_bf16 v[112:127], v[232:235], v[36:39], v[112:127]
    ds_read_b64_tr_b16 v[60:61], v11 offset:63744
    ds_read_b64_tr_b16 v[62:63], v11 offset:64256
    v_add_f32 v72, v72, v68
    v_add_f32 v72, v72, v69
    v_add_f32 v72, v72, v70
    s_waitcnt lgkmcnt(10)
    v_mfma_f32_32x32x16_bf16 v[96:111], v[236:239], v[40:43], v[96:111]
    v_add_f32 v72, v72, v71
    s_nop 1
    v_add_f32_dpp v72, v72, v72 quad_perm:[1,0,3,2] row_mask:0xf bank_mask:0xf
    s_nop 1
    v_add_f32_dpp v72, v72, v72 quad_perm:[2,3,0,1] row_mask:0xf bank_mask:0xf
    s_nop 1
    v_add_f32_dpp v72, v72, v72 row_half_mirror row_mask:0xf bank_mask:0xf
    s_waitcnt lgkmcnt(8)
    v_mfma_f32_32x32x16_bf16 v[112:127], v[236:239], v[44:47], v[112:127]
    s_waitcnt vmcnt(12)
    s_barrier
    ds_read_b64_tr_b16 v[32:33], v11 offset:0
    ds_read_b64_tr_b16 v[34:35], v11 offset:512
    ds_read_b64_tr_b16 v[36:37], v11 offset:256
    ds_read_b64_tr_b16 v[38:39], v11 offset:768
    ds_read_b64_tr_b16 v[40:41], v11 offset:2048
    ds_read_b64_tr_b16 v[42:43], v11 offset:2560
    ds_read_b64_tr_b16 v[44:45], v11 offset:2304
    ds_read_b64_tr_b16 v[46:47], v11 offset:2816
    v_add_f32_dpp v72, v72, v72 row_mirror row_mask:0xf bank_mask:0xf
    v_mov_b32 v74, v72
    s_nop 1
    v_permlane16_swap_b32 v72, v74
    s_waitcnt lgkmcnt(14)
    v_mfma_f32_32x32x16_bf16 v[96:111], v[248:251], v[48:51], v[96:111]
    v_add_f32 v72, v72, v74
    v_mov_b32 v74, v72
    s_nop 1
    v_permlane32_swap_b32 v72, v74
    v_add_f32 v72, v72, v74
    s_waitcnt lgkmcnt(12)
    v_mfma_f32_32x32x16_bf16 v[112:127], v[248:251], v[52:55], v[112:127]
    v_mul_f32 v72, 0x3b000000, v72
    v_sub_f32 v76, v64, v72
    v_sub_f32 v77, v65, v72
    s_waitcnt lgkmcnt(10)
    v_mfma_f32_32x32x16_bf16 v[96:111], v[252:255], v[56:59], v[96:111]
    ds_read_b64_tr_b16 v[48:49], v11 offset:8192
    ds_read_b64_tr_b16 v[50:51], v11 offset:8704
    v_sub_f32 v78, v66, v72
    v_sub_f32 v79, v67, v72
    v_sub_f32 v80, v68, v72
    v_sub_f32 v81, v69, v72
    s_waitcnt lgkmcnt(10)
    v_mfma_f32_32x32x16_bf16 v[112:127], v[252:255], v[60:63], v[112:127]
    ds_read_b64_tr_b16 v[52:53], v11 offset:8448
    ds_read_b64_tr_b16 v[54:55], v11 offset:8960
    buffer_load_dword v1, v13, s[72:75], s64 offen
    v_sub_f32 v82, v70, v72
    v_sub_f32 v83, v71, v72
    v_mul_f32 v73, v76, v76
    s_waitcnt lgkmcnt(10)
    v_mfma_f32_32x32x16_bf16 v[96:111], v[128:131], v[32:35], v[96:111]
    ds_read_b64_tr_b16 v[56:57], v11 offset:10240
    ds_read_b64_tr_b16 v[58:59], v11 offset:10752
    v_fmac_f32 v73, v77, v77
    v_fmac_f32 v73, v78, v78
    v_fmac_f32 v73, v79, v79
    v_fmac_f32 v73, v80, v80
    s_waitcnt lgkmcnt(10)
    v_mfma_f32_32x32x16_bf16 v[112:127], v[128:131], v[36:39], v[112:127]
    ds_read_b64_tr_b16 v[60:61], v11 offset:10496
    ds_read_b64_tr_b16 v[62:63], v11 offset:11008
    v_fmac_f32 v73, v81, v81
    v_fmac_f32 v73, v82, v82
    v_fmac_f32 v73, v83, v83
    s_waitcnt lgkmcnt(10)
    v_mfma_f32_32x32x16_bf16 v[96:111], v[132:135], v[40:43], v[96:111]
    ds_read_b64_tr_b16 v[32:33], v11 offset:16384
    ds_read_b64_tr_b16 v[34:35], v11 offset:16896
    v_add_f32_dpp v73, v73, v73 quad_perm:[1,0,3,2] row_mask:0xf bank_mask:0xf
    s_nop 1
    v_add_f32_dpp v73, v73, v73 quad_perm:[2,3,0,1] row_mask:0xf bank_mask:0xf
    s_nop 1
    v_add_f32_dpp v73, v73, v73 row_half_mirror row_mask:0xf bank_mask:0xf
    s_nop 1
    v_add_f32_dpp v73, v73, v73 row_mirror row_mask:0xf bank_mask:0xf
    s_waitcnt lgkmcnt(10)
    v_mfma_f32_32x32x16_bf16 v[112:127], v[132:135], v[44:47], v[112:127]
    ds_read_b64_tr_b16 v[36:37], v11 offset:16640
    ds_read_b64_tr_b16 v[38:39], v11 offset:17152
    v_mov_b32 v74, v73
    s_nop 1
    v_permlane16_swap_b32 v73, v74
    v_add_f32 v73, v73, v74
    s_waitcnt lgkmcnt(10)
    v_mfma_f32_32x32x16_bf16 v[96:111], v[144:147], v[48:51], v[96:111]
    ds_read_b64_tr_b16 v[40:41], v11 offset:18432
    ds_read_b64_tr_b16 v[42:43], v11 offset:18944
    v_mov_b32 v74, v73
    s_nop 1
    v_permlane32_swap_b32 v73, v74
    v_add_f32 v73, v73, v74
    v_mul_f32 v73, 0x3b000000, v73
    s_waitcnt lgkmcnt(10)
    v_mfma_f32_32x32x16_bf16 v[112:127], v[144:147], v[52:55], v[112:127]
    ds_read_b64_tr_b16 v[44:45], v11 offset:18688
    ds_read_b64_tr_b16 v[46:47], v11 offset:19200
    v_cvt_pk_bf16_f32 v74, v72, v73
    v_lshlrev_b32 v72, 16, v74
    v_and_b32 v73, 0xffff0000, v74
    s_waitcnt lgkmcnt(10)
    v_mfma_f32_32x32x16_bf16 v[96:111], v[148:151], v[56:59], v[96:111]
    ds_read_b64_tr_b16 v[48:49], v11 offset:24576
    ds_read_b64_tr_b16 v[50:51], v11 offset:25088
    v_add_f32 v73, 0x3727c5ac, v73
    v_cvt_pk_bf16_f32 v73, v73, v73
    v_and_b32 v73, 0xffff0000, v73
    v_sqrt_f32 v73, v73
    s_waitcnt lgkmcnt(10)
    v_mfma_f32_32x32x16_bf16 v[112:127], v[148:151], v[60:63], v[112:127]
    ds_read_b64_tr_b16 v[52:53], v11 offset:24832
    ds_read_b64_tr_b16 v[54:55], v11 offset:25344
    v_cvt_pk_bf16_f32 v73, v73, v73
    v_and_b32 v73, 0xffff0000, v73
    v_rcp_f32 v74, v73
    s_waitcnt lgkmcnt(10)
    v_mfma_f32_32x32x16_bf16 v[96:111], v[160:163], v[32:35], v[96:111]
    ds_read_b64_tr_b16 v[56:57], v11 offset:26624
    ds_read_b64_tr_b16 v[58:59], v11 offset:27136
    v_sub_f32 v64, v64, v72
    v_sub_f32 v65, v65, v72
    v_sub_f32 v66, v66, v72
    v_sub_f32 v67, v67, v72
    s_waitcnt lgkmcnt(10)
    v_mfma_f32_32x32x16_bf16 v[112:127], v[160:163], v[36:39], v[112:127]
    ds_read_b64_tr_b16 v[60:61], v11 offset:26880
    ds_read_b64_tr_b16 v[62:63], v11 offset:27392
    v_sub_f32 v68, v68, v72
    v_sub_f32 v69, v69, v72
    v_sub_f32 v70, v70, v72
    s_waitcnt lgkmcnt(10)
    v_mfma_f32_32x32x16_bf16 v[96:111], v[164:167], v[40:43], v[96:111]
    ds_read_b64_tr_b16 v[32:33], v11 offset:32768
    ds_read_b64_tr_b16 v[34:35], v11 offset:33280
    v_sub_f32 v71, v71, v72
    v_cvt_pk_bf16_f32 v6, v64, v65
    v_cvt_pk_bf16_f32 v7, v66, v67
    v_cvt_pk_bf16_f32 v8, v68, v69
    s_waitcnt lgkmcnt(10)
    v_mfma_f32_32x32x16_bf16 v[112:127], v[164:167], v[44:47], v[112:127]
    ds_read_b64_tr_b16 v[36:37], v11 offset:33024
    ds_read_b64_tr_b16 v[38:39], v11 offset:33536
    v_cvt_pk_bf16_f32 v9, v70, v71
    v_lshlrev_b32 v64, 16, v6
    v_and_b32 v65, 0xffff0000, v6
    s_waitcnt lgkmcnt(10)
    v_mfma_f32_32x32x16_bf16 v[96:111], v[176:179], v[48:51], v[96:111]
    ds_read_b64_tr_b16 v[40:41], v11 offset:34816
    ds_read_b64_tr_b16 v[42:43], v11 offset:35328
    v_lshlrev_b32 v66, 16, v7
    v_and_b32 v67, 0xffff0000, v7
    v_lshlrev_b32 v68, 16, v8
    v_and_b32 v69, 0xffff0000, v8
    s_waitcnt lgkmcnt(10)
    v_mfma_f32_32x32x16_bf16 v[112:127], v[176:179], v[52:55], v[112:127]
    ds_read_b64_tr_b16 v[44:45], v11 offset:35072
    ds_read_b64_tr_b16 v[46:47], v11 offset:35584
    v_lshlrev_b32 v70, 16, v9
    v_and_b32 v71, 0xffff0000, v9
    v_mul_f32 v76, v64, v74
    s_waitcnt lgkmcnt(10)
    v_mfma_f32_32x32x16_bf16 v[96:111], v[180:183], v[56:59], v[96:111]
    ds_read_b64_tr_b16 v[48:49], v11 offset:40960
    ds_read_b64_tr_b16 v[50:51], v11 offset:41472
    v_mul_f32 v77, v65, v74
    v_mul_f32 v78, v66, v74
    v_mul_f32 v79, v67, v74
    v_mul_f32 v80, v68, v74
    s_waitcnt lgkmcnt(10)
    v_mfma_f32_32x32x16_bf16 v[112:127], v[180:183], v[60:63], v[112:127]
    ds_read_b64_tr_b16 v[52:53], v11 offset:41216
    ds_read_b64_tr_b16 v[54:55], v11 offset:41728
    v_mul_f32 v81, v69, v74
    v_mul_f32 v82, v70, v74
    v_mul_f32 v83, v71, v74
    s_waitcnt lgkmcnt(10)
    v_mfma_f32_32x32x16_bf16 v[96:111], v[192:195], v[32:35], v[96:111]
    ds_read_b64_tr_b16 v[56:57], v11 offset:43008
    ds_read_b64_tr_b16 v[58:59], v11 offset:43520
    v_fma_f32 v84, -v76, v73, v64
    v_fma_f32 v85, -v77, v73, v65
    v_fma_f32 v86, -v78, v73, v66
    v_fma_f32 v87, -v79, v73, v67
    s_waitcnt lgkmcnt(10)
    v_mfma_f32_32x32x16_bf16 v[112:127], v[192:195], v[36:39], v[112:127]
    ds_read_b64_tr_b16 v[60:61], v11 offset:43264
    ds_read_b64_tr_b16 v[62:63], v11 offset:43776
    v_fma_f32 v88, -v80, v73, v68
    v_fma_f32 v89, -v81, v73, v69
    v_fma_f32 v90, -v82, v73, v70
    s_waitcnt lgkmcnt(10)
    v_mfma_f32_32x32x16_bf16 v[96:111], v[196:199], v[40:43], v[96:111]
    ds_read_b64_tr_b16 v[32:33], v11 offset:49152
    ds_read_b64_tr_b16 v[34:35], v11 offset:49664
    v_fma_f32 v91, -v83, v73, v71
    v_fmac_f32 v76, v84, v74
    v_fmac_f32 v77, v85, v74
    v_fmac_f32 v78, v86, v74
    s_waitcnt lgkmcnt(10)
    v_mfma_f32_32x32x16_bf16 v[112:127], v[196:199], v[44:47], v[112:127]
    ds_read_b64_tr_b16 v[36:37], v11 offset:49408
    ds_read_b64_tr_b16 v[38:39], v11 offset:49920
    v_fmac_f32 v79, v87, v74
    v_fmac_f32 v80, v88, v74
    v_fmac_f32 v81, v89, v74
    s_waitcnt lgkmcnt(10)
    v_mfma_f32_32x32x16_bf16 v[96:111], v[208:211], v[48:51], v[96:111]
    ds_read_b64_tr_b16 v[40:41], v11 offset:51200
    ds_read_b64_tr_b16 v[42:43], v11 offset:51712
    v_fmac_f32 v82, v90, v74
    v_fmac_f32 v83, v91, v74
    v_cvt_pk_bf16_f32 v6, v76, v77
    v_cvt_pk_bf16_f32 v7, v78, v79
    s_waitcnt lgkmcnt(10)
    v_mfma_f32_32x32x16_bf16 v[112:127], v[208:211], v[52:55], v[112:127]
    ds_read_b64_tr_b16 v[44:45], v11 offset:51456
    ds_read_b64_tr_b16 v[46:47], v11 offset:51968
    v_cvt_pk_bf16_f32 v8, v80, v81
    v_cvt_pk_bf16_f32 v9, v82, v83
    v_lshrrev_b32 v15, 3, v2
    s_waitcnt lgkmcnt(10)
    v_mfma_f32_32x32x16_bf16 v[96:111], v[212:215], v[56:59], v[96:111]
    ds_read_b64_tr_b16 v[48:49], v11 offset:57344
    ds_read_b64_tr_b16 v[50:51], v11 offset:57856
    v_lshlrev_b32 v15, 9, v15
    v_and_b32 v5, 7, v2
    v_lshl_add_u32 v15, v5, 4, v15
    s_lshr_b32 s70, s44, 5
    s_waitcnt lgkmcnt(10)
    v_mfma_f32_32x32x16_bf16 v[112:127], v[212:215], v[60:63], v[112:127]
    ds_read_b64_tr_b16 v[52:53], v11 offset:57600
    ds_read_b64_tr_b16 v[54:55], v11 offset:58112
    s_lshl_b32 s70, s70, 15
    s_and_b32 s71, s44, 24
    s_lshl_b32 s71, s71, 4
    s_waitcnt lgkmcnt(10)
    v_mfma_f32_32x32x16_bf16 v[96:111], v[224:227], v[32:35], v[96:111]
    ds_read_b64_tr_b16 v[56:57], v11 offset:59392
    ds_read_b64_tr_b16 v[58:59], v11 offset:59904
    s_add_u32 s70, s70, s71
    s_add_u32 s70, s70, s27
    s_lshl_b32 s71, s24, 4
    s_add_u32 s71, s71, 0x20000
    s_waitcnt lgkmcnt(10)
    v_mfma_f32_32x32x16_bf16 v[112:127], v[224:227], v[36:39], v[112:127]
    ds_read_b64_tr_b16 v[60:61], v11 offset:59648
    ds_read_b64_tr_b16 v[62:63], v11 offset:60160
    v_lshl_add_u32 v5, v2, 7, s71
    s_add_u32 s71, s67, 0x20000
    v_add_u32 v14, s71, v3
    s_waitcnt lgkmcnt(10)
    v_mfma_f32_32x32x16_bf16 v[96:111], v[228:231], v[40:43], v[96:111]
    ds_write_b128 v5, v[6:9]
    s_waitcnt lgkmcnt(9)
    v_mfma_f32_32x32x16_bf16 v[112:127], v[228:231], v[44:47], v[112:127]
    s_waitcnt vmcnt(5) lgkmcnt(0)
    s_barrier
    ds_read_b64_tr_b16 v[32:33], v10 offset:0
    ds_read_b64_tr_b16 v[34:35], v10 offset:512
    ds_read_b64_tr_b16 v[36:37], v10 offset:256
    ds_read_b64_tr_b16 v[38:39], v10 offset:768
    ds_read_b64_tr_b16 v[40:41], v10 offset:2048
    ds_read_b64_tr_b16 v[42:43], v10 offset:2560
    ds_read_b64_tr_b16 v[44:45], v10 offset:2304
    ds_read_b64_tr_b16 v[46:47], v10 offset:2816
    v_mfma_f32_32x32x16_bf16 v[96:111], v[240:243], v[48:51], v[96:111]
    v_mfma_f32_32x32x16_bf16 v[112:127], v[240:243], v[52:55], v[112:127]
    v_mfma_f32_32x32x16_bf16 v[96:111], v[244:247], v[56:59], v[96:111]
    ds_read_b64_tr_b16 v[48:49], v10 offset:4096
    ds_read_b64_tr_b16 v[50:51], v10 offset:4608
    v_mfma_f32_32x32x16_bf16 v[112:127], v[244:247], v[60:63], v[112:127]
    ds_read_b64_tr_b16 v[52:53], v10 offset:4352
    ds_read_b64_tr_b16 v[54:55], v10 offset:4864
    s_waitcnt lgkmcnt(10)
    v_mfma_f32_32x32x16_bf16 v[64:79], v[128:131], v[32:35], 0
    ds_read_b64_tr_b16 v[56:57], v10 offset:6144
    ds_read_b64_tr_b16 v[58:59], v10 offset:6656
    ds_read_b128 v[6:9], v14
    s_waitcnt lgkmcnt(11)
    v_mfma_f32_32x32x16_bf16 v[80:95], v[128:131], v[36:39], 0
    ds_read_b64_tr_b16 v[60:61], v10 offset:6400
    ds_read_b64_tr_b16 v[62:63], v10 offset:6912
    s_add_u32 m0, s26, 0x10000
    s_add_u32 s28, s25, 0x180
    buffer_load_dwordx4 v4, s[4:7], s28 offen lds
    s_waitcnt lgkmcnt(11)
    v_mfma_f32_32x32x16_bf16 v[64:79], v[132:135], v[40:43], v[64:79]
    ds_read_b64_tr_b16 v[32:33], v10 offset:8192
    ds_read_b64_tr_b16 v[34:35], v10 offset:8704
    s_add_u32 m0, s26, 0x10400
    s_add_u32 s28, s25, 0x10180
    buffer_load_dwordx4 v4, s[4:7], s28 offen lds
    s_waitcnt lgkmcnt(11)
    v_mfma_f32_32x32x16_bf16 v[80:95], v[132:135], v[44:47], v[80:95]
    ds_read_b64_tr_b16 v[36:37], v10 offset:8448
    ds_read_b64_tr_b16 v[38:39], v10 offset:8960
    s_add_u32 m0, s26, 0x10800
    s_add_u32 s28, s25, 0x20180
    buffer_load_dwordx4 v4, s[4:7], s28 offen lds
    s_waitcnt lgkmcnt(11)
    v_mfma_f32_32x32x16_bf16 v[64:79], v[136:139], v[48:51], v[64:79]
    ds_read_b64_tr_b16 v[40:41], v10 offset:10240
    ds_read_b64_tr_b16 v[42:43], v10 offset:10752
    s_add_u32 m0, s26, 0x10c00
    s_add_u32 s28, s25, 0x30180
    buffer_load_dwordx4 v4, s[4:7], s28 offen lds
    s_waitcnt lgkmcnt(11)
    v_mfma_f32_32x32x16_bf16 v[80:95], v[136:139], v[52:55], v[80:95]
    ds_read_b64_tr_b16 v[44:45], v10 offset:10496
    ds_read_b64_tr_b16 v[46:47], v10 offset:11008
    s_add_u32 m0, s26, 0x11000
    s_add_u32 s28, s25, 0x40180
    buffer_load_dwordx4 v4, s[4:7], s28 offen lds
    s_waitcnt lgkmcnt(10)
    buffer_store_dwordx4 v[6:9], v15, s[20:23], s70 offen sc1
    v_mfma_f32_32x32x16_bf16 v[64:79], v[140:143], v[56:59], v[64:79]
    ds_read_b64_tr_b16 v[48:49], v10 offset:12288
    ds_read_b64_tr_b16 v[50:51], v10 offset:12800
    s_add_u32 m0, s26, 0x11400
    s_add_u32 s28, s25, 0x50180
    buffer_load_dwordx4 v4, s[4:7], s28 offen lds
    s_waitcnt lgkmcnt(10)
    v_mfma_f32_32x32x16_bf16 v[80:95], v[140:143], v[60:63], v[80:95]
    ds_read_b64_tr_b16 v[52:53], v10 offset:12544
    ds_read_b64_tr_b16 v[54:55], v10 offset:13056
    s_add_u32 m0, s26, 0x11800
    s_add_u32 s28, s25, 0x60180
    buffer_load_dwordx4 v4, s[4:7], s28 offen lds
    s_waitcnt lgkmcnt(10)
    v_mfma_f32_32x32x16_bf16 v[64:79], v[144:147], v[32:35], v[64:79]
    ds_read_b64_tr_b16 v[56:57], v10 offset:14336
    ds_read_b64_tr_b16 v[58:59], v10 offset:14848
    s_add_u32 m0, s26, 0x11c00
    s_add_u32 s28, s25, 0x70180
    buffer_load_dwordx4 v4, s[4:7], s28 offen lds
    s_waitcnt lgkmcnt(10)
    v_mfma_f32_32x32x16_bf16 v[80:95], v[144:147], v[36:39], v[80:95]
    ds_read_b64_tr_b16 v[60:61], v10 offset:14592
    ds_read_b64_tr_b16 v[62:63], v10 offset:15104
    v_mov_b32 v14, 0
    s_cmp_lg_u32 s24, 0
    s_cselect_b32 s94, 0x4000, 0
    s_lshl_b32 s94, s94, 16
    v_add_u32 v14, s94, v14
    v_mov_b32 v15, 0
    buffer_load_dword v15, v14, s[88:91], 0 offen
    s_waitcnt lgkmcnt(10)
    v_mfma_f32_32x32x16_bf16 v[64:79], v[148:151], v[40:43], v[64:79]
    ds_read_b64_tr_b16 v[32:33], v10 offset:16384
    ds_read_b64_tr_b16 v[34:35], v10 offset:16896
    v_cvt_pk_bf16_f32 v16, v96, v97
    v_cvt_pk_bf16_f32 v17, v98, v99
    v_cvt_pk_bf16_f32 v18, v100, v101
    v_cvt_pk_bf16_f32 v19, v102, v103
    s_waitcnt lgkmcnt(10)
    v_mfma_f32_32x32x16_bf16 v[80:95], v[148:151], v[44:47], v[80:95]
    ds_read_b64_tr_b16 v[36:37], v10 offset:16640
    ds_read_b64_tr_b16 v[38:39], v10 offset:17152
    s_add_u32 s28, s30, 0x4800
    buffer_store_dwordx4 v[16:19], v3, s[12:15], s28 offen sc1
    s_waitcnt lgkmcnt(10)
    v_mfma_f32_32x32x16_bf16 v[64:79], v[152:155], v[48:51], v[64:79]
    ds_read_b64_tr_b16 v[40:41], v10 offset:18432
    ds_read_b64_tr_b16 v[42:43], v10 offset:18944
    s_waitcnt lgkmcnt(10)
    v_mfma_f32_32x32x16_bf16 v[80:95], v[152:155], v[52:55], v[80:95]
    ds_read_b64_tr_b16 v[44:45], v10 offset:18688
    ds_read_b64_tr_b16 v[46:47], v10 offset:19200
    v_cvt_pk_bf16_f32 v20, v104, v105
    v_cvt_pk_bf16_f32 v21, v106, v107
    v_cvt_pk_bf16_f32 v22, v108, v109
    v_cvt_pk_bf16_f32 v23, v110, v111
    s_waitcnt lgkmcnt(10)
    v_mfma_f32_32x32x16_bf16 v[64:79], v[156:159], v[56:59], v[64:79]
    ds_read_b64_tr_b16 v[48:49], v10 offset:20480
    ds_read_b64_tr_b16 v[50:51], v10 offset:20992
    s_add_u32 s28, s30, 0x5800
    buffer_store_dwordx4 v[20:23], v3, s[12:15], s28 offen sc1
    s_waitcnt lgkmcnt(10)
    v_mfma_f32_32x32x16_bf16 v[80:95], v[156:159], v[60:63], v[80:95]
    ds_read_b64_tr_b16 v[52:53], v10 offset:20736
    ds_read_b64_tr_b16 v[54:55], v10 offset:21248
    s_waitcnt lgkmcnt(10)
    v_mfma_f32_32x32x16_bf16 v[64:79], v[160:163], v[32:35], v[64:79]
    ds_read_b64_tr_b16 v[56:57], v10 offset:22528
    ds_read_b64_tr_b16 v[58:59], v10 offset:23040
    v_cvt_pk_bf16_f32 v24, v112, v113
    v_cvt_pk_bf16_f32 v25, v114, v115
    v_cvt_pk_bf16_f32 v26, v116, v117
    v_cvt_pk_bf16_f32 v27, v118, v119
    s_waitcnt lgkmcnt(10)
    v_mfma_f32_32x32x16_bf16 v[80:95], v[160:163], v[36:39], v[80:95]
    ds_read_b64_tr_b16 v[60:61], v10 offset:22784
    ds_read_b64_tr_b16 v[62:63], v10 offset:23296
    s_add_u32 s28, s30, 0x4c00
    buffer_store_dwordx4 v[24:27], v3, s[12:15], s28 offen sc1
    s_waitcnt lgkmcnt(10)
    v_mfma_f32_32x32x16_bf16 v[64:79], v[164:167], v[40:43], v[64:79]
    ds_read_b64_tr_b16 v[32:33], v10 offset:24576
    ds_read_b64_tr_b16 v[34:35], v10 offset:25088
    s_waitcnt lgkmcnt(10)
    v_mfma_f32_32x32x16_bf16 v[80:95], v[164:167], v[44:47], v[80:95]
    ds_read_b64_tr_b16 v[36:37], v10 offset:24832
    ds_read_b64_tr_b16 v[38:39], v10 offset:25344
    v_cvt_pk_bf16_f32 v28, v120, v121
    v_cvt_pk_bf16_f32 v29, v122, v123
    v_cvt_pk_bf16_f32 v30, v124, v125
    v_cvt_pk_bf16_f32 v31, v126, v127
    s_waitcnt lgkmcnt(10)
    v_mfma_f32_32x32x16_bf16 v[64:79], v[168:171], v[48:51], v[64:79]
    ds_read_b64_tr_b16 v[40:41], v10 offset:26624
    ds_read_b64_tr_b16 v[42:43], v10 offset:27136
    s_add_u32 s28, s30, 0x5c00
    buffer_store_dwordx4 v[28:31], v3, s[12:15], s28 offen sc1
    s_waitcnt lgkmcnt(10)
    v_mfma_f32_32x32x16_bf16 v[80:95], v[168:171], v[52:55], v[80:95]
    ds_read_b64_tr_b16 v[44:45], v10 offset:26880
    ds_read_b64_tr_b16 v[46:47], v10 offset:27392
    s_waitcnt lgkmcnt(10)
    v_mfma_f32_32x32x16_bf16 v[64:79], v[172:175], v[56:59], v[64:79]
    ds_read_b64_tr_b16 v[48:49], v10 offset:28672
    ds_read_b64_tr_b16 v[50:51], v10 offset:29184
    s_waitcnt lgkmcnt(10)
    v_mfma_f32_32x32x16_bf16 v[80:95], v[172:175], v[60:63], v[80:95]
    ds_read_b64_tr_b16 v[52:53], v10 offset:28928
    ds_read_b64_tr_b16 v[54:55], v10 offset:29440
    s_waitcnt lgkmcnt(10)
    v_mfma_f32_32x32x16_bf16 v[64:79], v[176:179], v[32:35], v[64:79]
    ds_read_b64_tr_b16 v[56:57], v10 offset:30720
    ds_read_b64_tr_b16 v[58:59], v10 offset:31232
    s_waitcnt lgkmcnt(10)
    v_mfma_f32_32x32x16_bf16 v[80:95], v[176:179], v[36:39], v[80:95]
    ds_read_b64_tr_b16 v[60:61], v10 offset:30976
    ds_read_b64_tr_b16 v[62:63], v10 offset:31488
    s_waitcnt lgkmcnt(10)
    v_mfma_f32_32x32x16_bf16 v[64:79], v[180:183], v[40:43], v[64:79]
    ds_read_b64_tr_b16 v[32:33], v10 offset:32768
    ds_read_b64_tr_b16 v[34:35], v10 offset:33280
    s_waitcnt lgkmcnt(10)
    v_mfma_f32_32x32x16_bf16 v[80:95], v[180:183], v[44:47], v[80:95]
    ds_read_b64_tr_b16 v[36:37], v10 offset:33024
    ds_read_b64_tr_b16 v[38:39], v10 offset:33536
    s_waitcnt lgkmcnt(10)
    v_mfma_f32_32x32x16_bf16 v[64:79], v[184:187], v[48:51], v[64:79]
    ds_read_b64_tr_b16 v[40:41], v10 offset:34816
    ds_read_b64_tr_b16 v[42:43], v10 offset:35328
    s_waitcnt lgkmcnt(10)
    v_mfma_f32_32x32x16_bf16 v[80:95], v[184:187], v[52:55], v[80:95]
    ds_read_b64_tr_b16 v[44:45], v10 offset:35072
    ds_read_b64_tr_b16 v[46:47], v10 offset:35584
    s_waitcnt lgkmcnt(10)
    v_mfma_f32_32x32x16_bf16 v[64:79], v[188:191], v[56:59], v[64:79]
    ds_read_b64_tr_b16 v[48:49], v10 offset:36864
    ds_read_b64_tr_b16 v[50:51], v10 offset:37376
    buffer_load_dword v1, v13, s[76:79], s64 offen
    s_waitcnt lgkmcnt(10)
    v_mfma_f32_32x32x16_bf16 v[80:95], v[188:191], v[60:63], v[80:95]
    ds_read_b64_tr_b16 v[52:53], v10 offset:37120
    ds_read_b64_tr_b16 v[54:55], v10 offset:37632
    s_waitcnt lgkmcnt(10)
    v_mfma_f32_32x32x16_bf16 v[64:79], v[192:195], v[32:35], v[64:79]
    ds_read_b64_tr_b16 v[56:57], v10 offset:38912
    ds_read_b64_tr_b16 v[58:59], v10 offset:39424
    s_waitcnt lgkmcnt(10)
    v_mfma_f32_32x32x16_bf16 v[80:95], v[192:195], v[36:39], v[80:95]
    ds_read_b64_tr_b16 v[60:61], v10 offset:39168
    ds_read_b64_tr_b16 v[62:63], v10 offset:39680
    s_waitcnt lgkmcnt(10)
    v_mfma_f32_32x32x16_bf16 v[64:79], v[196:199], v[40:43], v[64:79]
    ds_read_b64_tr_b16 v[32:33], v10 offset:40960
    ds_read_b64_tr_b16 v[34:35], v10 offset:41472
    s_waitcnt lgkmcnt(10)
    v_mfma_f32_32x32x16_bf16 v[80:95], v[196:199], v[44:47], v[80:95]
    ds_read_b64_tr_b16 v[36:37], v10 offset:41216
    ds_read_b64_tr_b16 v[38:39], v10 offset:41728
    s_waitcnt lgkmcnt(10)
    v_mfma_f32_32x32x16_bf16 v[64:79], v[200:203], v[48:51], v[64:79]
    ds_read_b64_tr_b16 v[40:41], v10 offset:43008
    ds_read_b64_tr_b16 v[42:43], v10 offset:43520
    s_waitcnt lgkmcnt(10)
    v_mfma_f32_32x32x16_bf16 v[80:95], v[200:203], v[52:55], v[80:95]
    ds_read_b64_tr_b16 v[44:45], v10 offset:43264
    ds_read_b64_tr_b16 v[46:47], v10 offset:43776
    s_waitcnt lgkmcnt(10)
    v_mfma_f32_32x32x16_bf16 v[64:79], v[204:207], v[56:59], v[64:79]
    ds_read_b64_tr_b16 v[48:49], v10 offset:45056
    ds_read_b64_tr_b16 v[50:51], v10 offset:45568
    s_waitcnt lgkmcnt(10)
    v_mfma_f32_32x32x16_bf16 v[80:95], v[204:207], v[60:63], v[80:95]
    ds_read_b64_tr_b16 v[52:53], v10 offset:45312
    ds_read_b64_tr_b16 v[54:55], v10 offset:45824
    s_waitcnt lgkmcnt(10)
    v_mfma_f32_32x32x16_bf16 v[64:79], v[208:211], v[32:35], v[64:79]
    ds_read_b64_tr_b16 v[56:57], v10 offset:47104
    ds_read_b64_tr_b16 v[58:59], v10 offset:47616
    s_waitcnt lgkmcnt(10)
    v_mfma_f32_32x32x16_bf16 v[80:95], v[208:211], v[36:39], v[80:95]
    ds_read_b64_tr_b16 v[60:61], v10 offset:47360
    ds_read_b64_tr_b16 v[62:63], v10 offset:47872
    s_waitcnt lgkmcnt(10)
    v_mfma_f32_32x32x16_bf16 v[64:79], v[212:215], v[40:43], v[64:79]
    ds_read_b64_tr_b16 v[32:33], v10 offset:49152
    ds_read_b64_tr_b16 v[34:35], v10 offset:49664
    s_waitcnt lgkmcnt(10)
    v_mfma_f32_32x32x16_bf16 v[80:95], v[212:215], v[44:47], v[80:95]
    ds_read_b64_tr_b16 v[36:37], v10 offset:49408
    ds_read_b64_tr_b16 v[38:39], v10 offset:49920
    s_waitcnt lgkmcnt(10)
    v_mfma_f32_32x32x16_bf16 v[64:79], v[216:219], v[48:51], v[64:79]
    ds_read_b64_tr_b16 v[40:41], v10 offset:51200
    ds_read_b64_tr_b16 v[42:43], v10 offset:51712
    s_waitcnt lgkmcnt(10)
    v_mfma_f32_32x32x16_bf16 v[80:95], v[216:219], v[52:55], v[80:95]
    ds_read_b64_tr_b16 v[44:45], v10 offset:51456
    ds_read_b64_tr_b16 v[46:47], v10 offset:51968
    s_waitcnt lgkmcnt(10)
    v_mfma_f32_32x32x16_bf16 v[64:79], v[220:223], v[56:59], v[64:79]
    ds_read_b64_tr_b16 v[48:49], v10 offset:53248
    ds_read_b64_tr_b16 v[50:51], v10 offset:53760
    s_waitcnt lgkmcnt(10)
    v_mfma_f32_32x32x16_bf16 v[80:95], v[220:223], v[60:63], v[80:95]
    ds_read_b64_tr_b16 v[52:53], v10 offset:53504
    ds_read_b64_tr_b16 v[54:55], v10 offset:54016
    s_waitcnt lgkmcnt(10)
    v_mfma_f32_32x32x16_bf16 v[64:79], v[224:227], v[32:35], v[64:79]
    ds_read_b64_tr_b16 v[56:57], v10 offset:55296
    ds_read_b64_tr_b16 v[58:59], v10 offset:55808
    s_waitcnt lgkmcnt(10)
    v_mfma_f32_32x32x16_bf16 v[80:95], v[224:227], v[36:39], v[80:95]
    ds_read_b64_tr_b16 v[60:61], v10 offset:55552
    ds_read_b64_tr_b16 v[62:63], v10 offset:56064
    s_waitcnt lgkmcnt(10)
    v_mfma_f32_32x32x16_bf16 v[64:79], v[228:231], v[40:43], v[64:79]
    ds_read_b64_tr_b16 v[32:33], v10 offset:57344
    ds_read_b64_tr_b16 v[34:35], v10 offset:57856
    s_waitcnt lgkmcnt(10)
    v_mfma_f32_32x32x16_bf16 v[80:95], v[228:231], v[44:47], v[80:95]
    ds_read_b64_tr_b16 v[36:37], v10 offset:57600
    ds_read_b64_tr_b16 v[38:39], v10 offset:58112
    s_waitcnt lgkmcnt(10)
    v_mfma_f32_32x32x16_bf16 v[64:79], v[232:235], v[48:51], v[64:79]
    ds_read_b64_tr_b16 v[40:41], v10 offset:59392
    ds_read_b64_tr_b16 v[42:43], v10 offset:59904
    s_waitcnt lgkmcnt(10)
    v_mfma_f32_32x32x16_bf16 v[80:95], v[232:235], v[52:55], v[80:95]
    ds_read_b64_tr_b16 v[44:45], v10 offset:59648
    ds_read_b64_tr_b16 v[46:47], v10 offset:60160
    s_waitcnt lgkmcnt(10)
    v_mfma_f32_32x32x16_bf16 v[64:79], v[236:239], v[56:59], v[64:79]
    ds_read_b64_tr_b16 v[48:49], v10 offset:61440
    ds_read_b64_tr_b16 v[50:51], v10 offset:61952
    s_waitcnt lgkmcnt(10)
    v_mfma_f32_32x32x16_bf16 v[80:95], v[236:239], v[60:63], v[80:95]
    ds_read_b64_tr_b16 v[52:53], v10 offset:61696
    ds_read_b64_tr_b16 v[54:55], v10 offset:62208
    s_waitcnt lgkmcnt(10)
    v_mfma_f32_32x32x16_bf16 v[64:79], v[240:243], v[32:35], v[64:79]
    ds_read_b64_tr_b16 v[56:57], v10 offset:63488
    ds_read_b64_tr_b16 v[58:59], v10 offset:64000
    s_waitcnt lgkmcnt(10)
    v_mfma_f32_32x32x16_bf16 v[80:95], v[240:243], v[36:39], v[80:95]
    ds_read_b64_tr_b16 v[60:61], v10 offset:63744
    ds_read_b64_tr_b16 v[62:63], v10 offset:64256
    s_waitcnt lgkmcnt(10)
    v_mfma_f32_32x32x16_bf16 v[64:79], v[244:247], v[40:43], v[64:79]
    s_waitcnt lgkmcnt(8)
    v_mfma_f32_32x32x16_bf16 v[80:95], v[244:247], v[44:47], v[80:95]
    s_waitcnt vmcnt(6) lgkmcnt(0)
    s_waitcnt vmcnt(4)
    s_barrier
    ds_read_b64_tr_b16 v[32:33], v11 offset:0
    ds_read_b64_tr_b16 v[34:35], v11 offset:512
    ds_read_b64_tr_b16 v[36:37], v11 offset:256
    ds_read_b64_tr_b16 v[38:39], v11 offset:768
    ds_read_b64_tr_b16 v[40:41], v11 offset:2048
    ds_read_b64_tr_b16 v[42:43], v11 offset:2560
    ds_read_b64_tr_b16 v[44:45], v11 offset:2304
    ds_read_b64_tr_b16 v[46:47], v11 offset:2816
    v_mfma_f32_32x32x16_bf16 v[64:79], v[248:251], v[48:51], v[64:79]
    s_waitcnt vmcnt(5)
    s_cmp_lg_u32 s24, 0
    s_cbranch_scc1 .Lkvproj_kernel_chk_13
    v_cmp_ne_u32 vcc, 1, v15
    s_cbranch_vccz .Lkvproj_kernel_cok_14
    s_mov_b32 s48, 0x40000
.Lkvproj_kernel_poll_15:
    buffer_load_dword v15, v14, s[88:91], 0 offen sc1
    s_waitcnt vmcnt(0)
    v_cmp_ne_u32 vcc, 1, v15
    s_cbranch_vccz .Lkvproj_kernel_pdone_16
    s_sub_u32 s48, s48, 1
    s_sleep 2
    s_cmp_lg_u32 s48, 0
    s_cbranch_scc1 .Lkvproj_kernel_poll_15
.Lkvproj_kernel_pdone_16:
.Lkvproj_kernel_cok_14:
    s_waitcnt vmcnt(63)
    s_lshl_b32 s48, s2, 8
    s_add_u32 s48, s48, 0x0
    v_mov_b32 v5, s48
    v_mov_b32 v6, 1
    s_mov_b64 exec, 1
    buffer_store_dword v6, v5, s[84:87], 0 offen sc1
    s_mov_b64 exec, -1
.Lkvproj_kernel_chk_13:
    v_mfma_f32_32x32x16_bf16 v[80:95], v[248:251], v[52:55], v[80:95]
    v_mfma_f32_32x32x16_bf16 v[64:79], v[252:255], v[56:59], v[64:79]
    ds_read_b64_tr_b16 v[48:49], v11 offset:4096
    ds_read_b64_tr_b16 v[50:51], v11 offset:4608
    v_mfma_f32_32x32x16_bf16 v[80:95], v[252:255], v[60:63], v[80:95]
    ds_read_b64_tr_b16 v[52:53], v11 offset:4352
    ds_read_b64_tr_b16 v[54:55], v11 offset:4864
    s_waitcnt lgkmcnt(10)
    v_mfma_f32_32x32x16_bf16 v[96:111], v[128:131], v[32:35], 0
    ds_read_b64_tr_b16 v[56:57], v11 offset:6144
    ds_read_b64_tr_b16 v[58:59], v11 offset:6656
    s_waitcnt lgkmcnt(10)
    v_mfma_f32_32x32x16_bf16 v[112:127], v[128:131], v[36:39], 0
    ds_read_b64_tr_b16 v[60:61], v11 offset:6400
    ds_read_b64_tr_b16 v[62:63], v11 offset:6912
    s_waitcnt lgkmcnt(10)
    v_mfma_f32_32x32x16_bf16 v[96:111], v[132:135], v[40:43], v[96:111]
    ds_read_b64_tr_b16 v[32:33], v11 offset:8192
    ds_read_b64_tr_b16 v[34:35], v11 offset:8704
    v_lshrrev_b32 v5, 1, v2
    v_and_b32 v13, 1, v2
    v_lshlrev_b32 v13, 7, v13
    v_lshl_add_u32 v13, v5, 13, v13
    v_mov_b32 v5, 0x40000000
    v_cmp_gt_u32 vcc, 16, v2
    s_nop 1
    v_cndmask_b32 v13, v5, v13, vcc
    buffer_load_dword v1, v13, s[60:63], s80 offen
    s_waitcnt lgkmcnt(10)
    v_mfma_f32_32x32x16_bf16 v[112:127], v[132:135], v[44:47], v[112:127]
    ds_read_b64_tr_b16 v[36:37], v11 offset:8448
    ds_read_b64_tr_b16 v[38:39], v11 offset:8960
    s_waitcnt lgkmcnt(10)
    v_mfma_f32_32x32x16_bf16 v[96:111], v[136:139], v[48:51], v[96:111]
    ds_read_b64_tr_b16 v[40:41], v11 offset:10240
    ds_read_b64_tr_b16 v[42:43], v11 offset:10752
    s_waitcnt lgkmcnt(10)
    v_mfma_f32_32x32x16_bf16 v[112:127], v[136:139], v[52:55], v[112:127]
    ds_read_b64_tr_b16 v[44:45], v11 offset:10496
    ds_read_b64_tr_b16 v[46:47], v11 offset:11008
    s_waitcnt lgkmcnt(10)
    v_mfma_f32_32x32x16_bf16 v[96:111], v[140:143], v[56:59], v[96:111]
    ds_read_b64_tr_b16 v[48:49], v11 offset:12288
    ds_read_b64_tr_b16 v[50:51], v11 offset:12800
    s_waitcnt lgkmcnt(10)
    v_mfma_f32_32x32x16_bf16 v[112:127], v[140:143], v[60:63], v[112:127]
    ds_read_b64_tr_b16 v[52:53], v11 offset:12544
    ds_read_b64_tr_b16 v[54:55], v11 offset:13056
    s_waitcnt lgkmcnt(10)
    v_mfma_f32_32x32x16_bf16 v[96:111], v[144:147], v[32:35], v[96:111]
    ds_read_b64_tr_b16 v[56:57], v11 offset:14336
    ds_read_b64_tr_b16 v[58:59], v11 offset:14848
    s_waitcnt lgkmcnt(10)
    v_mfma_f32_32x32x16_bf16 v[112:127], v[144:147], v[36:39], v[112:127]
    ds_read_b64_tr_b16 v[60:61], v11 offset:14592
    ds_read_b64_tr_b16 v[62:63], v11 offset:15104
    s_waitcnt lgkmcnt(10)
    v_mfma_f32_32x32x16_bf16 v[96:111], v[148:151], v[40:43], v[96:111]
    ds_read_b64_tr_b16 v[32:33], v11 offset:16384
    ds_read_b64_tr_b16 v[34:35], v11 offset:16896
    v_cvt_pk_bf16_f32 v16, v64, v65
    v_cvt_pk_bf16_f32 v17, v66, v67
    v_cvt_pk_bf16_f32 v18, v68, v69
    v_cvt_pk_bf16_f32 v19, v70, v71
    s_waitcnt lgkmcnt(10)
    v_mfma_f32_32x32x16_bf16 v[112:127], v[148:151], v[44:47], v[112:127]
    ds_read_b64_tr_b16 v[36:37], v11 offset:16640
    ds_read_b64_tr_b16 v[38:39], v11 offset:17152
    s_add_u32 s28, s30, 0x104000
    buffer_store_dwordx4 v[16:19], v3, s[12:15], s28 offen sc1
    s_waitcnt lgkmcnt(10)
    v_mfma_f32_32x32x16_bf16 v[96:111], v[152:155], v[48:51], v[96:111]
    ds_read_b64_tr_b16 v[40:41], v11 offset:18432
    ds_read_b64_tr_b16 v[42:43], v11 offset:18944
    s_waitcnt lgkmcnt(10)
    v_mfma_f32_32x32x16_bf16 v[112:127], v[152:155], v[52:55], v[112:127]
    ds_read_b64_tr_b16 v[44:45], v11 offset:18688
    ds_read_b64_tr_b16 v[46:47], v11 offset:19200
    v_cvt_pk_bf16_f32 v20, v72, v73
    v_cvt_pk_bf16_f32 v21, v74, v75
    v_cvt_pk_bf16_f32 v22, v76, v77
    v_cvt_pk_bf16_f32 v23, v78, v79
    s_waitcnt lgkmcnt(10)
    v_mfma_f32_32x32x16_bf16 v[96:111], v[156:159], v[56:59], v[96:111]
    ds_read_b64_tr_b16 v[48:49], v11 offset:20480
    ds_read_b64_tr_b16 v[50:51], v11 offset:20992
    s_add_u32 s28, s30, 0x105000
    buffer_store_dwordx4 v[20:23], v3, s[12:15], s28 offen sc1
    s_waitcnt lgkmcnt(10)
    v_mfma_f32_32x32x16_bf16 v[112:127], v[156:159], v[60:63], v[112:127]
    ds_read_b64_tr_b16 v[52:53], v11 offset:20736
    ds_read_b64_tr_b16 v[54:55], v11 offset:21248
    s_waitcnt lgkmcnt(10)
    v_mfma_f32_32x32x16_bf16 v[96:111], v[160:163], v[32:35], v[96:111]
    ds_read_b64_tr_b16 v[56:57], v11 offset:22528
    ds_read_b64_tr_b16 v[58:59], v11 offset:23040
    v_cvt_pk_bf16_f32 v24, v80, v81
    v_cvt_pk_bf16_f32 v25, v82, v83
    v_cvt_pk_bf16_f32 v26, v84, v85
    v_cvt_pk_bf16_f32 v27, v86, v87
    s_waitcnt lgkmcnt(10)
    v_mfma_f32_32x32x16_bf16 v[112:127], v[160:163], v[36:39], v[112:127]
    ds_read_b64_tr_b16 v[60:61], v11 offset:22784
    ds_read_b64_tr_b16 v[62:63], v11 offset:23296
    s_add_u32 s28, s30, 0x104400
    buffer_store_dwordx4 v[24:27], v3, s[12:15], s28 offen sc1
    s_waitcnt lgkmcnt(10)
    v_mfma_f32_32x32x16_bf16 v[96:111], v[164:167], v[40:43], v[96:111]
    ds_read_b64_tr_b16 v[32:33], v11 offset:24576
    ds_read_b64_tr_b16 v[34:35], v11 offset:25088
    s_waitcnt lgkmcnt(10)
    v_mfma_f32_32x32x16_bf16 v[112:127], v[164:167], v[44:47], v[112:127]
    ds_read_b64_tr_b16 v[36:37], v11 offset:24832
    ds_read_b64_tr_b16 v[38:39], v11 offset:25344
    v_cvt_pk_bf16_f32 v28, v88, v89
    v_cvt_pk_bf16_f32 v29, v90, v91
    v_cvt_pk_bf16_f32 v30, v92, v93
    v_cvt_pk_bf16_f32 v31, v94, v95
    s_waitcnt lgkmcnt(10)
    v_mfma_f32_32x32x16_bf16 v[96:111], v[168:171], v[48:51], v[96:111]
    ds_read_b64_tr_b16 v[40:41], v11 offset:26624
    ds_read_b64_tr_b16 v[42:43], v11 offset:27136
    s_add_u32 s28, s30, 0x105400
    buffer_store_dwordx4 v[28:31], v3, s[12:15], s28 offen sc1
    s_waitcnt lgkmcnt(10)
    v_mfma_f32_32x32x16_bf16 v[112:127], v[168:171], v[52:55], v[112:127]
    ds_read_b64_tr_b16 v[44:45], v11 offset:26880
    ds_read_b64_tr_b16 v[46:47], v11 offset:27392
    s_waitcnt lgkmcnt(10)
    v_mfma_f32_32x32x16_bf16 v[96:111], v[172:175], v[56:59], v[96:111]
    ds_read_b64_tr_b16 v[48:49], v11 offset:28672
    ds_read_b64_tr_b16 v[50:51], v11 offset:29184
    s_waitcnt lgkmcnt(10)
    v_mfma_f32_32x32x16_bf16 v[112:127], v[172:175], v[60:63], v[112:127]
    ds_read_b64_tr_b16 v[52:53], v11 offset:28928
    ds_read_b64_tr_b16 v[54:55], v11 offset:29440
    s_waitcnt lgkmcnt(10)
    v_mfma_f32_32x32x16_bf16 v[96:111], v[176:179], v[32:35], v[96:111]
    ds_read_b64_tr_b16 v[56:57], v11 offset:30720
    ds_read_b64_tr_b16 v[58:59], v11 offset:31232
    s_waitcnt lgkmcnt(10)
    v_mfma_f32_32x32x16_bf16 v[112:127], v[176:179], v[36:39], v[112:127]
    ds_read_b64_tr_b16 v[60:61], v11 offset:30976
    ds_read_b64_tr_b16 v[62:63], v11 offset:31488
    s_waitcnt lgkmcnt(10)
    v_mfma_f32_32x32x16_bf16 v[96:111], v[180:183], v[40:43], v[96:111]
    ds_read_b64_tr_b16 v[32:33], v11 offset:32768
    ds_read_b64_tr_b16 v[34:35], v11 offset:33280
    s_waitcnt lgkmcnt(10)
    v_mfma_f32_32x32x16_bf16 v[112:127], v[180:183], v[44:47], v[112:127]
    ds_read_b64_tr_b16 v[36:37], v11 offset:33024
    ds_read_b64_tr_b16 v[38:39], v11 offset:33536
    s_waitcnt lgkmcnt(10)
    v_mfma_f32_32x32x16_bf16 v[96:111], v[184:187], v[48:51], v[96:111]
    ds_read_b64_tr_b16 v[40:41], v11 offset:34816
    ds_read_b64_tr_b16 v[42:43], v11 offset:35328
    s_waitcnt lgkmcnt(10)
    v_mfma_f32_32x32x16_bf16 v[112:127], v[184:187], v[52:55], v[112:127]
    ds_read_b64_tr_b16 v[44:45], v11 offset:35072
    ds_read_b64_tr_b16 v[46:47], v11 offset:35584
    s_waitcnt lgkmcnt(10)
    v_mfma_f32_32x32x16_bf16 v[96:111], v[188:191], v[56:59], v[96:111]
    ds_read_b64_tr_b16 v[48:49], v11 offset:36864
    ds_read_b64_tr_b16 v[50:51], v11 offset:37376
    s_waitcnt lgkmcnt(10)
    v_mfma_f32_32x32x16_bf16 v[112:127], v[188:191], v[60:63], v[112:127]
    ds_read_b64_tr_b16 v[52:53], v11 offset:37120
    ds_read_b64_tr_b16 v[54:55], v11 offset:37632
    s_waitcnt lgkmcnt(10)
    v_mfma_f32_32x32x16_bf16 v[96:111], v[192:195], v[32:35], v[96:111]
    ds_read_b64_tr_b16 v[56:57], v11 offset:38912
    ds_read_b64_tr_b16 v[58:59], v11 offset:39424
    s_waitcnt lgkmcnt(10)
    v_mfma_f32_32x32x16_bf16 v[112:127], v[192:195], v[36:39], v[112:127]
    ds_read_b64_tr_b16 v[60:61], v11 offset:39168
    ds_read_b64_tr_b16 v[62:63], v11 offset:39680
    s_waitcnt lgkmcnt(10)
    v_mfma_f32_32x32x16_bf16 v[96:111], v[196:199], v[40:43], v[96:111]
    ds_read_b64_tr_b16 v[32:33], v11 offset:40960
    ds_read_b64_tr_b16 v[34:35], v11 offset:41472
    s_waitcnt lgkmcnt(10)
    v_mfma_f32_32x32x16_bf16 v[112:127], v[196:199], v[44:47], v[112:127]
    ds_read_b64_tr_b16 v[36:37], v11 offset:41216
    ds_read_b64_tr_b16 v[38:39], v11 offset:41728
    s_waitcnt lgkmcnt(10)
    v_mfma_f32_32x32x16_bf16 v[96:111], v[200:203], v[48:51], v[96:111]
    ds_read_b64_tr_b16 v[40:41], v11 offset:43008
    ds_read_b64_tr_b16 v[42:43], v11 offset:43520
    s_waitcnt lgkmcnt(10)
    v_mfma_f32_32x32x16_bf16 v[112:127], v[200:203], v[52:55], v[112:127]
    ds_read_b64_tr_b16 v[44:45], v11 offset:43264
    ds_read_b64_tr_b16 v[46:47], v11 offset:43776
    s_waitcnt lgkmcnt(10)
    v_mfma_f32_32x32x16_bf16 v[96:111], v[204:207], v[56:59], v[96:111]
    ds_read_b64_tr_b16 v[48:49], v11 offset:45056
    ds_read_b64_tr_b16 v[50:51], v11 offset:45568
    s_waitcnt lgkmcnt(10)
    v_mfma_f32_32x32x16_bf16 v[112:127], v[204:207], v[60:63], v[112:127]
    ds_read_b64_tr_b16 v[52:53], v11 offset:45312
    ds_read_b64_tr_b16 v[54:55], v11 offset:45824
    s_waitcnt lgkmcnt(10)
    v_mfma_f32_32x32x16_bf16 v[96:111], v[208:211], v[32:35], v[96:111]
    ds_read_b64_tr_b16 v[56:57], v11 offset:47104
    ds_read_b64_tr_b16 v[58:59], v11 offset:47616
    s_waitcnt lgkmcnt(10)
    v_mfma_f32_32x32x16_bf16 v[112:127], v[208:211], v[36:39], v[112:127]
    ds_read_b64_tr_b16 v[60:61], v11 offset:47360
    ds_read_b64_tr_b16 v[62:63], v11 offset:47872
    s_waitcnt lgkmcnt(10)
    v_mfma_f32_32x32x16_bf16 v[96:111], v[212:215], v[40:43], v[96:111]
    ds_read_b64_tr_b16 v[32:33], v11 offset:49152
    ds_read_b64_tr_b16 v[34:35], v11 offset:49664
    s_waitcnt lgkmcnt(10)
    v_mfma_f32_32x32x16_bf16 v[112:127], v[212:215], v[44:47], v[112:127]
    ds_read_b64_tr_b16 v[36:37], v11 offset:49408
    ds_read_b64_tr_b16 v[38:39], v11 offset:49920
    s_waitcnt lgkmcnt(10)
    v_mfma_f32_32x32x16_bf16 v[96:111], v[216:219], v[48:51], v[96:111]
    ds_read_b64_tr_b16 v[40:41], v11 offset:51200
    ds_read_b64_tr_b16 v[42:43], v11 offset:51712
    v_and_b32 v14, 15, v2
    s_lshl_b32 s48, s42, 12
    v_lshl_add_u32 v14, v14, 8, s48
    v_xor_b32 v5, 0xf000, v14
    v_cmp_gt_u32 vcc, 32, v2
    s_nop 1
    v_cndmask_b32 v14, v5, v14, vcc
    s_cmp_lg_u32 s24, 0
    s_cselect_b32 s94, 0x4000, 0
    s_lshl_b32 s94, s94, 16
    v_add_u32 v14, s94, v14
    v_mov_b32 v15, 0
    buffer_load_dword v15, v14, s[84:87], 0 offen sc1
    s_waitcnt lgkmcnt(10)
    v_mfma_f32_32x32x16_bf16 v[112:127], v[216:219], v[52:55], v[112:127]
    ds_read_b64_tr_b16 v[44:45], v11 offset:51456
    ds_read_b64_tr_b16 v[46:47], v11 offset:51968
    s_waitcnt lgkmcnt(10)
    v_mfma_f32_32x32x16_bf16 v[96:111], v[220:223], v[56:59], v[96:111]
    ds_read_b64_tr_b16 v[48:49], v11 offset:53248
    ds_read_b64_tr_b16 v[50:51], v11 offset:53760
    s_waitcnt lgkmcnt(10)
    v_mfma_f32_32x32x16_bf16 v[112:127], v[220:223], v[60:63], v[112:127]
    ds_read_b64_tr_b16 v[52:53], v11 offset:53504
    ds_read_b64_tr_b16 v[54:55], v11 offset:54016
    s_waitcnt lgkmcnt(10)
    v_mfma_f32_32x32x16_bf16 v[96:111], v[224:227], v[32:35], v[96:111]
    ds_read_b64_tr_b16 v[56:57], v11 offset:55296
    ds_read_b64_tr_b16 v[58:59], v11 offset:55808
    s_waitcnt lgkmcnt(10)
    v_mfma_f32_32x32x16_bf16 v[112:127], v[224:227], v[36:39], v[112:127]
    ds_read_b64_tr_b16 v[60:61], v11 offset:55552
    ds_read_b64_tr_b16 v[62:63], v11 offset:56064
    s_waitcnt lgkmcnt(10)
    v_mfma_f32_32x32x16_bf16 v[96:111], v[228:231], v[40:43], v[96:111]
    ds_read_b64_tr_b16 v[32:33], v11 offset:57344
    ds_read_b64_tr_b16 v[34:35], v11 offset:57856
    s_waitcnt lgkmcnt(10)
    v_mfma_f32_32x32x16_bf16 v[112:127], v[228:231], v[44:47], v[112:127]
    ds_read_b64_tr_b16 v[36:37], v11 offset:57600
    ds_read_b64_tr_b16 v[38:39], v11 offset:58112
    s_waitcnt lgkmcnt(10)
    v_mfma_f32_32x32x16_bf16 v[96:111], v[232:235], v[48:51], v[96:111]
    ds_read_b64_tr_b16 v[40:41], v11 offset:59392
    ds_read_b64_tr_b16 v[42:43], v11 offset:59904
    s_waitcnt lgkmcnt(10)
    v_mfma_f32_32x32x16_bf16 v[112:127], v[232:235], v[52:55], v[112:127]
    ds_read_b64_tr_b16 v[44:45], v11 offset:59648
    ds_read_b64_tr_b16 v[46:47], v11 offset:60160
    s_waitcnt lgkmcnt(10)
    v_mfma_f32_32x32x16_bf16 v[96:111], v[236:239], v[56:59], v[96:111]
    ds_read_b64_tr_b16 v[48:49], v11 offset:61440
    ds_read_b64_tr_b16 v[50:51], v11 offset:61952
    s_waitcnt lgkmcnt(10)
    v_mfma_f32_32x32x16_bf16 v[112:127], v[236:239], v[60:63], v[112:127]
    ds_read_b64_tr_b16 v[52:53], v11 offset:61696
    ds_read_b64_tr_b16 v[54:55], v11 offset:62208
    s_waitcnt lgkmcnt(10)
    v_mfma_f32_32x32x16_bf16 v[96:111], v[240:243], v[32:35], v[96:111]
    ds_read_b64_tr_b16 v[56:57], v11 offset:63488
    ds_read_b64_tr_b16 v[58:59], v11 offset:64000
    s_waitcnt lgkmcnt(10)
    v_mfma_f32_32x32x16_bf16 v[112:127], v[240:243], v[36:39], v[112:127]
    ds_read_b64_tr_b16 v[60:61], v11 offset:63744
    ds_read_b64_tr_b16 v[62:63], v11 offset:64256
    s_waitcnt lgkmcnt(10)
    v_mfma_f32_32x32x16_bf16 v[96:111], v[244:247], v[40:43], v[96:111]
    s_waitcnt lgkmcnt(8)
    v_mfma_f32_32x32x16_bf16 v[112:127], v[244:247], v[44:47], v[112:127]
    s_waitcnt lgkmcnt(6)
    v_mfma_f32_32x32x16_bf16 v[96:111], v[248:251], v[48:51], v[96:111]
    s_waitcnt lgkmcnt(4)
    v_mfma_f32_32x32x16_bf16 v[112:127], v[248:251], v[52:55], v[112:127]
    s_waitcnt lgkmcnt(2)
    v_mfma_f32_32x32x16_bf16 v[96:111], v[252:255], v[56:59], v[96:111]
    s_waitcnt lgkmcnt(0)
    v_mfma_f32_32x32x16_bf16 v[112:127], v[252:255], v[60:63], v[112:127]
    s_nop 7
    s_nop 1
    v_cvt_pk_bf16_f32 v16, v96, v97
    v_cvt_pk_bf16_f32 v17, v98, v99
    v_cvt_pk_bf16_f32 v18, v100, v101
    v_cvt_pk_bf16_f32 v19, v102, v103
    s_add_u32 s28, s30, 0x104800
    buffer_store_dwordx4 v[16:19], v3, s[12:15], s28 offen sc1
    v_cvt_pk_bf16_f32 v20, v104, v105
    v_cvt_pk_bf16_f32 v21, v106, v107
    v_cvt_pk_bf16_f32 v22, v108, v109
    v_cvt_pk_bf16_f32 v23, v110, v111
    s_add_u32 s28, s30, 0x105800
    buffer_store_dwordx4 v[20:23], v3, s[12:15], s28 offen sc1
    v_cvt_pk_bf16_f32 v24, v112, v113
    v_cvt_pk_bf16_f32 v25, v114, v115
    v_cvt_pk_bf16_f32 v26, v116, v117
    v_cvt_pk_bf16_f32 v27, v118, v119
    s_add_u32 s28, s30, 0x104c00
    buffer_store_dwordx4 v[24:27], v3, s[12:15], s28 offen sc1
    v_cvt_pk_bf16_f32 v28, v120, v121
    v_cvt_pk_bf16_f32 v29, v122, v123
    v_cvt_pk_bf16_f32 v30, v124, v125
    v_cvt_pk_bf16_f32 v31, v126, v127
    s_add_u32 s28, s30, 0x105c00
    buffer_store_dwordx4 v[28:31], v3, s[12:15], s28 offen sc1
    s_waitcnt vmcnt(4)
    s_cmp_lg_u32 s24, 0
    s_cbranch_scc1 .Lkvproj_kernel_chk_17
    v_cmp_ne_u32 vcc, 1, v15
    s_cbranch_vccz .Lkvproj_kernel_cok_18
    s_mov_b32 s48, 0x40000
.Lkvproj_kernel_poll_19:
    buffer_load_dword v15, v14, s[84:87], 0 offen sc1
    s_waitcnt vmcnt(0)
    v_cmp_ne_u32 vcc, 1, v15
    s_cbranch_vccz .Lkvproj_kernel_pdone_20
    s_sub_u32 s48, s48, 1
    s_sleep 2
    s_cmp_lg_u32 s48, 0
    s_cbranch_scc1 .Lkvproj_kernel_poll_19
.Lkvproj_kernel_pdone_20:
.Lkvproj_kernel_cok_18:
.Lkvproj_kernel_chk_17:
    s_branch .Lk2_begin
.Lk1_end:
    s_endpgm
.Lk2_begin:
    s_load_dwordx2 s[60:61], s[0:1], 16
    s_load_dwordx4 s[64:67], s[0:1], 56
    s_load_dwordx2 s[62:63], s[0:1], 96
    v_lshrrev_b32 v1, 6, v0
    v_and_b32 v2, 63, v0
    v_readfirstlane_b32 s32, v1
    s_and_b32 s52, s2, 7
    s_lshr_b32 s53, s2, 3
    s_and_b32 s53, s53, 3
    s_lshl_b32 s53, s53, 3
    s_add_u32 s36, s52, s53
    s_lshr_b32 s37, s2, 5
    s_lshl_b32 s33, s32, 13
    s_and_b32 s34, s32, 3
    s_lshr_b32 s35, s32, 2
    s_sub_u32 s52, 15, s37
    s_cmp_eq_u32 s35, 0
    s_cselect_b32 s52, s37, s52
    s_lshl_b32 s52, s52, 2
    s_add_u32 s41, s52, s34
    v_lshlrev_b32 v3, 4, v2
    v_lshrrev_b32 v5, 5, v2
    v_lshlrev_b32 v5, 2, v5
    v_bfe_u32 v6, v2, 2, 2
    v_add_u32 v5, v5, v6
    v_bfe_u32 v6, v2, 4, 1
    v_lshlrev_b32 v6, 6, v6
    v_and_b32 v7, 3, v2
    v_lshl_add_u32 v6, v7, 4, v6
    v_lshl_add_u32 v4, v5, 13, v6
    v_mul_u32_u24 v5, 3584, v5
    v_add_u32 v12, v5, v6
    s_mul_i32 s52, s36, 7
    s_lshr_b32 s52, s52, 1
    s_mul_i32 s53, s32, 28672
    s_lshl_b32 s54, s52, 5
    s_add_u32 s39, s53, s54
    s_mul_i32 s53, s41, 368
    s_add_u32 s53, s53, s52
    s_add_u32 s53, s53, 256
    s_lshl_b32 s51, s53, 10
    s_lshl_b32 s53, s32, 16
    s_lshl_b32 s54, s36, 8
    s_add_u32 s40, s53, s54
    s_lshl_b32 s87, s32, 10
    s_lshr_b32 s55, s36, 3
    s_lshl_b32 s54, s41, 15
    s_add_u32 s53, s55, 0
    s_and_b32 s53, s53, 3
    s_mul_i32 s68, s53, 458752
    s_add_u32 s68, s68, s39
    s_lshl_b32 s72, s53, 20
    s_add_u32 s72, s72, s40
    s_lshl_b32 s76, s53, 13
    s_add_u32 s76, s76, s54
    s_add_u32 s53, s55, 1
    s_and_b32 s53, s53, 3
    s_mul_i32 s69, s53, 458752
    s_add_u32 s69, s69, s39
    s_lshl_b32 s73, s53, 20
    s_add_u32 s73, s73, s40
    s_lshl_b32 s77, s53, 13
    s_add_u32 s77, s77, s54
    s_add_u32 s53, s55, 2
    s_and_b32 s53, s53, 3
    s_mul_i32 s70, s53, 458752
    s_add_u32 s70, s70, s39
    s_lshl_b32 s74, s53, 20
    s_add_u32 s74, s74, s40
    s_lshl_b32 s78, s53, 13
    s_add_u32 s78, s78, s54
    s_add_u32 s53, s55, 3
    s_and_b32 s53, s53, 3
    s_mul_i32 s71, s53, 458752
    s_add_u32 s71, s71, s39
    s_lshl_b32 s75, s53, 20
    s_add_u32 s75, s75, s40
    s_lshl_b32 s79, s53, 13
    s_add_u32 s79, s79, s54
    v_add_u32 v9, 4096, v3
    s_waitcnt lgkmcnt(0)
    s_mov_b32 s4, s64
    s_and_b32 s5, s65, 0xffff
    s_mov_b32 s6, 0x1c0000
    s_mov_b32 s7, 0x00020000
    s_mov_b32 s16, s62
    s_and_b32 s17, s63, 0xffff
    s_mov_b32 s18, 0x200000
    s_mov_b32 s19, 0x00020000
    s_add_u32 m0, s87, 0x0
    s_add_u32 s38, s68, 0x0
    buffer_load_dwordx4 v12, s[4:7], s38 offen lds
    s_mov_b32 s12, s60
    s_and_b32 s13, s61, 0xffff
    s_mov_b32 s14, 0x400000
    s_mov_b32 s15, 0x00020000
    s_barrier
    s_add_u32 m0, s87, 0x10000
    s_add_u32 s38, s72, 0x0
    buffer_load_dwordx4 v4, s[12:15], s38 offen lds
    buffer_load_dwordx4 v[128:131], v3, s[16:19], s76 offen offset:0
    buffer_load_dwordx4 v[132:135], v3, s[16:19], s76 offen offset:1024
    s_mov_b32 s8, s66
    s_and_b32 s9, s67, 0xffff
    s_mov_b32 s10, 0x1c0000
    s_mov_b32 s11, 0x00020000
    s_cmp_ge_u32 s32, 4
    s_cselect_b32 s54, 0x40000000, 0
    s_add_u32 s24, s62, 0x200000
    s_addc_u32 s25, s63, 0
    s_and_b32 s25, s25, 0xffff
    s_mov_b32 s26, 0x2000000
    s_mov_b32 s27, 0x00020000
    s_lshl_b32 s47, s36, 20
    s_and_b32 s53, s32, 1
    s_lshl_b32 s53, s53, 3
    s_add_u32 s53, s53, s37
    s_lshl_b32 s53, s53, 13
    s_cmp_lt_u32 s32, 2
    s_cselect_b32 s84, 0, 557056
    s_add_u32 s84, s84, s53
    s_add_u32 s84, s84, s47
    s_mov_b32 s85, s54
    s_add_u32 s20, s62, 0x2200000
    s_addc_u32 s21, s63, 0
    s_and_b32 s21, s21, 0xffff
    s_mov_b32 s22, 0x1700000
    s_mov_b32 s23, 0x00020000
    s_add_u32 s28, s62, 0x2200000
    s_addc_u32 s29, s63, 0
    s_and_b32 s29, s29, 0xffff
    s_mov_b32 s30, 0x1700000
    s_mov_b32 s31, 0x00020000
    v_lshrrev_b32 v5, 5, v2
    v_lshlrev_b32 v5, 10, v5
    v_bfe_u32 v6, v2, 2, 2
    v_lshlrev_b32 v6, 6, v6
    v_bfe_u32 v7, v2, 4, 1
    v_lshlrev_b32 v7, 5, v7
    v_add3_u32 v5, v5, v6, v7
    v_and_b32 v6, 3, v2
    v_lshlrev_b32 v6, 3, v6
    v_add_u32 v10, v5, v6
    v_add_u32 v11, 0x10000, v10
    s_lshl_b32 s52, s35, 15
    v_add_u32 v13, 0x8000, v3
    s_lshl_b32 s53, s34, 13
    v_add_u32 v15, s53, v3
    s_add_u32 s48, s52, s53
    s_add_u32 s53, s53, 0x20000
    s_mov_b32 s86, s53
    s_lshl_b32 s50, s41, 5
    v_and_b32 v5, 31, v2
    v_lshrrev_b32 v6, 5, v2
    v_lshlrev_b32 v6, 2, v6
    v_sub_u32 v14, v5, v6
    s_lshl_b32 s52, s37, 1
    s_add_u32 s53, s52, 2
    s_cmp_eq_u32 s35, 0
    s_cselect_b32 s45, s53, 99
    s_cselect_b32 s56, s53, 0
    s_sub_u32 s57, 16, s56
    s_sub_u32 s46, 15, s52
    s_cmp_eq_u32 s35, 0
    s_cselect_b32 s58, 21, 4
    s_lshl_b32 s58, s58, 15
    s_add_u32 s58, s58, s47
    s_add_u32 s59, s47, 1015808
    s_lshl_b32 s53, s37, 2
    s_add_u32 s53, s53, s34
    s_lshl_b32 s53, s53, 10
    v_lshlrev_b32 v5, 7, v2
    v_add_u32 v5, s53, v5
    v_cmp_gt_u32 vcc, 8, v2
    v_mov_b32 v6, 0x40000000
    s_nop 0
    v_cndmask_b32 v7, v6, v5, vcc
    s_mov_b32 s44, 0
    s_mov_b32 s64, 0x10000
    s_mov_b32 s42, 0xbf800000
    s_mov_b32 s43, 0xf149f2ca
    s_mov_b32 s49, 0
    s_add_u32 s88, s62, 0x6000000
    s_addc_u32 s89, s63, 0
    s_and_b32 s89, s89, 0xffff
    s_mov_b32 s90, 0x60000
    s_mov_b32 s91, 0x00020000
    s_waitcnt vmcnt(0)
    s_barrier
    buffer_load_dwordx4 v[136:139], v3, s[16:19], s76 offen offset:2048
    buffer_load_dwordx4 v[140:143], v3, s[16:19], s76 offen offset:3072
    buffer_load_dwordx4 v[144:147], v9, s[16:19], s76 offen offset:0
    buffer_load_dwordx4 v[148:151], v9, s[16:19], s76 offen offset:1024
    s_add_u32 m0, s87, 0x2000
    s_add_u32 s38, s68, 0x38000
    buffer_load_dwordx4 v12, s[4:7], s38 offen lds
    s_add_u32 m0, s87, 0x12000
    s_add_u32 s38, s72, 0x80000
    buffer_load_dwordx4 v4, s[12:15], s38 offen lds
    buffer_load_dwordx4 v[152:155], v9, s[16:19], s76 offen offset:2048
    buffer_load_dwordx4 v[156:159], v9, s[16:19], s76 offen offset:3072
    ds_read_b64_tr_b16 v[32:33], v10 offset:0
    ds_read_b64_tr_b16 v[34:35], v10 offset:512
    ds_read_b64_tr_b16 v[36:37], v10 offset:256
    ds_read_b64_tr_b16 v[38:39], v10 offset:768
    ds_read_b64_tr_b16 v[40:41], v11 offset:0
    ds_read_b64_tr_b16 v[42:43], v11 offset:512
    ds_read_b64_tr_b16 v[44:45], v11 offset:256
    ds_read_b64_tr_b16 v[46:47], v11 offset:768
    ds_read_b64_tr_b16 v[48:49], v10 offset:2048
    ds_read_b64_tr_b16 v[50:51], v10 offset:2560
    ds_read_b64_tr_b16 v[52:53], v10 offset:2304
    ds_read_b64_tr_b16 v[54:55], v10 offset:2816
    s_waitcnt lgkmcnt(10)
    v_mfma_f32_32x32x16_bf16 v[64:79], v[32:35], v[128:131], 0
    ds_read_b64_tr_b16 v[56:57], v11 offset:2048
    ds_read_b64_tr_b16 v[58:59], v11 offset:2560
    s_cmp_lg_u32 s32, 0
    s_cbranch_scc1 .Lk2_ns
    s_waitcnt vmcnt(63)
    s_lshl_b32 s52, s2, 8
    s_add_u32 s52, s52, 0x10000
    v_mov_b32 v5, s52
    v_mov_b32 v6, 1
    s_mov_b64 exec, 1
    buffer_store_dword v6, v5, s[88:91], 0 offen sc1
    s_mov_b64 exec, -1
.Lk2_ns:
    s_waitcnt lgkmcnt(10)
    v_mfma_f32_32x32x16_bf16 v[80:95], v[36:39], v[128:131], 0
    ds_read_b64_tr_b16 v[60:61], v11 offset:2304
    ds_read_b64_tr_b16 v[62:63], v11 offset:2816
    buffer_load_dwordx4 v[160:163], v3, s[16:19], s77 offen offset:0
    s_waitcnt lgkmcnt(10)
    v_mfma_f32_32x32x16_bf16 v[96:111], v[40:43], v[128:131], 0
    ds_read_b64_tr_b16 v[32:33], v10 offset:4096
    ds_read_b64_tr_b16 v[34:35], v10 offset:4608
    s_add_u32 m0, s87, 0x4000
    s_add_u32 s38, s69, 0x0
    buffer_load_dwordx4 v12, s[4:7], s38 offen lds
    s_waitcnt lgkmcnt(10)
    v_mfma_f32_32x32x16_bf16 v[112:127], v[44:47], v[128:131], 0
    ds_read_b64_tr_b16 v[36:37], v10 offset:4352
    ds_read_b64_tr_b16 v[38:39], v10 offset:4864
    s_waitcnt lgkmcnt(10)
    v_mfma_f32_32x32x16_bf16 v[64:79], v[48:51], v[132:135], v[64:79]
    ds_read_b64_tr_b16 v[40:41], v11 offset:4096
    ds_read_b64_tr_b16 v[42:43], v11 offset:4608
    s_waitcnt lgkmcnt(10)
    v_mfma_f32_32x32x16_bf16 v[80:95], v[52:55], v[132:135], v[80:95]
    ds_read_b64_tr_b16 v[44:45], v11 offset:4352
    ds_read_b64_tr_b16 v[46:47], v11 offset:4864
    buffer_load_dwordx4 v[164:167], v3, s[16:19], s77 offen offset:1024
    s_waitcnt lgkmcnt(10)
    v_mfma_f32_32x32x16_bf16 v[96:111], v[56:59], v[132:135], v[96:111]
    ds_read_b64_tr_b16 v[48:49], v10 offset:6144
    ds_read_b64_tr_b16 v[50:51], v10 offset:6656
    s_add_u32 m0, s87, 0x14000
    s_add_u32 s38, s73, 0x0
    buffer_load_dwordx4 v4, s[12:15], s38 offen lds
    s_waitcnt lgkmcnt(10)
    v_mfma_f32_32x32x16_bf16 v[112:127], v[60:63], v[132:135], v[112:127]
    ds_read_b64_tr_b16 v[52:53], v10 offset:6400
    ds_read_b64_tr_b16 v[54:55], v10 offset:6912
    s_waitcnt vmcnt(11)
    s_waitcnt lgkmcnt(10)
    v_mfma_f32_32x32x16_bf16 v[64:79], v[32:35], v[136:139], v[64:79]
    ds_read_b64_tr_b16 v[56:57], v11 offset:6144
    ds_read_b64_tr_b16 v[58:59], v11 offset:6656
    s_waitcnt lgkmcnt(10)
    v_mfma_f32_32x32x16_bf16 v[80:95], v[36:39], v[136:139], v[80:95]
    ds_read_b64_tr_b16 v[60:61], v11 offset:6400
    ds_read_b64_tr_b16 v[62:63], v11 offset:6912
    buffer_load_dwordx4 v[168:171], v3, s[16:19], s77 offen offset:2048
    s_waitcnt lgkmcnt(10)
    v_mfma_f32_32x32x16_bf16 v[96:111], v[40:43], v[136:139], v[96:111]
    s_waitcnt lgkmcnt(8)
    v_mfma_f32_32x32x16_bf16 v[112:127], v[44:47], v[136:139], v[112:127]
    s_waitcnt vmcnt(7)
    s_barrier
    ds_read_b64_tr_b16 v[32:33], v10 offset:8192
    ds_read_b64_tr_b16 v[34:35], v10 offset:8704
    ds_read_b64_tr_b16 v[36:37], v10 offset:8448
    ds_read_b64_tr_b16 v[38:39], v10 offset:8960
    ds_read_b64_tr_b16 v[40:41], v11 offset:8192
    ds_read_b64_tr_b16 v[42:43], v11 offset:8704
    ds_read_b64_tr_b16 v[44:45], v11 offset:8448
    ds_read_b64_tr_b16 v[46:47], v11 offset:8960
    s_waitcnt lgkmcnt(14)
    v_mfma_f32_32x32x16_bf16 v[64:79], v[48:51], v[140:143], v[64:79]
    s_waitcnt lgkmcnt(12)
    v_mfma_f32_32x32x16_bf16 v[80:95], v[52:55], v[140:143], v[80:95]
    buffer_load_dwordx4 v[172:175], v3, s[16:19], s77 offen offset:3072
    s_waitcnt lgkmcnt(10)
    v_mfma_f32_32x32x16_bf16 v[96:111], v[56:59], v[140:143], v[96:111]
    ds_read_b64_tr_b16 v[48:49], v10 offset:10240
    ds_read_b64_tr_b16 v[50:51], v10 offset:10752
    s_waitcnt lgkmcnt(10)
    v_mfma_f32_32x32x16_bf16 v[112:127], v[60:63], v[140:143], v[112:127]
    ds_read_b64_tr_b16 v[52:53], v10 offset:10496
    ds_read_b64_tr_b16 v[54:55], v10 offset:11008
    s_waitcnt lgkmcnt(10)
    v_mfma_f32_32x32x16_bf16 v[64:79], v[32:35], v[144:147], v[64:79]
    ds_read_b64_tr_b16 v[56:57], v11 offset:10240
    ds_read_b64_tr_b16 v[58:59], v11 offset:10752
    s_waitcnt lgkmcnt(10)
    v_mfma_f32_32x32x16_bf16 v[80:95], v[36:39], v[144:147], v[80:95]
    ds_read_b64_tr_b16 v[60:61], v11 offset:10496
    ds_read_b64_tr_b16 v[62:63], v11 offset:11008
    buffer_load_dwordx4 v[176:179], v9, s[16:19], s77 offen offset:0
    s_waitcnt lgkmcnt(10)
    v_mfma_f32_32x32x16_bf16 v[96:111], v[40:43], v[144:147], v[96:111]
    ds_read_b64_tr_b16 v[32:33], v10 offset:12288
    ds_read_b64_tr_b16 v[34:35], v10 offset:12800
    s_add_u32 m0, s87, 0x6000
    s_add_u32 s38, s69, 0x38000
    buffer_load_dwordx4 v12, s[4:7], s38 offen lds
    s_waitcnt lgkmcnt(10)
    v_mfma_f32_32x32x16_bf16 v[112:127], v[44:47], v[144:147], v[112:127]
    ds_read_b64_tr_b16 v[36:37], v10 offset:12544
    ds_read_b64_tr_b16 v[38:39], v10 offset:13056
    s_waitcnt lgkmcnt(10)
    v_mfma_f32_32x32x16_bf16 v[64:79], v[48:51], v[148:151], v[64:79]
    ds_read_b64_tr_b16 v[40:41], v11 offset:12288
    ds_read_b64_tr_b16 v[42:43], v11 offset:12800
    s_waitcnt lgkmcnt(10)
    v_mfma_f32_32x32x16_bf16 v[80:95], v[52:55], v[148:151], v[80:95]
    ds_read_b64_tr_b16 v[44:45], v11 offset:12544
    ds_read_b64_tr_b16 v[46:47], v11 offset:13056
    buffer_load_dwordx4 v[180:183], v9, s[16:19], s77 offen offset:1024
    s_waitcnt lgkmcnt(10)
    v_mfma_f32_32x32x16_bf16 v[96:111], v[56:59], v[148:151], v[96:111]
    ds_read_b64_tr_b16 v[48:49], v10 offset:14336
    ds_read_b64_tr_b16 v[50:51], v10 offset:14848
    s_add_u32 m0, s87, 0x16000
    s_add_u32 s38, s73, 0x80000
    buffer_load_dwordx4 v4, s[12:15], s38 offen lds
    s_waitcnt lgkmcnt(10)
    v_mfma_f32_32x32x16_bf16 v[112:127], v[60:63], v[148:151], v[112:127]
    ds_read_b64_tr_b16 v[52:53], v10 offset:14592
    ds_read_b64_tr_b16 v[54:55], v10 offset:15104
    s_waitcnt vmcnt(11)
    s_waitcnt lgkmcnt(10)
    v_mfma_f32_32x32x16_bf16 v[64:79], v[32:35], v[152:155], v[64:79]
    ds_read_b64_tr_b16 v[56:57], v11 offset:14336
    ds_read_b64_tr_b16 v[58:59], v11 offset:14848
    s_waitcnt lgkmcnt(10)
    v_mfma_f32_32x32x16_bf16 v[80:95], v[36:39], v[152:155], v[80:95]
    ds_read_b64_tr_b16 v[60:61], v11 offset:14592
    ds_read_b64_tr_b16 v[62:63], v11 offset:15104
    buffer_load_dwordx4 v[184:187], v9, s[16:19], s77 offen offset:2048
    s_waitcnt lgkmcnt(10)
    v_mfma_f32_32x32x16_bf16 v[96:111], v[40:43], v[152:155], v[96:111]
    s_waitcnt lgkmcnt(8)
    v_mfma_f32_32x32x16_bf16 v[112:127], v[44:47], v[152:155], v[112:127]
    s_waitcnt vmcnt(7)
    s_barrier
    ds_read_b64_tr_b16 v[32:33], v10 offset:16384
    ds_read_b64_tr_b16 v[34:35], v10 offset:16896
    ds_read_b64_tr_b16 v[36:37], v10 offset:16640
    ds_read_b64_tr_b16 v[38:39], v10 offset:17152
    ds_read_b64_tr_b16 v[40:41], v11 offset:16384
    ds_read_b64_tr_b16 v[42:43], v11 offset:16896
    ds_read_b64_tr_b16 v[44:45], v11 offset:16640
    ds_read_b64_tr_b16 v[46:47], v11 offset:17152
    s_waitcnt lgkmcnt(14)
    v_mfma_f32_32x32x16_bf16 v[64:79], v[48:51], v[156:159], v[64:79]
    s_waitcnt lgkmcnt(12)
    v_mfma_f32_32x32x16_bf16 v[80:95], v[52:55], v[156:159], v[80:95]
    buffer_load_dwordx4 v[188:191], v9, s[16:19], s77 offen offset:3072
    s_waitcnt lgkmcnt(10)
    v_mfma_f32_32x32x16_bf16 v[96:111], v[56:59], v[156:159], v[96:111]
    ds_read_b64_tr_b16 v[48:49], v10 offset:18432
    ds_read_b64_tr_b16 v[50:51], v10 offset:18944
    s_waitcnt lgkmcnt(10)
    v_mfma_f32_32x32x16_bf16 v[112:127], v[60:63], v[156:159], v[112:127]
    ds_read_b64_tr_b16 v[52:53], v10 offset:18688
    ds_read_b64_tr_b16 v[54:55], v10 offset:19200
    s_waitcnt lgkmcnt(10)
    v_mfma_f32_32x32x16_bf16 v[64:79], v[32:35], v[160:163], v[64:79]
    ds_read_b64_tr_b16 v[56:57], v11 offset:18432
    ds_read_b64_tr_b16 v[58:59], v11 offset:18944
    s_waitcnt lgkmcnt(10)
    v_mfma_f32_32x32x16_bf16 v[80:95], v[36:39], v[160:163], v[80:95]
    ds_read_b64_tr_b16 v[60:61], v11 offset:18688
    ds_read_b64_tr_b16 v[62:63], v11 offset:19200
    buffer_load_dwordx4 v[192:195], v3, s[16:19], s78 offen offset:0
    s_waitcnt lgkmcnt(10)
    v_mfma_f32_32x32x16_bf16 v[96:111], v[40:43], v[160:163], v[96:111]
    ds_read_b64_tr_b16 v[32:33], v10 offset:20480
    ds_read_b64_tr_b16 v[34:35], v10 offset:20992
    s_add_u32 m0, s87, 0x8000
    s_add_u32 s38, s70, 0x0
    buffer_load_dwordx4 v12, s[4:7], s38 offen lds
    s_waitcnt lgkmcnt(10)
    v_mfma_f32_32x32x16_bf16 v[112:127], v[44:47], v[160:163], v[112:127]
    ds_read_b64_tr_b16 v[36:37], v10 offset:20736
    ds_read_b64_tr_b16 v[38:39], v10 offset:21248
    s_waitcnt lgkmcnt(10)
    v_mfma_f32_32x32x16_bf16 v[64:79], v[48:51], v[164:167], v[64:79]
    ds_read_b64_tr_b16 v[40:41], v11 offset:20480
    ds_read_b64_tr_b16 v[42:43], v11 offset:20992
    s_waitcnt lgkmcnt(10)
    v_mfma_f32_32x32x16_bf16 v[80:95], v[52:55], v[164:167], v[80:95]
    ds_read_b64_tr_b16 v[44:45], v11 offset:20736
    ds_read_b64_tr_b16 v[46:47], v11 offset:21248
    buffer_load_dwordx4 v[196:199], v3, s[16:19], s78 offen offset:1024
    s_waitcnt lgkmcnt(10)
    v_mfma_f32_32x32x16_bf16 v[96:111], v[56:59], v[164:167], v[96:111]
    ds_read_b64_tr_b16 v[48:49], v10 offset:22528
    ds_read_b64_tr_b16 v[50:51], v10 offset:23040
    s_add_u32 m0, s87, 0x18000
    s_add_u32 s38, s74, 0x0
    buffer_load_dwordx4 v4, s[12:15], s38 offen lds
    s_waitcnt lgkmcnt(10)
    v_mfma_f32_32x32x16_bf16 v[112:127], v[60:63], v[164:167], v[112:127]
    ds_read_b64_tr_b16 v[52:53], v10 offset:22784
    ds_read_b64_tr_b16 v[54:55], v10 offset:23296
    s_waitcnt vmcnt(11)
    s_waitcnt lgkmcnt(10)
    v_mfma_f32_32x32x16_bf16 v[64:79], v[32:35], v[168:171], v[64:79]
    ds_read_b64_tr_b16 v[56:57], v11 offset:22528
    ds_read_b64_tr_b16 v[58:59], v11 offset:23040
    s_waitcnt lgkmcnt(10)
    v_mfma_f32_32x32x16_bf16 v[80:95], v[36:39], v[168:171], v[80:95]
    ds_read_b64_tr_b16 v[60:61], v11 offset:22784
    ds_read_b64_tr_b16 v[62:63], v11 offset:23296
    buffer_load_dwordx4 v[200:203], v3, s[16:19], s78 offen offset:2048
    s_waitcnt lgkmcnt(10)
    v_mfma_f32_32x32x16_bf16 v[96:111], v[40:43], v[168:171], v[96:111]
    s_waitcnt lgkmcnt(8)
    v_mfma_f32_32x32x16_bf16 v[112:127], v[44:47], v[168:171], v[112:127]
    s_waitcnt vmcnt(7)
    s_barrier
    ds_read_b64_tr_b16 v[32:33], v10 offset:24576
    ds_read_b64_tr_b16 v[34:35], v10 offset:25088
    ds_read_b64_tr_b16 v[36:37], v10 offset:24832
    ds_read_b64_tr_b16 v[38:39], v10 offset:25344
    ds_read_b64_tr_b16 v[40:41], v11 offset:24576
    ds_read_b64_tr_b16 v[42:43], v11 offset:25088
    ds_read_b64_tr_b16 v[44:45], v11 offset:24832
    ds_read_b64_tr_b16 v[46:47], v11 offset:25344
    s_waitcnt lgkmcnt(14)
    v_mfma_f32_32x32x16_bf16 v[64:79], v[48:51], v[172:175], v[64:79]
    s_waitcnt lgkmcnt(12)
    v_mfma_f32_32x32x16_bf16 v[80:95], v[52:55], v[172:175], v[80:95]
    buffer_load_dwordx4 v[204:207], v3, s[16:19], s78 offen offset:3072
    s_waitcnt lgkmcnt(10)
    v_mfma_f32_32x32x16_bf16 v[96:111], v[56:59], v[172:175], v[96:111]
    ds_read_b64_tr_b16 v[48:49], v10 offset:26624
    ds_read_b64_tr_b16 v[50:51], v10 offset:27136
    s_waitcnt lgkmcnt(10)
    v_mfma_f32_32x32x16_bf16 v[112:127], v[60:63], v[172:175], v[112:127]
    ds_read_b64_tr_b16 v[52:53], v10 offset:26880
    ds_read_b64_tr_b16 v[54:55], v10 offset:27392
    s_waitcnt lgkmcnt(10)
    v_mfma_f32_32x32x16_bf16 v[64:79], v[32:35], v[176:179], v[64:79]
    ds_read_b64_tr_b16 v[56:57], v11 offset:26624
    ds_read_b64_tr_b16 v[58:59], v11 offset:27136
    s_waitcnt lgkmcnt(10)
    v_mfma_f32_32x32x16_bf16 v[80:95], v[36:39], v[176:179], v[80:95]
    ds_read_b64_tr_b16 v[60:61], v11 offset:26880
    ds_read_b64_tr_b16 v[62:63], v11 offset:27392
    buffer_load_dwordx4 v[208:211], v9, s[16:19], s78 offen offset:0
    s_waitcnt lgkmcnt(10)
    v_mfma_f32_32x32x16_bf16 v[96:111], v[40:43], v[176:179], v[96:111]
    ds_read_b64_tr_b16 v[32:33], v10 offset:28672
    ds_read_b64_tr_b16 v[34:35], v10 offset:29184
    s_add_u32 m0, s87, 0xa000
    s_add_u32 s38, s70, 0x38000
    buffer_load_dwordx4 v12, s[4:7], s38 offen lds
    s_waitcnt lgkmcnt(10)
    v_mfma_f32_32x32x16_bf16 v[112:127], v[44:47], v[176:179], v[112:127]
    ds_read_b64_tr_b16 v[36:37], v10 offset:28928
    ds_read_b64_tr_b16 v[38:39], v10 offset:29440
    s_waitcnt lgkmcnt(10)
    v_mfma_f32_32x32x16_bf16 v[64:79], v[48:51], v[180:183], v[64:79]
    ds_read_b64_tr_b16 v[40:41], v11 offset:28672
    ds_read_b64_tr_b16 v[42:43], v11 offset:29184
    s_waitcnt lgkmcnt(10)
    v_mfma_f32_32x32x16_bf16 v[80:95], v[52:55], v[180:183], v[80:95]
    ds_read_b64_tr_b16 v[44:45], v11 offset:28928
    ds_read_b64_tr_b16 v[46:47], v11 offset:29440
    buffer_load_dwordx4 v[212:215], v9, s[16:19], s78 offen offset:1024
    s_waitcnt lgkmcnt(10)
    v_mfma_f32_32x32x16_bf16 v[96:111], v[56:59], v[180:183], v[96:111]
    ds_read_b64_tr_b16 v[48:49], v10 offset:30720
    ds_read_b64_tr_b16 v[50:51], v10 offset:31232
    s_add_u32 m0, s87, 0x1a000
    s_add_u32 s38, s74, 0x80000
    buffer_load_dwordx4 v4, s[12:15], s38 offen lds
    s_waitcnt lgkmcnt(10)
    v_mfma_f32_32x32x16_bf16 v[112:127], v[60:63], v[180:183], v[112:127]
    ds_read_b64_tr_b16 v[52:53], v10 offset:30976
    ds_read_b64_tr_b16 v[54:55], v10 offset:31488
    s_waitcnt vmcnt(11)
    s_waitcnt lgkmcnt(10)
    v_mfma_f32_32x32x16_bf16 v[64:79], v[32:35], v[184:187], v[64:79]
    ds_read_b64_tr_b16 v[56:57], v11 offset:30720
    ds_read_b64_tr_b16 v[58:59], v11 offset:31232
    s_waitcnt lgkmcnt(10)
    v_mfma_f32_32x32x16_bf16 v[80:95], v[36:39], v[184:187], v[80:95]
    ds_read_b64_tr_b16 v[60:61], v11 offset:30976
    ds_read_b64_tr_b16 v[62:63], v11 offset:31488
    buffer_load_dwordx4 v[216:219], v9, s[16:19], s78 offen offset:2048
    s_waitcnt lgkmcnt(10)
    v_mfma_f32_32x32x16_bf16 v[96:111], v[40:43], v[184:187], v[96:111]
    s_waitcnt lgkmcnt(8)
    v_mfma_f32_32x32x16_bf16 v[112:127], v[44:47], v[184:187], v[112:127]
    s_waitcnt vmcnt(7)
    s_barrier
    ds_read_b64_tr_b16 v[32:33], v10 offset:32768
    ds_read_b64_tr_b16 v[34:35], v10 offset:33280
    ds_read_b64_tr_b16 v[36:37], v10 offset:33024
    ds_read_b64_tr_b16 v[38:39], v10 offset:33536
    ds_read_b64_tr_b16 v[40:41], v11 offset:32768
    ds_read_b64_tr_b16 v[42:43], v11 offset:33280
    ds_read_b64_tr_b16 v[44:45], v11 offset:33024
    ds_read_b64_tr_b16 v[46:47], v11 offset:33536
    s_waitcnt lgkmcnt(14)
    v_mfma_f32_32x32x16_bf16 v[64:79], v[48:51], v[188:191], v[64:79]
    s_waitcnt lgkmcnt(12)
    v_mfma_f32_32x32x16_bf16 v[80:95], v[52:55], v[188:191], v[80:95]
    buffer_load_dwordx4 v[220:223], v9, s[16:19], s78 offen offset:3072
    s_waitcnt lgkmcnt(10)
    v_mfma_f32_32x32x16_bf16 v[96:111], v[56:59], v[188:191], v[96:111]
    ds_read_b64_tr_b16 v[48:49], v10 offset:34816
    ds_read_b64_tr_b16 v[50:51], v10 offset:35328
    s_waitcnt lgkmcnt(10)
    v_mfma_f32_32x32x16_bf16 v[112:127], v[60:63], v[188:191], v[112:127]
    ds_read_b64_tr_b16 v[52:53], v10 offset:35072
    ds_read_b64_tr_b16 v[54:55], v10 offset:35584
    s_waitcnt lgkmcnt(10)
    v_mfma_f32_32x32x16_bf16 v[64:79], v[32:35], v[192:195], v[64:79]
    ds_read_b64_tr_b16 v[56:57], v11 offset:34816
    ds_read_b64_tr_b16 v[58:59], v11 offset:35328
    s_waitcnt lgkmcnt(10)
    v_mfma_f32_32x32x16_bf16 v[80:95], v[36:39], v[192:195], v[80:95]
    ds_read_b64_tr_b16 v[60:61], v11 offset:35072
    ds_read_b64_tr_b16 v[62:63], v11 offset:35584
    buffer_load_dwordx4 v[224:227], v3, s[16:19], s79 offen offset:0
    s_waitcnt lgkmcnt(10)
    v_mfma_f32_32x32x16_bf16 v[96:111], v[40:43], v[192:195], v[96:111]
    ds_read_b64_tr_b16 v[32:33], v10 offset:36864
    ds_read_b64_tr_b16 v[34:35], v10 offset:37376
    s_add_u32 m0, s87, 0xc000
    s_add_u32 s38, s71, 0x0
    buffer_load_dwordx4 v12, s[4:7], s38 offen lds
    s_waitcnt lgkmcnt(10)
    v_mfma_f32_32x32x16_bf16 v[112:127], v[44:47], v[192:195], v[112:127]
    ds_read_b64_tr_b16 v[36:37], v10 offset:37120
    ds_read_b64_tr_b16 v[38:39], v10 offset:37632
    s_waitcnt lgkmcnt(10)
    v_mfma_f32_32x32x16_bf16 v[64:79], v[48:51], v[196:199], v[64:79]
    ds_read_b64_tr_b16 v[40:41], v11 offset:36864
    ds_read_b64_tr_b16 v[42:43], v11 offset:37376
    s_waitcnt lgkmcnt(10)
    v_mfma_f32_32x32x16_bf16 v[80:95], v[52:55], v[196:199], v[80:95]
    ds_read_b64_tr_b16 v[44:45], v11 offset:37120
    ds_read_b64_tr_b16 v[46:47], v11 offset:37632
    buffer_load_dwordx4 v[228:231], v3, s[16:19], s79 offen offset:1024
    s_waitcnt lgkmcnt(10)
    v_mfma_f32_32x32x16_bf16 v[96:111], v[56:59], v[196:199], v[96:111]
    ds_read_b64_tr_b16 v[48:49], v10 offset:38912
    ds_read_b64_tr_b16 v[50:51], v10 offset:39424
    s_add_u32 m0, s87, 0x1c000
    s_add_u32 s38, s75, 0x0
    buffer_load_dwordx4 v4, s[12:15], s38 offen lds
    s_waitcnt lgkmcnt(10)
    v_mfma_f32_32x32x16_bf16 v[112:127], v[60:63], v[196:199], v[112:127]
    ds_read_b64_tr_b16 v[52:53], v10 offset:39168
    ds_read_b64_tr_b16 v[54:55], v10 offset:39680
    s_waitcnt vmcnt(11)
    s_waitcnt lgkmcnt(10)
    v_mfma_f32_32x32x16_bf16 v[64:79], v[32:35], v[200:203], v[64:79]
    ds_read_b64_tr_b16 v[56:57], v11 offset:38912
    ds_read_b64_tr_b16 v[58:59], v11 offset:39424
    s_waitcnt lgkmcnt(10)
    v_mfma_f32_32x32x16_bf16 v[80:95], v[36:39], v[200:203], v[80:95]
    ds_read_b64_tr_b16 v[60:61], v11 offset:39168
    ds_read_b64_tr_b16 v[62:63], v11 offset:39680
    buffer_load_dwordx4 v[232:235], v3, s[16:19], s79 offen offset:2048
    s_waitcnt lgkmcnt(10)
    v_mfma_f32_32x32x16_bf16 v[96:111], v[40:43], v[200:203], v[96:111]
    s_waitcnt lgkmcnt(8)
    v_mfma_f32_32x32x16_bf16 v[112:127], v[44:47], v[200:203], v[112:127]
    s_waitcnt vmcnt(7)
    s_barrier
    ds_read_b64_tr_b16 v[32:33], v10 offset:40960
    ds_read_b64_tr_b16 v[34:35], v10 offset:41472
    ds_read_b64_tr_b16 v[36:37], v10 offset:41216
    ds_read_b64_tr_b16 v[38:39], v10 offset:41728
    ds_read_b64_tr_b16 v[40:41], v11 offset:40960
    ds_read_b64_tr_b16 v[42:43], v11 offset:41472
    ds_read_b64_tr_b16 v[44:45], v11 offset:41216
    ds_read_b64_tr_b16 v[46:47], v11 offset:41728
    s_waitcnt lgkmcnt(14)
    v_mfma_f32_32x32x16_bf16 v[64:79], v[48:51], v[204:207], v[64:79]
    s_waitcnt lgkmcnt(12)
    v_mfma_f32_32x32x16_bf16 v[80:95], v[52:55], v[204:207], v[80:95]
    buffer_load_dwordx4 v[236:239], v3, s[16:19], s79 offen offset:3072
    s_waitcnt lgkmcnt(10)
    v_mfma_f32_32x32x16_bf16 v[96:111], v[56:59], v[204:207], v[96:111]
    ds_read_b64_tr_b16 v[48:49], v10 offset:43008
    ds_read_b64_tr_b16 v[50:51], v10 offset:43520
    s_waitcnt lgkmcnt(10)
    v_mfma_f32_32x32x16_bf16 v[112:127], v[60:63], v[204:207], v[112:127]
    ds_read_b64_tr_b16 v[52:53], v10 offset:43264
    ds_read_b64_tr_b16 v[54:55], v10 offset:43776
    s_waitcnt lgkmcnt(10)
    v_mfma_f32_32x32x16_bf16 v[64:79], v[32:35], v[208:211], v[64:79]
    ds_read_b64_tr_b16 v[56:57], v11 offset:43008
    ds_read_b64_tr_b16 v[58:59], v11 offset:43520
    s_waitcnt lgkmcnt(10)
    v_mfma_f32_32x32x16_bf16 v[80:95], v[36:39], v[208:211], v[80:95]
    ds_read_b64_tr_b16 v[60:61], v11 offset:43264
    ds_read_b64_tr_b16 v[62:63], v11 offset:43776
    buffer_load_dwordx4 v[240:243], v9, s[16:19], s79 offen offset:0
    s_waitcnt lgkmcnt(10)
    v_mfma_f32_32x32x16_bf16 v[96:111], v[40:43], v[208:211], v[96:111]
    ds_read_b64_tr_b16 v[32:33], v10 offset:45056
    ds_read_b64_tr_b16 v[34:35], v10 offset:45568
    s_add_u32 m0, s87, 0xe000
    s_add_u32 s38, s71, 0x38000
    buffer_load_dwordx4 v12, s[4:7], s38 offen lds
    s_waitcnt lgkmcnt(10)
    v_mfma_f32_32x32x16_bf16 v[112:127], v[44:47], v[208:211], v[112:127]
    ds_read_b64_tr_b16 v[36:37], v10 offset:45312
    ds_read_b64_tr_b16 v[38:39], v10 offset:45824
    s_waitcnt lgkmcnt(10)
    v_mfma_f32_32x32x16_bf16 v[64:79], v[48:51], v[212:215], v[64:79]
    ds_read_b64_tr_b16 v[40:41], v11 offset:45056
    ds_read_b64_tr_b16 v[42:43], v11 offset:45568
    s_waitcnt lgkmcnt(10)
    v_mfma_f32_32x32x16_bf16 v[80:95], v[52:55], v[212:215], v[80:95]
    ds_read_b64_tr_b16 v[44:45], v11 offset:45312
    ds_read_b64_tr_b16 v[46:47], v11 offset:45824
    buffer_load_dwordx4 v[244:247], v9, s[16:19], s79 offen offset:1024
    s_waitcnt lgkmcnt(10)
    v_mfma_f32_32x32x16_bf16 v[96:111], v[56:59], v[212:215], v[96:111]
    ds_read_b64_tr_b16 v[48:49], v10 offset:47104
    ds_read_b64_tr_b16 v[50:51], v10 offset:47616
    s_add_u32 m0, s87, 0x1e000
    s_add_u32 s38, s75, 0x80000
    buffer_load_dwordx4 v4, s[12:15], s38 offen lds
    s_waitcnt lgkmcnt(10)
    v_mfma_f32_32x32x16_bf16 v[112:127], v[60:63], v[212:215], v[112:127]
    ds_read_b64_tr_b16 v[52:53], v10 offset:47360
    ds_read_b64_tr_b16 v[54:55], v10 offset:47872
    s_waitcnt vmcnt(11)
    s_waitcnt lgkmcnt(10)
    v_mfma_f32_32x32x16_bf16 v[64:79], v[32:35], v[216:219], v[64:79]
    ds_read_b64_tr_b16 v[56:57], v11 offset:47104
    ds_read_b64_tr_b16 v[58:59], v11 offset:47616
    s_waitcnt lgkmcnt(10)
    v_mfma_f32_32x32x16_bf16 v[80:95], v[36:39], v[216:219], v[80:95]
    ds_read_b64_tr_b16 v[60:61], v11 offset:47360
    ds_read_b64_tr_b16 v[62:63], v11 offset:47872
    buffer_load_dwordx4 v[248:251], v9, s[16:19], s79 offen offset:2048
    s_waitcnt lgkmcnt(10)
    v_mfma_f32_32x32x16_bf16 v[96:111], v[40:43], v[216:219], v[96:111]
    s_add_u32 m0, s87, 0x0
    s_add_u32 s38, s68, 0x0
    buffer_load_dwordx4 v12, s[8:11], s38 offen lds
    s_waitcnt lgkmcnt(8)
    v_mfma_f32_32x32x16_bf16 v[112:127], v[44:47], v[216:219], v[112:127]
    s_waitcnt vmcnt(8)
    s_barrier
    ds_read_b64_tr_b16 v[32:33], v10 offset:49152
    ds_read_b64_tr_b16 v[34:35], v10 offset:49664
    ds_read_b64_tr_b16 v[36:37], v10 offset:49408
    ds_read_b64_tr_b16 v[38:39], v10 offset:49920
    ds_read_b64_tr_b16 v[40:41], v11 offset:49152
    ds_read_b64_tr_b16 v[42:43], v11 offset:49664
    ds_read_b64_tr_b16 v[44:45], v11 offset:49408
    ds_read_b64_tr_b16 v[46:47], v11 offset:49920
    s_waitcnt lgkmcnt(14)
    v_mfma_f32_32x32x16_bf16 v[64:79], v[48:51], v[220:223], v[64:79]
    s_waitcnt lgkmcnt(12)
    v_mfma_f32_32x32x16_bf16 v[80:95], v[52:55], v[220:223], v[80:95]
    buffer_load_dwordx4 v[252:255], v9, s[16:19], s79 offen offset:3072
    s_waitcnt lgkmcnt(10)
    v_mfma_f32_32x32x16_bf16 v[96:111], v[56:59], v[220:223], v[96:111]
    ds_read_b64_tr_b16 v[48:49], v10 offset:51200
    ds_read_b64_tr_b16 v[50:51], v10 offset:51712
    s_add_u32 m0, s87, 0x2000
    s_add_u32 s38, s68, 0x38000
    buffer_load_dwordx4 v12, s[8:11], s38 offen lds
    s_waitcnt lgkmcnt(10)
    v_mfma_f32_32x32x16_bf16 v[112:127], v[60:63], v[220:223], v[112:127]
    ds_read_b64_tr_b16 v[52:53], v10 offset:51456
    ds_read_b64_tr_b16 v[54:55], v10 offset:51968
    s_waitcnt lgkmcnt(10)
    v_mfma_f32_32x32x16_bf16 v[64:79], v[32:35], v[224:227], v[64:79]
    ds_read_b64_tr_b16 v[56:57], v11 offset:51200
    ds_read_b64_tr_b16 v[58:59], v11 offset:51712
    v_and_b32 v5, 15, v2
    s_lshr_b32 s52, s36, 1
    s_lshl_b32 s52, s52, 8
    v_lshl_add_u32 v5, v5, 12, s52
    s_cmp_lg_u32 s32, 0
    s_cselect_b32 s94, 0x4000, 1
    s_lshl_b32 s94, s94, 16
    v_add_u32 v5, s94, v5
    v_mov_b32 v6, 0
    buffer_load_dword v6, v5, s[88:91], 0 offen sc1
    s_waitcnt lgkmcnt(10)
    v_mfma_f32_32x32x16_bf16 v[80:95], v[36:39], v[224:227], v[80:95]
    ds_read_b64_tr_b16 v[60:61], v11 offset:51456
    ds_read_b64_tr_b16 v[62:63], v11 offset:51968
    s_waitcnt lgkmcnt(10)
    v_mfma_f32_32x32x16_bf16 v[96:111], v[40:43], v[224:227], v[96:111]
    ds_read_b64_tr_b16 v[32:33], v10 offset:53248
    ds_read_b64_tr_b16 v[34:35], v10 offset:53760
    s_add_u32 m0, s87, 0x4000
    s_add_u32 s38, s69, 0x0
    buffer_load_dwordx4 v12, s[8:11], s38 offen lds
    s_waitcnt lgkmcnt(10)
    v_mfma_f32_32x32x16_bf16 v[112:127], v[44:47], v[224:227], v[112:127]
    ds_read_b64_tr_b16 v[36:37], v10 offset:53504
    ds_read_b64_tr_b16 v[38:39], v10 offset:54016
    s_waitcnt lgkmcnt(10)
    v_mfma_f32_32x32x16_bf16 v[64:79], v[48:51], v[228:231], v[64:79]
    ds_read_b64_tr_b16 v[40:41], v11 offset:53248
    ds_read_b64_tr_b16 v[42:43], v11 offset:53760
    s_add_u32 m0, s87, 0x6000
    s_add_u32 s38, s69, 0x38000
    buffer_load_dwordx4 v12, s[8:11], s38 offen lds
    s_waitcnt lgkmcnt(10)
    v_mfma_f32_32x32x16_bf16 v[80:95], v[52:55], v[228:231], v[80:95]
    ds_read_b64_tr_b16 v[44:45], v11 offset:53504
    ds_read_b64_tr_b16 v[46:47], v11 offset:54016
    s_waitcnt lgkmcnt(10)
    v_mfma_f32_32x32x16_bf16 v[96:111], v[56:59], v[228:231], v[96:111]
    ds_read_b64_tr_b16 v[48:49], v10 offset:55296
    ds_read_b64_tr_b16 v[50:51], v10 offset:55808
    s_add_u32 m0, s87, 0x8000
    s_add_u32 s38, s70, 0x0
    buffer_load_dwordx4 v12, s[8:11], s38 offen lds
    s_waitcnt lgkmcnt(10)
    v_mfma_f32_32x32x16_bf16 v[112:127], v[60:63], v[228:231], v[112:127]
    ds_read_b64_tr_b16 v[52:53], v10 offset:55552
    ds_read_b64_tr_b16 v[54:55], v10 offset:56064
    s_waitcnt vmcnt(13)
    s_waitcnt lgkmcnt(10)
    v_mfma_f32_32x32x16_bf16 v[64:79], v[32:35], v[232:235], v[64:79]
    ds_read_b64_tr_b16 v[56:57], v11 offset:55296
    ds_read_b64_tr_b16 v[58:59], v11 offset:55808
    s_waitcnt lgkmcnt(10)
    v_mfma_f32_32x32x16_bf16 v[80:95], v[36:39], v[232:235], v[80:95]
    ds_read_b64_tr_b16 v[60:61], v11 offset:55552
    ds_read_b64_tr_b16 v[62:63], v11 offset:56064
    s_waitcnt lgkmcnt(10)
    v_mfma_f32_32x32x16_bf16 v[96:111], v[40:43], v[232:235], v[96:111]
    s_waitcnt lgkmcnt(8)
    v_mfma_f32_32x32x16_bf16 v[112:127], v[44:47], v[232:235], v[112:127]
    s_waitcnt vmcnt(8) lgkmcnt(0)
    s_barrier
    ds_read_b64_tr_b16 v[32:33], v11 offset:57344
    ds_read_b64_tr_b16 v[34:35], v11 offset:57856
    ds_read_b64_tr_b16 v[36:37], v11 offset:57600
    ds_read_b64_tr_b16 v[38:39], v11 offset:58112
    ds_read_b64_tr_b16 v[40:41], v11 offset:59392
    ds_read_b64_tr_b16 v[42:43], v11 offset:59904
    ds_read_b64_tr_b16 v[44:45], v11 offset:59648
    ds_read_b64_tr_b16 v[46:47], v11 offset:60160
    v_mfma_f32_32x32x16_bf16 v[64:79], v[48:51], v[236:239], v[64:79]
    s_add_u32 m0, s87, 0xa000
    s_add_u32 s38, s70, 0x38000
    buffer_load_dwordx4 v12, s[8:11], s38 offen lds
    v_mfma_f32_32x32x16_bf16 v[80:95], v[52:55], v[236:239], v[80:95]
    v_mfma_f32_32x32x16_bf16 v[96:111], v[56:59], v[236:239], v[96:111]
    ds_read_b64_tr_b16 v[48:49], v11 offset:61440
    ds_read_b64_tr_b16 v[50:51], v11 offset:61952
    s_add_u32 m0, s87, 0xc000
    s_add_u32 s38, s71, 0x0
    buffer_load_dwordx4 v12, s[8:11], s38 offen lds
    v_mfma_f32_32x32x16_bf16 v[112:127], v[60:63], v[236:239], v[112:127]
    ds_read_b64_tr_b16 v[52:53], v11 offset:61696
    ds_read_b64_tr_b16 v[54:55], v11 offset:62208
    s_waitcnt lgkmcnt(10)
    v_mfma_f32_32x32x16_bf16 v[96:111], v[32:35], v[240:243], v[96:111]
    ds_read_b64_tr_b16 v[56:57], v11 offset:63488
    ds_read_b64_tr_b16 v[58:59], v11 offset:64000
    s_waitcnt lgkmcnt(10)
    v_mfma_f32_32x32x16_bf16 v[112:127], v[36:39], v[240:243], v[112:127]
    ds_read_b64_tr_b16 v[60:61], v11 offset:63744
    ds_read_b64_tr_b16 v[62:63], v11 offset:64256
    s_waitcnt lgkmcnt(10)
    v_mfma_f32_32x32x16_bf16 v[96:111], v[40:43], v[244:247], v[96:111]
    ds_read_b64_tr_b16 v[32:33], v10 offset:57344
    ds_read_b64_tr_b16 v[34:35], v10 offset:57856
    s_waitcnt lgkmcnt(10)
    v_mfma_f32_32x32x16_bf16 v[112:127], v[44:47], v[244:247], v[112:127]
    ds_read_b64_tr_b16 v[36:37], v10 offset:57600
    ds_read_b64_tr_b16 v[38:39], v10 offset:58112
    s_waitcnt vmcnt(9)
    s_waitcnt lgkmcnt(10)
    v_mfma_f32_32x32x16_bf16 v[96:111], v[48:51], v[248:251], v[96:111]
    ds_read_b64_tr_b16 v[40:41], v10 offset:59392
    ds_read_b64_tr_b16 v[42:43], v10 offset:59904
    s_waitcnt lgkmcnt(10)
    v_mfma_f32_32x32x16_bf16 v[112:127], v[52:55], v[248:251], v[112:127]
    ds_read_b64_tr_b16 v[44:45], v10 offset:59648
    ds_read_b64_tr_b16 v[46:47], v10 offset:60160
    s_waitcnt vmcnt(7)
    s_waitcnt lgkmcnt(10)
    v_mfma_f32_32x32x16_bf16 v[96:111], v[56:59], v[252:255], v[96:111]
    ds_read_b64_tr_b16 v[48:49], v10 offset:61440
    ds_read_b64_tr_b16 v[50:51], v10 offset:61952
    s_waitcnt lgkmcnt(10)
    v_mfma_f32_32x32x16_bf16 v[112:127], v[60:63], v[252:255], v[112:127]
    ds_read_b64_tr_b16 v[52:53], v10 offset:61696
    ds_read_b64_tr_b16 v[54:55], v10 offset:62208
    s_waitcnt lgkmcnt(10)
    v_mfma_f32_32x32x16_bf16 v[64:79], v[32:35], v[240:243], v[64:79]
    ds_read_b64_tr_b16 v[56:57], v10 offset:63488
    ds_read_b64_tr_b16 v[58:59], v10 offset:64000
    s_nop 1
    v_mul_f32 v96, 0x3e0293ee, v96
    v_mul_f32 v97, 0x3e0293ee, v97
    v_cvt_pk_bf16_f32 v16, v96, v97
    v_mul_f32 v98, 0x3e0293ee, v98
    v_mul_f32 v99, 0x3e0293ee, v99
    v_cvt_pk_bf16_f32 v17, v98, v99
    s_waitcnt lgkmcnt(10)
    v_mfma_f32_32x32x16_bf16 v[80:95], v[36:39], v[240:243], v[80:95]
    ds_read_b64_tr_b16 v[60:61], v10 offset:63744
    ds_read_b64_tr_b16 v[62:63], v10 offset:64256
    v_mul_f32 v100, 0x3e0293ee, v100
    v_mul_f32 v101, 0x3e0293ee, v101
    v_cvt_pk_bf16_f32 v18, v100, v101
    v_mul_f32 v102, 0x3e0293ee, v102
    v_mul_f32 v103, 0x3e0293ee, v103
    v_cvt_pk_bf16_f32 v19, v102, v103
    s_waitcnt lgkmcnt(10)
    v_mfma_f32_32x32x16_bf16 v[64:79], v[40:43], v[244:247], v[64:79]
    v_mul_f32 v104, 0x3e0293ee, v104
    v_mul_f32 v105, 0x3e0293ee, v105
    v_cvt_pk_bf16_f32 v20, v104, v105
    v_mul_f32 v106, 0x3e0293ee, v106
    v_mul_f32 v107, 0x3e0293ee, v107
    v_cvt_pk_bf16_f32 v21, v106, v107
    s_waitcnt lgkmcnt(8)
    v_mfma_f32_32x32x16_bf16 v[80:95], v[44:47], v[244:247], v[80:95]
    s_waitcnt vmcnt(2) lgkmcnt(0)
    s_cmp_lg_u32 s32, 0
    s_cbranch_scc1 .Lkvproj_kernel_chk_21
    v_cmp_ne_u32 vcc, 1, v6
    s_cbranch_vccz .Lkvproj_kernel_cok_22
    s_mov_b32 s52, 0x40000
.Lkvproj_kernel_poll_23:
    buffer_load_dword v6, v5, s[88:91], 0 offen sc1
    s_waitcnt vmcnt(0)
    v_cmp_ne_u32 vcc, 1, v6
    s_cbranch_vccz .Lkvproj_kernel_pdone_24
    s_sub_u32 s52, s52, 1
    s_sleep 2
    s_cmp_lg_u32 s52, 0
    s_cbranch_scc1 .Lkvproj_kernel_poll_23
.Lkvproj_kernel_pdone_24:
.Lkvproj_kernel_cok_22:
.Lkvproj_kernel_chk_21:
    s_barrier
    ds_read_b64_tr_b16 v[32:33], v10 offset:0
    ds_read_b64_tr_b16 v[34:35], v10 offset:512
    ds_read_b64_tr_b16 v[36:37], v10 offset:256
    ds_read_b64_tr_b16 v[38:39], v10 offset:768
    ds_read_b64_tr_b16 v[40:41], v10 offset:2048
    ds_read_b64_tr_b16 v[42:43], v10 offset:2560
    ds_read_b64_tr_b16 v[44:45], v10 offset:2304
    ds_read_b64_tr_b16 v[46:47], v10 offset:2816
    s_add_u32 m0, s87, 0xe000
    s_add_u32 s38, s71, 0x38000
    buffer_load_dwordx4 v12, s[8:11], s38 offen lds
    v_mul_f32 v108, 0x3e0293ee, v108
    v_mul_f32 v109, 0x3e0293ee, v109
    v_cvt_pk_bf16_f32 v22, v108, v109
    v_mul_f32 v110, 0x3e0293ee, v110
    v_mul_f32 v111, 0x3e0293ee, v111
    v_cvt_pk_bf16_f32 v23, v110, v111
    v_mfma_f32_32x32x16_bf16 v[64:79], v[48:51], v[248:251], v[64:79]
    v_mul_f32 v112, 0x3e0293ee, v112
    v_mul_f32 v113, 0x3e0293ee, v113
    v_cvt_pk_bf16_f32 v24, v112, v113
    v_mul_f32 v114, 0x3e0293ee, v114
    v_mul_f32 v115, 0x3e0293ee, v115
    v_cvt_pk_bf16_f32 v25, v114, v115
    v_mfma_f32_32x32x16_bf16 v[80:95], v[52:55], v[248:251], v[80:95]
    s_add_u32 m0, s87, 0x10000
    s_add_u32 s38, s72, 0x80
    buffer_load_dwordx4 v4, s[12:15], s38 offen lds
    v_mul_f32 v116, 0x3e0293ee, v116
    v_mul_f32 v117, 0x3e0293ee, v117
    v_cvt_pk_bf16_f32 v26, v116, v117
    v_mul_f32 v118, 0x3e0293ee, v118
    v_mul_f32 v119, 0x3e0293ee, v119
    v_cvt_pk_bf16_f32 v27, v118, v119
    v_mfma_f32_32x32x16_bf16 v[64:79], v[56:59], v[252:255], v[64:79]
    ds_read_b64_tr_b16 v[48:49], v10 offset:4096
    ds_read_b64_tr_b16 v[50:51], v10 offset:4608
    v_mul_f32 v120, 0x3e0293ee, v120
    v_mul_f32 v121, 0x3e0293ee, v121
    v_cvt_pk_bf16_f32 v28, v120, v121
    v_mul_f32 v122, 0x3e0293ee, v122
    v_mul_f32 v123, 0x3e0293ee, v123
    v_cvt_pk_bf16_f32 v29, v122, v123
    v_mfma_f32_32x32x16_bf16 v[80:95], v[60:63], v[252:255], v[80:95]
    ds_read_b64_tr_b16 v[52:53], v10 offset:4352
    ds_read_b64_tr_b16 v[54:55], v10 offset:4864
    s_add_u32 m0, s87, 0x12000
    s_add_u32 s38, s72, 0x80080
    buffer_load_dwordx4 v4, s[12:15], s38 offen lds
    v_mul_f32 v124, 0x3e0293ee, v124
    v_mul_f32 v125, 0x3e0293ee, v125
    v_cvt_pk_bf16_f32 v30, v124, v125
    v_mul_f32 v126, 0x3e0293ee, v126
    v_mul_f32 v127, 0x3e0293ee, v127
    v_cvt_pk_bf16_f32 v31, v126, v127
    s_waitcnt lgkmcnt(10)
    v_mfma_f32_32x32x16_bf16 v[96:111], v[32:35], v[128:131], 0
    ds_read_b64_tr_b16 v[56:57], v10 offset:6144
    ds_read_b64_tr_b16 v[58:59], v10 offset:6656
    s_waitcnt lgkmcnt(10)
    v_mfma_f32_32x32x16_bf16 v[112:127], v[36:39], v[128:131], 0
    ds_read_b64_tr_b16 v[60:61], v10 offset:6400
    ds_read_b64_tr_b16 v[62:63], v10 offset:6912
    s_add_u32 m0, s87, 0x14000
    s_add_u32 s38, s73, 0x80
    buffer_load_dwordx4 v4, s[12:15], s38 offen lds
    s_waitcnt lgkmcnt(10)
    v_mfma_f32_32x32x16_bf16 v[96:111], v[40:43], v[132:135], v[96:111]
    ds_read_b64_tr_b16 v[32:33], v10 offset:8192
    ds_read_b64_tr_b16 v[34:35], v10 offset:8704
    s_waitcnt lgkmcnt(10)
    v_mfma_f32_32x32x16_bf16 v[112:127], v[44:47], v[132:135], v[112:127]
    ds_read_b64_tr_b16 v[36:37], v10 offset:8448
    ds_read_b64_tr_b16 v[38:39], v10 offset:8960
    s_add_u32 m0, s87, 0x16000
    s_add_u32 s38, s73, 0x80080
    buffer_load_dwordx4 v4, s[12:15], s38 offen lds
    s_waitcnt lgkmcnt(10)
    v_mfma_f32_32x32x16_bf16 v[96:111], v[48:51], v[136:139], v[96:111]
    ds_read_b64_tr_b16 v[40:41], v10 offset:10240
    ds_read_b64_tr_b16 v[42:43], v10 offset:10752
    v_cvt_pk_bf16_f32 v92, v92, v93
    v_cvt_pk_bf16_f32 v94, v94, v95
    v_and_b32 v93, 0xffff0000, v92
    v_lshlrev_b32 v92, 16, v92
    s_waitcnt lgkmcnt(10)
    v_mfma_f32_32x32x16_bf16 v[112:127], v[52:55], v[136:139], v[112:127]
    ds_read_b64_tr_b16 v[44:45], v10 offset:10496
    ds_read_b64_tr_b16 v[46:47], v10 offset:11008
    s_add_u32 m0, s87, 0x18000
    s_add_u32 s38, s74, 0x80
    buffer_load_dwordx4 v4, s[12:15], s38 offen lds
    v_and_b32 v95, 0xffff0000, v94
    v_lshlrev_b32 v94, 16, v94
    v_mul_f32 v92, 0xbfb8aa3b, v92
    v_mul_f32 v93, 0xbfb8aa3b, v93
    s_waitcnt lgkmcnt(10)
    v_mfma_f32_32x32x16_bf16 v[96:111], v[56:59], v[140:143], v[96:111]
    ds_read_b64_tr_b16 v[48:49], v10 offset:12288
    ds_read_b64_tr_b16 v[50:51], v10 offset:12800
    v_mul_f32 v94, 0xbfb8aa3b, v94
    v_mul_f32 v95, 0xbfb8aa3b, v95
    v_exp_f32 v92, v92
    v_exp_f32 v93, v93
    s_waitcnt lgkmcnt(10)
    v_mfma_f32_32x32x16_bf16 v[112:127], v[60:63], v[140:143], v[112:127]
    ds_read_b64_tr_b16 v[52:53], v10 offset:12544
    ds_read_b64_tr_b16 v[54:55], v10 offset:13056
    s_add_u32 m0, s87, 0x1a000
    s_add_u32 s38, s74, 0x80080
    buffer_load_dwordx4 v4, s[12:15], s38 offen lds
    v_exp_f32 v94, v94
    v_exp_f32 v95, v95
    v_add_f32 v92, 1.0, v92
    s_waitcnt lgkmcnt(10)
    v_mfma_f32_32x32x16_bf16 v[96:111], v[32:35], v[144:147], v[96:111]
    ds_read_b64_tr_b16 v[56:57], v10 offset:14336
    ds_read_b64_tr_b16 v[58:59], v10 offset:14848
    v_add_f32 v93, 1.0, v93
    v_add_f32 v94, 1.0, v94
    v_add_f32 v95, 1.0, v95
    v_rcp_f32 v92, v92
    s_waitcnt lgkmcnt(10)
    v_mfma_f32_32x32x16_bf16 v[112:127], v[36:39], v[144:147], v[112:127]
    ds_read_b64_tr_b16 v[60:61], v10 offset:14592
    ds_read_b64_tr_b16 v[62:63], v10 offset:15104
    s_add_u32 m0, s87, 0x1c000
    s_add_u32 s38, s75, 0x80
    buffer_load_dwordx4 v4, s[12:15], s38 offen lds
    v_rcp_f32 v93, v93
    v_rcp_f32 v94, v94
    v_rcp_f32 v95, v95
    s_nop 0
    s_waitcnt lgkmcnt(10)
    v_mfma_f32_32x32x16_bf16 v[96:111], v[40:43], v[148:151], v[96:111]
    ds_read_b64_tr_b16 v[32:33], v10 offset:16384
    ds_read_b64_tr_b16 v[34:35], v10 offset:16896
    v_cvt_pk_bf16_f32 v95, v94, v95
    v_cvt_pk_bf16_f32 v94, v92, v93
    v_cvt_pk_bf16_f32 v88, v88, v89
    s_waitcnt lgkmcnt(10)
    v_mfma_f32_32x32x16_bf16 v[112:127], v[44:47], v[148:151], v[112:127]
    ds_read_b64_tr_b16 v[36:37], v10 offset:16640
    ds_read_b64_tr_b16 v[38:39], v10 offset:17152
    s_add_u32 m0, s87, 0x1e000
    s_add_u32 s38, s75, 0x80080
    buffer_load_dwordx4 v4, s[12:15], s38 offen lds
    v_cvt_pk_bf16_f32 v90, v90, v91
    v_and_b32 v89, 0xffff0000, v88
    v_lshlrev_b32 v88, 16, v88
    v_and_b32 v91, 0xffff0000, v90
    s_waitcnt lgkmcnt(10)
    v_mfma_f32_32x32x16_bf16 v[96:111], v[48:51], v[152:155], v[96:111]
    ds_read_b64_tr_b16 v[40:41], v10 offset:18432
    ds_read_b64_tr_b16 v[42:43], v10 offset:18944
    v_lshlrev_b32 v90, 16, v90
    v_mul_f32 v88, 0xbfb8aa3b, v88
    v_mul_f32 v89, 0xbfb8aa3b, v89
    v_mul_f32 v90, 0xbfb8aa3b, v90
    s_waitcnt lgkmcnt(10)
    v_mfma_f32_32x32x16_bf16 v[112:127], v[52:55], v[152:155], v[112:127]
    ds_read_b64_tr_b16 v[44:45], v10 offset:18688
    ds_read_b64_tr_b16 v[46:47], v10 offset:19200
    v_mul_f32 v91, 0xbfb8aa3b, v91
    v_exp_f32 v88, v88
    v_exp_f32 v89, v89
    v_exp_f32 v90, v90
    s_waitcnt lgkmcnt(10)
    v_mfma_f32_32x32x16_bf16 v[96:111], v[56:59], v[156:159], v[96:111]
    ds_read_b64_tr_b16 v[48:49], v10 offset:20480
    ds_read_b64_tr_b16 v[50:51], v10 offset:20992
    v_exp_f32 v91, v91
    v_add_f32 v88, 1.0, v88
    v_add_f32 v89, 1.0, v89
    s_waitcnt lgkmcnt(10)
    v_mfma_f32_32x32x16_bf16 v[112:127], v[60:63], v[156:159], v[112:127]
    ds_read_b64_tr_b16 v[52:53], v10 offset:20736
    ds_read_b64_tr_b16 v[54:55], v10 offset:21248
    v_add_f32 v90, 1.0, v90
    v_add_f32 v91, 1.0, v91
    v_rcp_f32 v88, v88
    v_rcp_f32 v89, v89
    s_waitcnt lgkmcnt(10)
    v_mfma_f32_32x32x16_bf16 v[96:111], v[32:35], v[160:163], v[96:111]
    ds_read_b64_tr_b16 v[56:57], v10 offset:22528
    ds_read_b64_tr_b16 v[58:59], v10 offset:23040
    v_add_u32 v9, s86, v3
    v_lshlrev_b32 v1, 7, v2
    v_add_u32 v1, s85, v1
    buffer_load_dword v1, v1, s[24:27], s84 offen
    v_rcp_f32 v90, v90
    v_rcp_f32 v91, v91
    s_nop 0
    v_cvt_pk_bf16_f32 v93, v90, v91
    s_waitcnt lgkmcnt(10)
    v_mfma_f32_32x32x16_bf16 v[112:127], v[36:39], v[160:163], v[112:127]
    ds_read_b64_tr_b16 v[60:61], v10 offset:22784
    ds_read_b64_tr_b16 v[62:63], v10 offset:23296
    v_cvt_pk_bf16_f32 v92, v88, v89
    v_cvt_pk_bf16_f32 v84, v84, v85
    v_cvt_pk_bf16_f32 v86, v86, v87
    s_waitcnt lgkmcnt(10)
    v_mfma_f32_32x32x16_bf16 v[96:111], v[40:43], v[164:167], v[96:111]
    ds_read_b64_tr_b16 v[32:33], v10 offset:24576
    ds_read_b64_tr_b16 v[34:35], v10 offset:25088
    v_and_b32 v85, 0xffff0000, v84
    v_lshlrev_b32 v84, 16, v84
    v_and_b32 v87, 0xffff0000, v86
    v_lshlrev_b32 v86, 16, v86
    s_waitcnt lgkmcnt(10)
    v_mfma_f32_32x32x16_bf16 v[112:127], v[44:47], v[164:167], v[112:127]
    ds_read_b64_tr_b16 v[36:37], v10 offset:24832
    ds_read_b64_tr_b16 v[38:39], v10 offset:25344
    v_mul_f32 v84, 0xbfb8aa3b, v84
    v_mul_f32 v85, 0xbfb8aa3b, v85
    v_mul_f32 v86, 0xbfb8aa3b, v86
    v_mul_f32 v87, 0xbfb8aa3b, v87
    s_waitcnt lgkmcnt(10)
    v_mfma_f32_32x32x16_bf16 v[96:111], v[48:51], v[168:171], v[96:111]
    ds_read_b64_tr_b16 v[40:41], v10 offset:26624
    ds_read_b64_tr_b16 v[42:43], v10 offset:27136
    v_exp_f32 v84, v84
    v_exp_f32 v85, v85
    v_exp_f32 v86, v86
    s_waitcnt lgkmcnt(10)
    v_mfma_f32_32x32x16_bf16 v[112:127], v[52:55], v[168:171], v[112:127]
    ds_read_b64_tr_b16 v[44:45], v10 offset:26880
    ds_read_b64_tr_b16 v[46:47], v10 offset:27392
    v_exp_f32 v87, v87
    v_add_f32 v84, 1.0, v84
    v_add_f32 v85, 1.0, v85
    v_add_f32 v86, 1.0, v86
    s_waitcnt lgkmcnt(10)
    v_mfma_f32_32x32x16_bf16 v[96:111], v[56:59], v[172:175], v[96:111]
    ds_read_b64_tr_b16 v[48:49], v10 offset:28672
    ds_read_b64_tr_b16 v[50:51], v10 offset:29184
    v_add_f32 v87, 1.0, v87
    v_rcp_f32 v84, v84
    v_rcp_f32 v85, v85
    v_rcp_f32 v86, v86
    s_waitcnt lgkmcnt(10)
    v_mfma_f32_32x32x16_bf16 v[112:127], v[60:63], v[172:175], v[112:127]
    ds_read_b64_tr_b16 v[52:53], v10 offset:28928
    ds_read_b64_tr_b16 v[54:55], v10 offset:29440
    v_rcp_f32 v87, v87
    s_nop 0
    v_cvt_pk_bf16_f32 v91, v86, v87
    v_cvt_pk_bf16_f32 v90, v84, v85
    s_waitcnt lgkmcnt(10)
    v_mfma_f32_32x32x16_bf16 v[96:111], v[32:35], v[176:179], v[96:111]
    ds_read_b64_tr_b16 v[56:57], v10 offset:30720
    ds_read_b64_tr_b16 v[58:59], v10 offset:31232
    v_cvt_pk_bf16_f32 v80, v80, v81
    v_cvt_pk_bf16_f32 v82, v82, v83
    v_and_b32 v81, 0xffff0000, v80
    s_waitcnt lgkmcnt(10)
    v_mfma_f32_32x32x16_bf16 v[112:127], v[36:39], v[176:179], v[112:127]
    ds_read_b64_tr_b16 v[60:61], v10 offset:30976
    ds_read_b64_tr_b16 v[62:63], v10 offset:31488
    v_lshlrev_b32 v80, 16, v80
    v_and_b32 v83, 0xffff0000, v82
    v_lshlrev_b32 v82, 16, v82
    v_mul_f32 v80, 0xbfb8aa3b, v80
    s_waitcnt lgkmcnt(10)
    v_mfma_f32_32x32x16_bf16 v[96:111], v[40:43], v[180:183], v[96:111]
    ds_read_b64_tr_b16 v[32:33], v10 offset:32768
    ds_read_b64_tr_b16 v[34:35], v10 offset:33280
    v_mul_f32 v81, 0xbfb8aa3b, v81
    v_mul_f32 v82, 0xbfb8aa3b, v82
    v_mul_f32 v83, 0xbfb8aa3b, v83
    v_exp_f32 v80, v80
    s_waitcnt lgkmcnt(10)
    v_mfma_f32_32x32x16_bf16 v[112:127], v[44:47], v[180:183], v[112:127]
    ds_read_b64_tr_b16 v[36:37], v10 offset:33024
    ds_read_b64_tr_b16 v[38:39], v10 offset:33536
    v_exp_f32 v81, v81
    v_exp_f32 v82, v82
    v_exp_f32 v83, v83
    s_waitcnt lgkmcnt(10)
    v_mfma_f32_32x32x16_bf16 v[96:111], v[48:51], v[184:187], v[96:111]
    ds_read_b64_tr_b16 v[40:41], v10 offset:34816
    ds_read_b64_tr_b16 v[42:43], v10 offset:35328
    v_add_f32 v80, 1.0, v80
    v_add_f32 v81, 1.0, v81
    v_add_f32 v82, 1.0, v82
    v_add_f32 v83, 1.0, v83
    s_waitcnt lgkmcnt(10)
    v_mfma_f32_32x32x16_bf16 v[112:127], v[52:55], v[184:187], v[112:127]
    ds_read_b64_tr_b16 v[44:45], v10 offset:35072
    ds_read_b64_tr_b16 v[46:47], v10 offset:35584
    v_rcp_f32 v80, v80
    v_rcp_f32 v81, v81
    v_rcp_f32 v82, v82
    v_rcp_f32 v83, v83
    s_waitcnt lgkmcnt(10)
    v_mfma_f32_32x32x16_bf16 v[96:111], v[56:59], v[188:191], v[96:111]
    ds_read_b64_tr_b16 v[48:49], v10 offset:36864
    ds_read_b64_tr_b16 v[50:51], v10 offset:37376
    s_nop 0
    v_cvt_pk_bf16_f32 v89, v82, v83
    v_cvt_pk_bf16_f32 v88, v80, v81
    s_waitcnt lgkmcnt(10)
    v_mfma_f32_32x32x16_bf16 v[112:127], v[60:63], v[188:191], v[112:127]
    ds_read_b64_tr_b16 v[52:53], v10 offset:37120
    ds_read_b64_tr_b16 v[54:55], v10 offset:37632
    v_cvt_pk_bf16_f32 v76, v76, v77
    v_cvt_pk_bf16_f32 v78, v78, v79
    v_and_b32 v77, 0xffff0000, v76
    v_lshlrev_b32 v76, 16, v76
    s_waitcnt lgkmcnt(10)
    v_mfma_f32_32x32x16_bf16 v[96:111], v[32:35], v[192:195], v[96:111]
    ds_read_b64_tr_b16 v[56:57], v10 offset:38912
    ds_read_b64_tr_b16 v[58:59], v10 offset:39424
    v_and_b32 v79, 0xffff0000, v78
    v_lshlrev_b32 v78, 16, v78
    v_mul_f32 v76, 0xbfb8aa3b, v76
    v_mul_f32 v77, 0xbfb8aa3b, v77
    s_waitcnt lgkmcnt(10)
    v_mfma_f32_32x32x16_bf16 v[112:127], v[36:39], v[192:195], v[112:127]
    ds_read_b64_tr_b16 v[60:61], v10 offset:39168
    ds_read_b64_tr_b16 v[62:63], v10 offset:39680
    v_mul_f32 v78, 0xbfb8aa3b, v78
    v_mul_f32 v79, 0xbfb8aa3b, v79
    v_exp_f32 v76, v76
    v_exp_f32 v77, v77
    s_waitcnt lgkmcnt(10)
    v_mfma_f32_32x32x16_bf16 v[96:111], v[40:43], v[196:199], v[96:111]
    v_exp_f32 v78, v78
    v_exp_f32 v79, v79
    v_add_f32 v76, 1.0, v76
    s_waitcnt lgkmcnt(8)
    v_mfma_f32_32x32x16_bf16 v[112:127], v[44:47], v[196:199], v[112:127]
    s_waitcnt vmcnt(9)
    s_barrier
    ds_read_b64_tr_b16 v[32:33], v10 offset:40960
    ds_read_b64_tr_b16 v[34:35], v10 offset:41472
    ds_read_b64_tr_b16 v[36:37], v10 offset:41216
    ds_read_b64_tr_b16 v[38:39], v10 offset:41728
    ds_read_b64_tr_b16 v[40:41], v10 offset:43008
    ds_read_b64_tr_b16 v[42:43], v10 offset:43520
    ds_read_b64_tr_b16 v[44:45], v10 offset:43264
    ds_read_b64_tr_b16 v[46:47], v10 offset:43776
    v_add_f32 v77, 1.0, v77
    v_add_f32 v78, 1.0, v78
    v_add_f32 v79, 1.0, v79
    v_rcp_f32 v76, v76
    s_waitcnt lgkmcnt(14)
    v_mfma_f32_32x32x16_bf16 v[96:111], v[48:51], v[200:203], v[96:111]
    v_rcp_f32 v77, v77
    v_rcp_f32 v78, v78
    v_rcp_f32 v79, v79
    s_nop 0
    s_waitcnt lgkmcnt(12)
    v_mfma_f32_32x32x16_bf16 v[112:127], v[52:55], v[200:203], v[112:127]
    v_cvt_pk_bf16_f32 v87, v78, v79
    v_cvt_pk_bf16_f32 v86, v76, v77
    v_cvt_pk_bf16_f32 v72, v72, v73
    s_waitcnt lgkmcnt(10)
    v_mfma_f32_32x32x16_bf16 v[96:111], v[56:59], v[204:207], v[96:111]
    ds_read_b64_tr_b16 v[48:49], v10 offset:45056
    ds_read_b64_tr_b16 v[50:51], v10 offset:45568
    v_cvt_pk_bf16_f32 v74, v74, v75
    v_and_b32 v73, 0xffff0000, v72
    v_lshlrev_b32 v72, 16, v72
    v_and_b32 v75, 0xffff0000, v74
    s_waitcnt lgkmcnt(10)
    v_mfma_f32_32x32x16_bf16 v[112:127], v[60:63], v[204:207], v[112:127]
    ds_read_b64_tr_b16 v[52:53], v10 offset:45312
    ds_read_b64_tr_b16 v[54:55], v10 offset:45824
    v_lshlrev_b32 v74, 16, v74
    v_mul_f32 v72, 0xbfb8aa3b, v72
    v_mul_f32 v73, 0xbfb8aa3b, v73
    v_mul_f32 v74, 0xbfb8aa3b, v74
    s_waitcnt lgkmcnt(10)
    v_mfma_f32_32x32x16_bf16 v[96:111], v[32:35], v[208:211], v[96:111]
    ds_read_b64_tr_b16 v[56:57], v10 offset:47104
    ds_read_b64_tr_b16 v[58:59], v10 offset:47616
    v_mul_f32 v75, 0xbfb8aa3b, v75
    v_exp_f32 v72, v72
    v_exp_f32 v73, v73
    v_exp_f32 v74, v74
    s_waitcnt lgkmcnt(10)
    v_mfma_f32_32x32x16_bf16 v[112:127], v[36:39], v[208:211], v[112:127]
    ds_read_b64_tr_b16 v[60:61], v10 offset:47360
    ds_read_b64_tr_b16 v[62:63], v10 offset:47872
    v_exp_f32 v75, v75
    v_add_f32 v72, 1.0, v72
    v_add_f32 v73, 1.0, v73
    s_waitcnt lgkmcnt(10)
    v_mfma_f32_32x32x16_bf16 v[96:111], v[40:43], v[212:215], v[96:111]
    ds_read_b64_tr_b16 v[32:33], v10 offset:49152
    ds_read_b64_tr_b16 v[34:35], v10 offset:49664
    v_add_f32 v74, 1.0, v74
    v_add_f32 v75, 1.0, v75
    v_rcp_f32 v72, v72
    v_rcp_f32 v73, v73
    s_waitcnt lgkmcnt(10)
    v_mfma_f32_32x32x16_bf16 v[112:127], v[44:47], v[212:215], v[112:127]
    ds_read_b64_tr_b16 v[36:37], v10 offset:49408
    ds_read_b64_tr_b16 v[38:39], v10 offset:49920
    v_rcp_f32 v74, v74
    v_rcp_f32 v75, v75
    s_nop 0
    v_cvt_pk_bf16_f32 v85, v74, v75
    s_waitcnt lgkmcnt(10)
    v_mfma_f32_32x32x16_bf16 v[96:111], v[48:51], v[216:219], v[96:111]
    ds_read_b64_tr_b16 v[40:41], v10 offset:51200
    ds_read_b64_tr_b16 v[42:43], v10 offset:51712
    v_cvt_pk_bf16_f32 v84, v72, v73
    v_cvt_pk_bf16_f32 v68, v68, v69
    v_cvt_pk_bf16_f32 v70, v70, v71
    s_waitcnt lgkmcnt(10)
    v_mfma_f32_32x32x16_bf16 v[112:127], v[52:55], v[216:219], v[112:127]
    ds_read_b64_tr_b16 v[44:45], v10 offset:51456
    ds_read_b64_tr_b16 v[46:47], v10 offset:51968
    v_and_b32 v69, 0xffff0000, v68
    v_lshlrev_b32 v68, 16, v68
    v_and_b32 v71, 0xffff0000, v70
    v_lshlrev_b32 v70, 16, v70
    s_waitcnt lgkmcnt(10)
    v_mfma_f32_32x32x16_bf16 v[96:111], v[56:59], v[220:223], v[96:111]
    ds_read_b64_tr_b16 v[48:49], v10 offset:53248
    ds_read_b64_tr_b16 v[50:51], v10 offset:53760
    v_mul_f32 v68, 0xbfb8aa3b, v68
    v_mul_f32 v69, 0xbfb8aa3b, v69
    v_mul_f32 v70, 0xbfb8aa3b, v70
    v_mul_f32 v71, 0xbfb8aa3b, v71
    s_waitcnt lgkmcnt(10)
    v_mfma_f32_32x32x16_bf16 v[112:127], v[60:63], v[220:223], v[112:127]
    ds_read_b64_tr_b16 v[52:53], v10 offset:53504
    ds_read_b64_tr_b16 v[54:55], v10 offset:54016
    v_exp_f32 v68, v68
    v_exp_f32 v69, v69
    v_exp_f32 v70, v70
    s_waitcnt lgkmcnt(10)
    v_mfma_f32_32x32x16_bf16 v[96:111], v[32:35], v[224:227], v[96:111]
    ds_read_b64_tr_b16 v[56:57], v10 offset:55296
    ds_read_b64_tr_b16 v[58:59], v10 offset:55808
    v_exp_f32 v71, v71
    v_add_f32 v68, 1.0, v68
    v_add_f32 v69, 1.0, v69
    v_add_f32 v70, 1.0, v70
    s_waitcnt lgkmcnt(10)
    v_mfma_f32_32x32x16_bf16 v[112:127], v[36:39], v[224:227], v[112:127]
    ds_read_b64_tr_b16 v[60:61], v10 offset:55552
    ds_read_b64_tr_b16 v[62:63], v10 offset:56064
    v_add_f32 v71, 1.0, v71
    v_rcp_f32 v68, v68
    v_rcp_f32 v69, v69
    v_rcp_f32 v70, v70
    s_waitcnt lgkmcnt(10)
    v_mfma_f32_32x32x16_bf16 v[96:111], v[40:43], v[228:231], v[96:111]
    ds_read_b64_tr_b16 v[32:33], v10 offset:57344
    ds_read_b64_tr_b16 v[34:35], v10 offset:57856
    v_rcp_f32 v71, v71
    s_nop 0
    v_cvt_pk_bf16_f32 v83, v70, v71
    v_cvt_pk_bf16_f32 v82, v68, v69
    s_waitcnt lgkmcnt(10)
    v_mfma_f32_32x32x16_bf16 v[112:127], v[44:47], v[228:231], v[112:127]
    ds_read_b64_tr_b16 v[36:37], v10 offset:57600
    ds_read_b64_tr_b16 v[38:39], v10 offset:58112
    v_cvt_pk_bf16_f32 v64, v64, v65
    v_cvt_pk_bf16_f32 v66, v66, v67
    v_and_b32 v65, 0xffff0000, v64
    s_waitcnt lgkmcnt(10)
    v_mfma_f32_32x32x16_bf16 v[96:111], v[48:51], v[232:235], v[96:111]
    ds_read_b64_tr_b16 v[40:41], v10 offset:59392
    ds_read_b64_tr_b16 v[42:43], v10 offset:59904
    v_lshlrev_b32 v64, 16, v64
    v_and_b32 v67, 0xffff0000, v66
    v_lshlrev_b32 v66, 16, v66
    v_mul_f32 v64, 0xbfb8aa3b, v64
    s_waitcnt lgkmcnt(10)
    v_mfma_f32_32x32x16_bf16 v[112:127], v[52:55], v[232:235], v[112:127]
    ds_read_b64_tr_b16 v[44:45], v10 offset:59648
    ds_read_b64_tr_b16 v[46:47], v10 offset:60160
    v_mul_f32 v65, 0xbfb8aa3b, v65
    v_mul_f32 v66, 0xbfb8aa3b, v66
    v_mul_f32 v67, 0xbfb8aa3b, v67
    v_exp_f32 v64, v64
    s_waitcnt lgkmcnt(10)
    v_mfma_f32_32x32x16_bf16 v[96:111], v[56:59], v[236:239], v[96:111]
    ds_read_b64_tr_b16 v[48:49], v10 offset:61440
    ds_read_b64_tr_b16 v[50:51], v10 offset:61952
    v_exp_f32 v65, v65
    v_exp_f32 v66, v66
    v_exp_f32 v67, v67
    s_waitcnt lgkmcnt(10)
    v_mfma_f32_32x32x16_bf16 v[112:127], v[60:63], v[236:239], v[112:127]
    ds_read_b64_tr_b16 v[52:53], v10 offset:61696
    ds_read_b64_tr_b16 v[54:55], v10 offset:62208
    v_add_f32 v64, 1.0, v64
    v_add_f32 v65, 1.0, v65
    v_add_f32 v66, 1.0, v66
    v_add_f32 v67, 1.0, v67
    s_waitcnt lgkmcnt(10)
    v_mfma_f32_32x32x16_bf16 v[96:111], v[32:35], v[240:243], v[96:111]
    ds_read_b64_tr_b16 v[56:57], v10 offset:63488
    ds_read_b64_tr_b16 v[58:59], v10 offset:64000
    v_rcp_f32 v64, v64
    v_rcp_f32 v65, v65
    v_rcp_f32 v66, v66
    v_rcp_f32 v67, v67
    s_waitcnt lgkmcnt(10)
    v_mfma_f32_32x32x16_bf16 v[112:127], v[36:39], v[240:243], v[112:127]
    ds_read_b64_tr_b16 v[60:61], v10 offset:63744
    ds_read_b64_tr_b16 v[62:63], v10 offset:64256
    s_nop 0
    v_cvt_pk_bf16_f32 v81, v66, v67
    v_cvt_pk_bf16_f32 v80, v64, v65
    s_waitcnt lgkmcnt(10)
    v_mfma_f32_32x32x16_bf16 v[96:111], v[40:43], v[244:247], v[96:111]
    s_waitcnt lgkmcnt(8)
    v_mfma_f32_32x32x16_bf16 v[112:127], v[44:47], v[244:247], v[112:127]
    s_waitcnt vmcnt(1) lgkmcnt(0)
    s_barrier
    ds_read_b64_tr_b16 v[32:33], v11 offset:0
    ds_read_b64_tr_b16 v[34:35], v11 offset:512
    ds_read_b64_tr_b16 v[36:37], v11 offset:2048
    ds_read_b64_tr_b16 v[38:39], v11 offset:2560
    ds_read_b64_tr_b16 v[40:41], v11 offset:4096
    ds_read_b64_tr_b16 v[42:43], v11 offset:4608
    ds_read_b64_tr_b16 v[44:45], v11 offset:6144
    ds_read_b64_tr_b16 v[46:47], v11 offset:6656
    v_mfma_f32_32x32x16_bf16 v[96:111], v[48:51], v[248:251], v[96:111]
    v_mfma_f32_32x32x16_bf16 v[112:127], v[52:55], v[248:251], v[112:127]
    v_mfma_f32_32x32x16_bf16 v[96:111], v[56:59], v[252:255], v[96:111]
    ds_read_b64_tr_b16 v[48:49], v11 offset:8192
    ds_read_b64_tr_b16 v[50:51], v11 offset:8704
    v_mfma_f32_32x32x16_bf16 v[112:127], v[60:63], v[252:255], v[112:127]
    ds_read_b64_tr_b16 v[52:53], v11 offset:10240
    ds_read_b64_tr_b16 v[54:55], v11 offset:10752
    s_waitcnt lgkmcnt(10)
    v_mfma_f32_32x32x16_bf16 v[64:79], v[32:35], v[128:131], 0
    ds_read_b64_tr_b16 v[56:57], v11 offset:12288
    ds_read_b64_tr_b16 v[58:59], v11 offset:12800
    s_add_u32 s54, s44, 0
    s_add_u32 s55, s54, s46
    s_cmp_lt_u32 s54, s45
    s_cselect_b32 s55, s54, s55
    s_lshl_b32 s55, s55, 15
    s_add_u32 s55, s55, s47
    s_sub_u32 s54, s54, s56
    s_cmp_le_u32 s54, s57
    s_cselect_b32 s60, 1, 0
    s_waitcnt lgkmcnt(10)
    v_mfma_f32_32x32x16_bf16 v[64:79], v[36:39], v[132:135], v[64:79]
    ds_read_b64_tr_b16 v[60:61], v11 offset:14336
    ds_read_b64_tr_b16 v[62:63], v11 offset:14848
    s_cmp_eq_u32 s60, 0
    s_cbranch_scc1 .Lk2_g0
    s_add_u32 m0, s48, 0x0
    s_add_u32 s38, s55, 0x0
    buffer_load_dwordx4 v15, s[24:27], s38 offen offset:0 lds
    buffer_load_dwordx4 v15, s[24:27], s38 offen offset:1024 lds
    buffer_load_dwordx4 v15, s[24:27], s38 offen offset:2048 lds
    buffer_load_dwordx4 v15, s[24:27], s38 offen offset:3072 lds
.Lk2_g0:
    s_waitcnt lgkmcnt(10)
    v_mfma_f32_32x32x16_bf16 v[64:79], v[40:43], v[136:139], v[64:79]
    ds_read_b64_tr_b16 v[32:33], v11 offset:16384
    ds_read_b64_tr_b16 v[34:35], v11 offset:16896
    v_cvt_pk_bf16_f32 v97, v96, v97
    v_lshlrev_b32 v96, 16, v97
    v_and_b32 v97, 0xffff0000, v97
    v_lshlrev_b32 v5, 16, v80
    s_waitcnt lgkmcnt(10)
    v_mfma_f32_32x32x16_bf16 v[64:79], v[44:47], v[140:143], v[64:79]
    ds_read_b64_tr_b16 v[36:37], v11 offset:18432
    ds_read_b64_tr_b16 v[38:39], v11 offset:18944
    v_and_b32 v6, 0xffff0000, v80
    v_mul_f32 v96, v5, v96
    v_mul_f32 v97, v6, v97
    s_waitcnt lgkmcnt(10)
    v_mfma_f32_32x32x16_bf16 v[64:79], v[48:51], v[144:147], v[64:79]
    ds_read_b64_tr_b16 v[40:41], v11 offset:20480
    ds_read_b64_tr_b16 v[42:43], v11 offset:20992
    v_cvt_pk_bf16_f32 v80, v96, v97
    v_cvt_pk_bf16_f32 v99, v98, v99
    v_lshlrev_b32 v98, 16, v99
    v_and_b32 v99, 0xffff0000, v99
    s_waitcnt lgkmcnt(10)
    v_mfma_f32_32x32x16_bf16 v[64:79], v[52:55], v[148:151], v[64:79]
    ds_read_b64_tr_b16 v[44:45], v11 offset:22528
    ds_read_b64_tr_b16 v[46:47], v11 offset:23040
    v_lshlrev_b32 v5, 16, v81
    v_and_b32 v6, 0xffff0000, v81
    v_mul_f32 v98, v5, v98
    s_cmp_eq_u32 s60, 0
    s_cbranch_scc1 .Lk2_g1
    s_add_u32 m0, s48, 0x1000
    s_add_u32 s38, s55, 0x1000
    buffer_load_dwordx4 v15, s[24:27], s38 offen offset:0 lds
    buffer_load_dwordx4 v15, s[24:27], s38 offen offset:1024 lds
    buffer_load_dwordx4 v15, s[24:27], s38 offen offset:2048 lds
    buffer_load_dwordx4 v15, s[24:27], s38 offen offset:3072 lds
.Lk2_g1:
    s_waitcnt lgkmcnt(10)
    v_mfma_f32_32x32x16_bf16 v[64:79], v[56:59], v[152:155], v[64:79]
    ds_read_b64_tr_b16 v[48:49], v11 offset:24576
    ds_read_b64_tr_b16 v[50:51], v11 offset:25088
    v_mul_f32 v99, v6, v99
    v_cvt_pk_bf16_f32 v81, v98, v99
    v_cvt_pk_bf16_f32 v101, v100, v101
    v_lshlrev_b32 v100, 16, v101
    s_waitcnt lgkmcnt(10)
    v_mfma_f32_32x32x16_bf16 v[64:79], v[60:63], v[156:159], v[64:79]
    ds_read_b64_tr_b16 v[52:53], v11 offset:26624
    ds_read_b64_tr_b16 v[54:55], v11 offset:27136
    v_and_b32 v101, 0xffff0000, v101
    v_lshlrev_b32 v5, 16, v82
    v_and_b32 v6, 0xffff0000, v82
    s_waitcnt lgkmcnt(10)
    v_mfma_f32_32x32x16_bf16 v[64:79], v[32:35], v[160:163], v[64:79]
    ds_read_b64_tr_b16 v[56:57], v11 offset:28672
    ds_read_b64_tr_b16 v[58:59], v11 offset:29184
    v_mul_f32 v100, v5, v100
    v_mul_f32 v101, v6, v101
    v_cvt_pk_bf16_f32 v82, v100, v101
    v_cvt_pk_bf16_f32 v103, v102, v103
    s_waitcnt lgkmcnt(10)
    v_mfma_f32_32x32x16_bf16 v[64:79], v[36:39], v[164:167], v[64:79]
    ds_read_b64_tr_b16 v[60:61], v11 offset:30720
    ds_read_b64_tr_b16 v[62:63], v11 offset:31232
    v_lshlrev_b32 v102, 16, v103
    v_and_b32 v103, 0xffff0000, v103
    v_lshlrev_b32 v5, 16, v83
    s_waitcnt lgkmcnt(10)
    v_mfma_f32_32x32x16_bf16 v[64:79], v[40:43], v[168:171], v[64:79]
    ds_read_b64_tr_b16 v[32:33], v11 offset:32768
    ds_read_b64_tr_b16 v[34:35], v11 offset:33280
    v_and_b32 v6, 0xffff0000, v83
    v_mul_f32 v102, v5, v102
    v_mul_f32 v103, v6, v103
    v_cvt_pk_bf16_f32 v83, v102, v103
    s_waitcnt lgkmcnt(10)
    v_mfma_f32_32x32x16_bf16 v[64:79], v[44:47], v[172:175], v[64:79]
    ds_read_b64_tr_b16 v[36:37], v11 offset:34816
    ds_read_b64_tr_b16 v[38:39], v11 offset:35328
    buffer_store_dwordx4 v[80:83], v3, s[20:23], s51 offen offset:0 sc1
    v_cvt_pk_bf16_f32 v105, v104, v105
    v_lshlrev_b32 v104, 16, v105
    s_waitcnt lgkmcnt(10)
    v_mfma_f32_32x32x16_bf16 v[64:79], v[48:51], v[176:179], v[64:79]
    ds_read_b64_tr_b16 v[40:41], v11 offset:36864
    ds_read_b64_tr_b16 v[42:43], v11 offset:37376
    v_and_b32 v105, 0xffff0000, v105
    v_lshlrev_b32 v5, 16, v84
    v_and_b32 v6, 0xffff0000, v84
    v_mul_f32 v104, v5, v104
    s_waitcnt lgkmcnt(10)
    v_mfma_f32_32x32x16_bf16 v[64:79], v[52:55], v[180:183], v[64:79]
    ds_read_b64_tr_b16 v[44:45], v11 offset:38912
    ds_read_b64_tr_b16 v[46:47], v11 offset:39424
    v_mul_f32 v105, v6, v105
    v_cvt_pk_bf16_f32 v84, v104, v105
    v_cvt_pk_bf16_f32 v107, v106, v107
    s_waitcnt lgkmcnt(10)
    v_mfma_f32_32x32x16_bf16 v[64:79], v[56:59], v[184:187], v[64:79]
    ds_read_b64_tr_b16 v[48:49], v11 offset:40960
    ds_read_b64_tr_b16 v[50:51], v11 offset:41472
    v_lshlrev_b32 v106, 16, v107
    v_and_b32 v107, 0xffff0000, v107
    v_lshlrev_b32 v5, 16, v85
    v_and_b32 v6, 0xffff0000, v85
    s_waitcnt lgkmcnt(10)
    v_mfma_f32_32x32x16_bf16 v[64:79], v[60:63], v[188:191], v[64:79]
    ds_read_b64_tr_b16 v[52:53], v11 offset:43008
    ds_read_b64_tr_b16 v[54:55], v11 offset:43520
    v_mul_f32 v106, v5, v106
    v_mul_f32 v107, v6, v107
    v_cvt_pk_bf16_f32 v85, v106, v107
    s_waitcnt lgkmcnt(10)
    v_mfma_f32_32x32x16_bf16 v[64:79], v[32:35], v[192:195], v[64:79]
    ds_read_b64_tr_b16 v[56:57], v11 offset:45056
    ds_read_b64_tr_b16 v[58:59], v11 offset:45568
    v_cvt_pk_bf16_f32 v109, v108, v109
    v_lshlrev_b32 v108, 16, v109
    v_and_b32 v109, 0xffff0000, v109
    v_lshlrev_b32 v5, 16, v86
    s_waitcnt lgkmcnt(10)
    v_mfma_f32_32x32x16_bf16 v[64:79], v[36:39], v[196:199], v[64:79]
    ds_read_b64_tr_b16 v[60:61], v11 offset:47104
    ds_read_b64_tr_b16 v[62:63], v11 offset:47616
    v_and_b32 v6, 0xffff0000, v86
    v_mul_f32 v108, v5, v108
    v_mul_f32 v109, v6, v109
    s_waitcnt lgkmcnt(10)
    v_mfma_f32_32x32x16_bf16 v[64:79], v[40:43], v[200:203], v[64:79]
    ds_read_b64_tr_b16 v[32:33], v11 offset:49152
    ds_read_b64_tr_b16 v[34:35], v11 offset:49664
    v_cvt_pk_bf16_f32 v86, v108, v109
    v_cvt_pk_bf16_f32 v111, v110, v111
    v_lshlrev_b32 v110, 16, v111
    v_and_b32 v111, 0xffff0000, v111
    s_waitcnt lgkmcnt(10)
    v_mfma_f32_32x32x16_bf16 v[64:79], v[44:47], v[204:207], v[64:79]
    ds_read_b64_tr_b16 v[36:37], v11 offset:51200
    ds_read_b64_tr_b16 v[38:39], v11 offset:51712
    v_lshlrev_b32 v5, 16, v87
    v_and_b32 v6, 0xffff0000, v87
    v_mul_f32 v110, v5, v110
    s_waitcnt lgkmcnt(10)
    v_mfma_f32_32x32x16_bf16 v[64:79], v[48:51], v[208:211], v[64:79]
    ds_read_b64_tr_b16 v[40:41], v11 offset:53248
    ds_read_b64_tr_b16 v[42:43], v11 offset:53760
    v_mul_f32 v111, v6, v111
    v_cvt_pk_bf16_f32 v87, v110, v111
    buffer_store_dwordx4 v[84:87], v3, s[20:23], s51 offen offset:1024 sc1
    s_waitcnt lgkmcnt(10)
    v_mfma_f32_32x32x16_bf16 v[64:79], v[52:55], v[212:215], v[64:79]
    ds_read_b64_tr_b16 v[44:45], v11 offset:55296
    ds_read_b64_tr_b16 v[46:47], v11 offset:55808
    v_cvt_pk_bf16_f32 v113, v112, v113
    v_lshlrev_b32 v112, 16, v113
    v_and_b32 v113, 0xffff0000, v113
    v_lshlrev_b32 v5, 16, v88
    s_waitcnt lgkmcnt(10)
    v_mfma_f32_32x32x16_bf16 v[64:79], v[56:59], v[216:219], v[64:79]
    ds_read_b64_tr_b16 v[48:49], v11 offset:57344
    ds_read_b64_tr_b16 v[50:51], v11 offset:57856
    v_and_b32 v6, 0xffff0000, v88
    v_mul_f32 v112, v5, v112
    v_mul_f32 v113, v6, v113
    s_waitcnt lgkmcnt(10)
    v_mfma_f32_32x32x16_bf16 v[64:79], v[60:63], v[220:223], v[64:79]
    ds_read_b64_tr_b16 v[52:53], v11 offset:59392
    ds_read_b64_tr_b16 v[54:55], v11 offset:59904
    v_cvt_pk_bf16_f32 v88, v112, v113
    v_cvt_pk_bf16_f32 v115, v114, v115
    v_lshlrev_b32 v114, 16, v115
    v_and_b32 v115, 0xffff0000, v115
    s_waitcnt lgkmcnt(10)
    v_mfma_f32_32x32x16_bf16 v[64:79], v[32:35], v[224:227], v[64:79]
    ds_read_b64_tr_b16 v[56:57], v11 offset:61440
    ds_read_b64_tr_b16 v[58:59], v11 offset:61952
    v_lshlrev_b32 v5, 16, v89
    v_and_b32 v6, 0xffff0000, v89
    v_mul_f32 v114, v5, v114
    s_waitcnt lgkmcnt(10)
    v_mfma_f32_32x32x16_bf16 v[64:79], v[36:39], v[228:231], v[64:79]
    ds_read_b64_tr_b16 v[60:61], v11 offset:63488
    ds_read_b64_tr_b16 v[62:63], v11 offset:64000
    v_mul_f32 v115, v6, v115
    v_cvt_pk_bf16_f32 v89, v114, v115
    v_cvt_pk_bf16_f32 v117, v116, v117
    v_lshlrev_b32 v116, 16, v117
    s_waitcnt lgkmcnt(10)
    v_mfma_f32_32x32x16_bf16 v[64:79], v[40:43], v[232:235], v[64:79]
    ds_read_b64_tr_b16 v[32:33], v11 offset:256
    ds_read_b64_tr_b16 v[34:35], v11 offset:768
    v_and_b32 v117, 0xffff0000, v117
    v_lshlrev_b32 v5, 16, v90
    v_and_b32 v6, 0xffff0000, v90
    s_waitcnt lgkmcnt(10)
    v_mfma_f32_32x32x16_bf16 v[64:79], v[44:47], v[236:239], v[64:79]
    ds_read_b64_tr_b16 v[36:37], v11 offset:2304
    ds_read_b64_tr_b16 v[38:39], v11 offset:2816
    v_mul_f32 v116, v5, v116
    v_mul_f32 v117, v6, v117
    v_cvt_pk_bf16_f32 v90, v116, v117
    v_cvt_pk_bf16_f32 v119, v118, v119
    s_waitcnt lgkmcnt(10)
    v_mfma_f32_32x32x16_bf16 v[64:79], v[48:51], v[240:243], v[64:79]
    ds_read_b64_tr_b16 v[40:41], v11 offset:4352
    ds_read_b64_tr_b16 v[42:43], v11 offset:4864
    v_lshlrev_b32 v118, 16, v119
    v_and_b32 v119, 0xffff0000, v119
    v_lshlrev_b32 v5, 16, v91
    s_waitcnt lgkmcnt(10)
    v_mfma_f32_32x32x16_bf16 v[64:79], v[52:55], v[244:247], v[64:79]
    ds_read_b64_tr_b16 v[44:45], v11 offset:6400
    ds_read_b64_tr_b16 v[46:47], v11 offset:6912
    v_and_b32 v6, 0xffff0000, v91
    v_mul_f32 v118, v5, v118
    v_mul_f32 v119, v6, v119
    v_cvt_pk_bf16_f32 v91, v118, v119
    s_waitcnt lgkmcnt(10)
    v_mfma_f32_32x32x16_bf16 v[64:79], v[56:59], v[248:251], v[64:79]
    ds_read_b64_tr_b16 v[48:49], v11 offset:8448
    ds_read_b64_tr_b16 v[50:51], v11 offset:8960
    buffer_store_dwordx4 v[88:91], v3, s[20:23], s51 offen offset:2048 sc1
    v_cvt_pk_bf16_f32 v121, v120, v121
    v_lshlrev_b32 v120, 16, v121
    s_waitcnt lgkmcnt(10)
    v_mfma_f32_32x32x16_bf16 v[64:79], v[60:63], v[252:255], v[64:79]
    ds_read_b64_tr_b16 v[52:53], v11 offset:10496
    ds_read_b64_tr_b16 v[54:55], v11 offset:11008
    v_and_b32 v121, 0xffff0000, v121
    v_lshlrev_b32 v5, 16, v92
    v_and_b32 v6, 0xffff0000, v92
    v_mul_f32 v120, v5, v120
    s_waitcnt lgkmcnt(10)
    v_mfma_f32_32x32x16_bf16 v[96:111], v[32:35], v[128:131], 0
    ds_read_b64_tr_b16 v[56:57], v11 offset:12544
    ds_read_b64_tr_b16 v[58:59], v11 offset:13056
    v_mul_f32 v121, v6, v121
    v_cvt_pk_bf16_f32 v92, v120, v121
    v_cvt_pk_bf16_f32 v123, v122, v123
    s_waitcnt lgkmcnt(10)
    v_mfma_f32_32x32x16_bf16 v[96:111], v[36:39], v[132:135], v[96:111]
    ds_read_b64_tr_b16 v[60:61], v11 offset:14592
    ds_read_b64_tr_b16 v[62:63], v11 offset:15104
    v_lshlrev_b32 v122, 16, v123
    v_and_b32 v123, 0xffff0000, v123
    v_lshlrev_b32 v5, 16, v93
    v_and_b32 v6, 0xffff0000, v93
    s_waitcnt lgkmcnt(10)
    v_mfma_f32_32x32x16_bf16 v[96:111], v[40:43], v[136:139], v[96:111]
    ds_read_b64_tr_b16 v[32:33], v11 offset:16640
    ds_read_b64_tr_b16 v[34:35], v11 offset:17152
    v_mul_f32 v122, v5, v122
    v_mul_f32 v123, v6, v123
    v_cvt_pk_bf16_f32 v93, v122, v123
    s_waitcnt lgkmcnt(10)
    v_mfma_f32_32x32x16_bf16 v[96:111], v[44:47], v[140:143], v[96:111]
    ds_read_b64_tr_b16 v[36:37], v11 offset:18688
    ds_read_b64_tr_b16 v[38:39], v11 offset:19200
    v_cvt_pk_bf16_f32 v125, v124, v125
    v_lshlrev_b32 v124, 16, v125
    v_and_b32 v125, 0xffff0000, v125
    v_lshlrev_b32 v5, 16, v94
    s_waitcnt lgkmcnt(10)
    v_mfma_f32_32x32x16_bf16 v[96:111], v[48:51], v[144:147], v[96:111]
    ds_read_b64_tr_b16 v[40:41], v11 offset:20736
    ds_read_b64_tr_b16 v[42:43], v11 offset:21248
    v_and_b32 v6, 0xffff0000, v94
    v_mul_f32 v124, v5, v124
    v_mul_f32 v125, v6, v125
    v_mov_b32 v128, 0
    v_mov_b32 v129, 0
    v_mov_b32 v130, 0
    s_waitcnt lgkmcnt(10)
    v_mfma_f32_32x32x16_bf16 v[96:111], v[52:55], v[148:151], v[96:111]
    ds_read_b64_tr_b16 v[44:45], v11 offset:22784
    ds_read_b64_tr_b16 v[46:47], v11 offset:23296
    v_cvt_pk_bf16_f32 v94, v124, v125
    v_cvt_pk_bf16_f32 v127, v126, v127
    v_lshlrev_b32 v126, 16, v127
    v_and_b32 v127, 0xffff0000, v127
    v_mov_b32 v131, 0
    v_mov_b32 v132, 0
    v_mov_b32 v133, 0
    s_waitcnt lgkmcnt(10)
    v_mfma_f32_32x32x16_bf16 v[96:111], v[56:59], v[152:155], v[96:111]
    ds_read_b64_tr_b16 v[48:49], v11 offset:24832
    ds_read_b64_tr_b16 v[50:51], v11 offset:25344
    v_lshlrev_b32 v5, 16, v95
    v_and_b32 v6, 0xffff0000, v95
    v_mul_f32 v126, v5, v126
    v_mov_b32 v134, 0
    v_mov_b32 v135, 0
    v_mov_b32 v136, 0
    s_waitcnt lgkmcnt(10)
    v_mfma_f32_32x32x16_bf16 v[96:111], v[60:63], v[156:159], v[96:111]
    ds_read_b64_tr_b16 v[52:53], v11 offset:26880
    ds_read_b64_tr_b16 v[54:55], v11 offset:27392
    v_mul_f32 v127, v6, v127
    v_cvt_pk_bf16_f32 v95, v126, v127
    buffer_store_dwordx4 v[92:95], v3, s[20:23], s51 offen offset:3072 sc1
    v_mov_b32 v137, 0
    v_mov_b32 v138, 0
    v_mov_b32 v139, 0
    s_waitcnt lgkmcnt(10)
    v_mfma_f32_32x32x16_bf16 v[96:111], v[32:35], v[160:163], v[96:111]
    ds_read_b64_tr_b16 v[56:57], v11 offset:28928
    ds_read_b64_tr_b16 v[58:59], v11 offset:29440
    v_mul_f32 v64, 0x3e0293ee, v64
    v_mul_f32 v65, 0x3e0293ee, v65
    v_mov_b32 v140, 0
    v_mov_b32 v141, 0
    v_mov_b32 v142, 0
    s_waitcnt lgkmcnt(10)
    v_mfma_f32_32x32x16_bf16 v[96:111], v[36:39], v[164:167], v[96:111]
    ds_read_b64_tr_b16 v[60:61], v11 offset:30976
    ds_read_b64_tr_b16 v[62:63], v11 offset:31488
    v_cvt_pk_bf16_f32 v64, v64, v65
    v_mul_f32 v66, 0x3e0293ee, v66
    v_mov_b32 v143, 0
    v_mov_b32 v144, 0
    v_mov_b32 v145, 0
    s_waitcnt lgkmcnt(10)
    v_mfma_f32_32x32x16_bf16 v[96:111], v[40:43], v[168:171], v[96:111]
    ds_read_b64_tr_b16 v[32:33], v11 offset:49408
    ds_read_b64_tr_b16 v[34:35], v11 offset:49920
    v_mul_f32 v67, 0x3e0293ee, v67
    v_cvt_pk_bf16_f32 v65, v66, v67
    v_mov_b32 v146, 0
    v_mov_b32 v147, 0
    v_mov_b32 v148, 0
    s_waitcnt lgkmcnt(10)
    v_mfma_f32_32x32x16_bf16 v[96:111], v[44:47], v[172:175], v[96:111]
    ds_read_b64_tr_b16 v[36:37], v11 offset:51456
    ds_read_b64_tr_b16 v[38:39], v11 offset:51968
    v_mul_f32 v68, 0x3e0293ee, v68
    v_mul_f32 v69, 0x3e0293ee, v69
    v_mov_b32 v149, 0
    v_mov_b32 v150, 0
    v_mov_b32 v151, 0
    s_waitcnt lgkmcnt(10)
    v_mfma_f32_32x32x16_bf16 v[96:111], v[48:51], v[176:179], v[96:111]
    ds_read_b64_tr_b16 v[40:41], v11 offset:53504
    ds_read_b64_tr_b16 v[42:43], v11 offset:54016
    v_cvt_pk_bf16_f32 v66, v68, v69
    v_mul_f32 v70, 0x3e0293ee, v70
    v_mov_b32 v152, 0
    v_mov_b32 v153, 0
    v_mov_b32 v154, 0
    s_waitcnt lgkmcnt(10)
    v_mfma_f32_32x32x16_bf16 v[96:111], v[52:55], v[180:183], v[96:111]
    ds_read_b64_tr_b16 v[44:45], v11 offset:55552
    ds_read_b64_tr_b16 v[46:47], v11 offset:56064
    v_mul_f32 v71, 0x3e0293ee, v71
    v_cvt_pk_bf16_f32 v67, v70, v71
    v_mov_b32 v155, 0
    v_mov_b32 v156, 0
    v_mov_b32 v157, 0
    s_waitcnt lgkmcnt(10)
    v_mfma_f32_32x32x16_bf16 v[96:111], v[56:59], v[184:187], v[96:111]
    ds_read_b64_tr_b16 v[48:49], v11 offset:33024
    ds_read_b64_tr_b16 v[50:51], v11 offset:33536
    v_mul_f32 v72, 0x3e0293ee, v72
    v_mul_f32 v73, 0x3e0293ee, v73
    v_mov_b32 v158, 0
    v_mov_b32 v159, 0
    s_waitcnt lgkmcnt(10)
    v_mfma_f32_32x32x16_bf16 v[96:111], v[60:63], v[188:191], v[96:111]
    ds_read_b64_tr_b16 v[52:53], v11 offset:35072
    ds_read_b64_tr_b16 v[54:55], v11 offset:35584
    v_cvt_pk_bf16_f32 v68, v72, v73
    v_mul_f32 v74, 0x3e0293ee, v74
    v_mov_b32 v160, 0
    v_mov_b32 v161, 0
    v_mov_b32 v162, 0
    s_waitcnt lgkmcnt(10)
    v_mfma_f32_32x32x16_bf16 v[96:111], v[32:35], v[224:227], v[96:111]
    ds_read_b64_tr_b16 v[56:57], v11 offset:37120
    ds_read_b64_tr_b16 v[58:59], v11 offset:37632
    v_mul_f32 v75, 0x3e0293ee, v75
    v_cvt_pk_bf16_f32 v69, v74, v75
    v_mov_b32 v163, 0
    v_mov_b32 v164, 0
    v_mov_b32 v165, 0
    s_waitcnt lgkmcnt(10)
    v_mfma_f32_32x32x16_bf16 v[96:111], v[36:39], v[228:231], v[96:111]
    ds_read_b64_tr_b16 v[60:61], v11 offset:39168
    ds_read_b64_tr_b16 v[62:63], v11 offset:39680
    v_mul_f32 v76, 0x3e0293ee, v76
    v_mul_f32 v77, 0x3e0293ee, v77
    v_mov_b32 v166, 0
    v_mov_b32 v167, 0
    v_mov_b32 v168, 0
    s_waitcnt lgkmcnt(10)
    v_mfma_f32_32x32x16_bf16 v[96:111], v[40:43], v[232:235], v[96:111]
    ds_read_b64_tr_b16 v[32:33], v11 offset:41216
    ds_read_b64_tr_b16 v[34:35], v11 offset:41728
    v_cvt_pk_bf16_f32 v70, v76, v77
    v_mul_f32 v78, 0x3e0293ee, v78
    v_mov_b32 v169, 0
    v_mov_b32 v170, 0
    v_mov_b32 v171, 0
    s_waitcnt lgkmcnt(10)
    v_mfma_f32_32x32x16_bf16 v[96:111], v[44:47], v[236:239], v[96:111]
    ds_read_b64_tr_b16 v[36:37], v11 offset:43264
    ds_read_b64_tr_b16 v[38:39], v11 offset:43776
    v_mul_f32 v79, 0x3e0293ee, v79
    v_cvt_pk_bf16_f32 v71, v78, v79
    v_mov_b32 v172, 0
    v_mov_b32 v173, 0
    v_mov_b32 v174, 0
    s_waitcnt lgkmcnt(10)
    v_mfma_f32_32x32x16_bf16 v[96:111], v[48:51], v[192:195], v[96:111]
    ds_read_b64_tr_b16 v[40:41], v11 offset:45312
    ds_read_b64_tr_b16 v[42:43], v11 offset:45824
    v_mov_b32 v175, 0
    v_mov_b32 v176, 0
    v_mov_b32 v177, 0
    s_waitcnt lgkmcnt(10)
    v_mfma_f32_32x32x16_bf16 v[96:111], v[52:55], v[196:199], v[96:111]
    ds_read_b64_tr_b16 v[44:45], v11 offset:47360
    ds_read_b64_tr_b16 v[46:47], v11 offset:47872
    v_mov_b32 v178, 0
    v_mov_b32 v179, 0
    v_mov_b32 v180, 0
    s_waitcnt lgkmcnt(10)
    v_mfma_f32_32x32x16_bf16 v[96:111], v[56:59], v[200:203], v[96:111]
    ds_read_b64_tr_b16 v[48:49], v11 offset:57600
    ds_read_b64_tr_b16 v[50:51], v11 offset:58112
    v_mov_b32 v181, 0
    v_mov_b32 v182, 0
    v_mov_b32 v183, 0
    s_waitcnt lgkmcnt(10)
    v_mfma_f32_32x32x16_bf16 v[96:111], v[60:63], v[204:207], v[96:111]
    ds_read_b64_tr_b16 v[52:53], v11 offset:59648
    ds_read_b64_tr_b16 v[54:55], v11 offset:60160
    v_mov_b32 v184, 0
    v_mov_b32 v185, 0
    v_mov_b32 v186, 0
    s_waitcnt lgkmcnt(10)
    v_mfma_f32_32x32x16_bf16 v[96:111], v[32:35], v[208:211], v[96:111]
    ds_read_b64_tr_b16 v[56:57], v11 offset:61696
    ds_read_b64_tr_b16 v[58:59], v11 offset:62208
    v_mov_b32 v187, 0
    v_mov_b32 v188, 0
    v_mov_b32 v189, 0
    v_mov_b32 v224, 0
    v_mov_b32 v225, 0
    v_mov_b32 v226, 0
    v_mov_b32 v227, 0
    v_mov_b32 v228, 0
    v_mov_b32 v229, 0
    s_waitcnt lgkmcnt(10)
    v_mfma_f32_32x32x16_bf16 v[96:111], v[36:39], v[212:215], v[96:111]
    ds_read_b64_tr_b16 v[60:61], v11 offset:63744
    ds_read_b64_tr_b16 v[62:63], v11 offset:64256
    v_mov_b32 v190, 0
    v_mov_b32 v191, 0
    v_mov_b32 v230, 0
    v_mov_b32 v231, 0
    v_mov_b32 v232, 0
    v_mov_b32 v233, 0
    v_mov_b32 v234, 0
    v_mov_b32 v235, 0
    s_waitcnt lgkmcnt(10)
    v_mfma_f32_32x32x16_bf16 v[96:111], v[40:43], v[216:219], v[96:111]
    v_mov_b32 v236, 0
    v_mov_b32 v237, 0
    v_mov_b32 v238, 0
    v_mov_b32 v239, 0
    v_mov_b32 v90, 0
    s_waitcnt lgkmcnt(8)
    v_mfma_f32_32x32x16_bf16 v[96:111], v[44:47], v[220:223], v[96:111]
    s_waitcnt vmcnt(0) lgkmcnt(0)
    s_barrier
    ds_read_b128 v[32:35], v13 offset:0
    ds_read_b128 v[36:39], v13 offset:1024
    ds_read_b128 v[40:43], v13 offset:2048
    ds_read_b128 v[44:47], v13 offset:3072
    s_add_u32 s54, s44, 1
    s_add_u32 s55, s54, s46
    s_cmp_lt_u32 s54, s45
    s_cselect_b32 s55, s54, s55
    s_lshl_b32 s55, s55, 15
    s_add_u32 s55, s55, s47
    s_sub_u32 s54, s54, s56
    s_cmp_le_u32 s54, s57
    s_cselect_b32 s60, 1, 0
    s_xor_b32 s48, s48, 0x10000
    v_mfma_f32_32x32x16_bf16 v[96:111], v[48:51], v[240:243], v[96:111]
    ds_read_b128 v[48:51], v13 offset:4096
    s_cmp_eq_u32 s60, 0
    s_cbranch_scc1 .Lk2_g2
    s_add_u32 m0, s48, 0x0
    s_add_u32 s38, s55, 0x0
    buffer_load_dwordx4 v15, s[24:27], s38 offen offset:0 lds
    buffer_load_dwordx4 v15, s[24:27], s38 offen offset:1024 lds
.Lk2_g2:
    v_mfma_f32_32x32x16_bf16 v[96:111], v[52:55], v[244:247], v[96:111]
    s_cmp_lg_u32 s32, 0
    s_cbranch_scc1 .Lk2_hs
    s_waitcnt vmcnt(63)
    s_lshl_b32 s52, s2, 8
    s_add_u32 s52, s52, 0x40000
    v_mov_b32 v5, s52
    v_mov_b32 v6, 1
    s_mov_b64 exec, 1
    buffer_store_dword v6, v5, s[88:91], 0 offen sc1
    s_mov_b64 exec, -1
.Lk2_hs:
    ds_read_b128 v[52:55], v13 offset:5120
    v_mfma_f32_32x32x16_bf16 v[96:111], v[56:59], v[248:251], v[96:111]
    ds_read_b128 v[56:59], v13 offset:6144
    v_mfma_f32_32x32x16_bf16 v[96:111], v[60:63], v[252:255], v[96:111]
    ds_read_b128 v[60:63], v13 offset:7168
    s_nop 7
    s_nop 2
    v_mul_f32 v96, 0x3e0293ee, v96
    v_mul_f32 v97, 0x3e0293ee, v97
    v_cvt_pk_bf16_f32 v72, v96, v97
    v_mul_f32 v98, 0x3e0293ee, v98
    v_mul_f32 v99, 0x3e0293ee, v99
    v_cvt_pk_bf16_f32 v73, v98, v99
    v_mul_f32 v100, 0x3e0293ee, v100
    v_mul_f32 v101, 0x3e0293ee, v101
    v_cvt_pk_bf16_f32 v74, v100, v101
    v_mul_f32 v102, 0x3e0293ee, v102
    v_mul_f32 v103, 0x3e0293ee, v103
    v_cvt_pk_bf16_f32 v75, v102, v103
    v_mul_f32 v104, 0x3e0293ee, v104
    v_mul_f32 v105, 0x3e0293ee, v105
    v_cvt_pk_bf16_f32 v76, v104, v105
    v_mul_f32 v106, 0x3e0293ee, v106
    v_mul_f32 v107, 0x3e0293ee, v107
    v_cvt_pk_bf16_f32 v77, v106, v107
    v_mul_f32 v108, 0x3e0293ee, v108
    v_mul_f32 v109, 0x3e0293ee, v109
    v_cvt_pk_bf16_f32 v78, v108, v109
    v_mul_f32 v110, 0x3e0293ee, v110
    v_mul_f32 v111, 0x3e0293ee, v111
    v_cvt_pk_bf16_f32 v79, v110, v111
    s_load_dwordx2 s[8:9], s[0:1], 72
    s_load_dwordx2 s[12:13], s[0:1], 40
    s_add_u32 s4, s62, 0x200000
    s_addc_u32 s5, s63, 0
    s_and_b32 s5, s5, 0xffff
    s_mov_b32 s6, 0x2000000
    s_mov_b32 s7, 0x00020000
    s_bfe_u32 s17, s2, 0x20001
    s_lshl_b32 s17, s17, 5
    s_lshr_b32 s18, s2, 3
    s_add_u32 s17, s17, s18
    s_lshl_b32 s17, s17, 2
    s_add_u32 s17, s17, s34
    s_mul_i32 s19, s17, 3584
    s_lshl_b32 s18, s17, 13
    s_cmp_eq_u32 s35, 0
    s_cselect_b32 s16, 14, 17
    s_cmp_eq_u32 s35, 0
    s_cbranch_scc1 .Lk2_loop
    ds_write_b128 v9, v[16:19] offset:0
    ds_write_b128 v9, v[20:23] offset:1024
    ds_write_b128 v9, v[24:27] offset:2048
    ds_write_b128 v9, v[28:31] offset:3072
    ds_write_b128 v9, v[64:67] offset:4096
    ds_write_b128 v9, v[68:71] offset:5120
    ds_write_b128 v9, v[72:75] offset:6144
    ds_write_b128 v9, v[76:79] offset:7168
    s_waitcnt lgkmcnt(0)
    .p2align 7
    s_nop 0
    s_nop 0
    s_nop 0
    s_nop 0
    s_nop 0
    s_nop 0
.Lk2_loop:
    s_waitcnt lgkmcnt(7)
    v_mfma_f32_32x32x16_bf16 v[192:207], v[32:35], v[16:19], v[224:239]
    ds_read_b128 v[32:35], v13 offset:8192
    s_cmp_eq_u32 s60, 0
    s_cbranch_scc1 .Lkvproj_kernel_nod_25
    buffer_load_dwordx4 v15, s[24:27], s38 offen offset:2048 lds
.Lkvproj_kernel_nod_25:
    s_waitcnt lgkmcnt(7)
    v_mfma_f32_32x32x16_bf16 v[192:207], v[36:39], v[20:23], v[192:207]
    ds_read_b128 v[36:39], v13 offset:9216
    s_waitcnt lgkmcnt(7)
    v_mfma_f32_32x32x16_bf16 v[192:207], v[40:43], v[24:27], v[192:207]
    ds_read_b128 v[40:43], v13 offset:10240
    s_cmp_eq_u32 s60, 0
    s_cbranch_scc1 .Lkvproj_kernel_nod_26
    buffer_load_dwordx4 v15, s[24:27], s38 offen offset:3072 lds
.Lkvproj_kernel_nod_26:
    s_waitcnt lgkmcnt(7)
    v_mfma_f32_32x32x16_bf16 v[192:207], v[44:47], v[28:31], v[192:207]
    ds_read_b128 v[44:47], v13 offset:11264
    s_waitcnt lgkmcnt(7)
    v_mfma_f32_32x32x16_bf16 v[192:207], v[48:51], v[64:67], v[192:207]
    ds_read_b128 v[48:51], v13 offset:12288
    s_cmp_eq_u32 s60, 0
    s_cbranch_scc1 .Lkvproj_kernel_nod_27
    s_add_u32 m0, s48, 0x1000
    s_add_u32 s38, s55, 0x1000
    buffer_load_dwordx4 v15, s[24:27], s38 offen offset:0 lds
.Lkvproj_kernel_nod_27:
    s_waitcnt lgkmcnt(7)
    v_mfma_f32_32x32x16_bf16 v[192:207], v[52:55], v[68:71], v[192:207]
    ds_read_b128 v[52:55], v13 offset:13312
    s_waitcnt lgkmcnt(7)
    v_mfma_f32_32x32x16_bf16 v[192:207], v[56:59], v[72:75], v[192:207]
    ds_read_b128 v[56:59], v13 offset:14336
    s_cmp_eq_u32 s60, 0
    s_cbranch_scc1 .Lkvproj_kernel_nod_28
    buffer_load_dwordx4 v15, s[24:27], s38 offen offset:1024 lds
.Lkvproj_kernel_nod_28:
    s_waitcnt lgkmcnt(7)
    v_mfma_f32_32x32x16_bf16 v[192:207], v[60:63], v[76:79], v[192:207]
    ds_read_b128 v[60:63], v13 offset:15360
    s_waitcnt lgkmcnt(7)
    v_mfma_f32_32x32x16_bf16 v[208:223], v[32:35], v[16:19], v[224:239]
    ds_read_b128 v[32:35], v13 offset:16384
    s_cmp_eq_u32 s60, 0
    s_cbranch_scc1 .Lkvproj_kernel_nod_29
    buffer_load_dwordx4 v15, s[24:27], s38 offen offset:2048 lds
.Lkvproj_kernel_nod_29:
    s_waitcnt lgkmcnt(7)
    v_mfma_f32_32x32x16_bf16 v[208:223], v[36:39], v[20:23], v[208:223]
    ds_read_b128 v[36:39], v13 offset:17408
    s_add_u32 s52, s49, 31
    s_cmp_gt_u32 s52, s50
    s_cbranch_scc1 .Lkvproj_kernel_mask_30
.Lkvproj_kernel_mret_31:
    s_waitcnt lgkmcnt(7)
    v_mfma_f32_32x32x16_bf16 v[208:223], v[40:43], v[24:27], v[208:223]
    ds_read_b128 v[40:43], v13 offset:18432
    s_cmp_eq_u32 s60, 0
    s_cbranch_scc1 .Lkvproj_kernel_nod_32
    buffer_load_dwordx4 v15, s[24:27], s38 offen offset:3072 lds
.Lkvproj_kernel_nod_32:
    v_exp_f32 v80, v192
    v_exp_f32 v81, v193
    v_exp_f32 v82, v194
    v_add_f32 v88, v80, v81
    s_waitcnt lgkmcnt(7)
    v_mfma_f32_32x32x16_bf16 v[208:223], v[44:47], v[28:31], v[208:223]
    ds_read_b128 v[44:47], v13 offset:19456
    v_exp_f32 v83, v195
    v_cvt_pk_bf16_f32 v240, v80, v81
    v_exp_f32 v84, v196
    v_add_f32 v88, v88, v82
    s_waitcnt lgkmcnt(7)
    v_mfma_f32_32x32x16_bf16 v[208:223], v[48:51], v[64:67], v[208:223]
    ds_read_b128 v[48:51], v13 offset:20480
    buffer_load_dword v2, v7, s[4:7], s58 offen
    s_add_u32 s58, s58, 0x8000
    s_min_u32 s58, s58, s59
    s_add_u32 s52, s44, 1
    s_cmp_eq_u32 s52, s45
    s_cselect_b32 s61, 0x18000, s64
    v_exp_f32 v85, v197
    v_add_f32 v88, v88, v83
    v_cvt_pk_bf16_f32 v241, v82, v83
    v_exp_f32 v86, v198
    s_waitcnt lgkmcnt(7)
    v_mfma_f32_32x32x16_bf16 v[208:223], v[52:55], v[68:71], v[208:223]
    ds_read_b128 v[52:55], v13 offset:21504
    v_add_f32 v88, v88, v84
    v_exp_f32 v87, v199
    v_add_f32 v88, v88, v85
    v_cvt_pk_bf16_f32 v242, v84, v85
    s_waitcnt lgkmcnt(7)
    v_mfma_f32_32x32x16_bf16 v[208:223], v[56:59], v[72:75], v[208:223]
    ds_read_b128 v[56:59], v13 offset:22528
    v_add_f32 v88, v88, v86
    v_add_f32 v88, v88, v87
    v_cvt_pk_bf16_f32 v243, v86, v87
    s_waitcnt lgkmcnt(7)
    v_mfma_f32_32x32x16_bf16 v[208:223], v[60:63], v[76:79], v[208:223]
    v_cmp_lt_f32 vcc, s42, v88
    s_cbranch_vccnz .Lkvproj_kernel_fb_33
.Lkvproj_kernel_fret_34:
    v_add_f32 v90, v90, v88
    ds_read_b128 v[60:63], v13 offset:23552
    v_exp_f32 v80, v200
    v_exp_f32 v81, v201
    v_exp_f32 v82, v202
    v_add_f32 v89, v80, v81
    v_exp_f32 v83, v203
    s_waitcnt lgkmcnt(7)
    v_mfma_f32_32x32x16_bf16 v[128:143], v[32:35], v[240:243], v[128:143]
    ds_read_b128 v[32:35], v13 offset:24576
    v_cvt_pk_bf16_f32 v244, v80, v81
    v_exp_f32 v84, v204
    v_add_f32 v89, v89, v82
    v_exp_f32 v85, v205
    v_add_f32 v89, v89, v83
    s_waitcnt lgkmcnt(7)
    v_mfma_f32_32x32x16_bf16 v[144:159], v[36:39], v[240:243], v[144:159]
    ds_read_b128 v[36:39], v13 offset:25600
    v_cvt_pk_bf16_f32 v245, v82, v83
    v_exp_f32 v86, v206
    v_add_f32 v89, v89, v84
    v_exp_f32 v87, v207
    v_add_f32 v89, v89, v85
    s_waitcnt lgkmcnt(7)
    v_mfma_f32_32x32x16_bf16 v[160:175], v[40:43], v[240:243], v[160:175]
    ds_read_b128 v[40:43], v13 offset:26624
    s_add_u32 s52, s49, 63
    s_cmp_gt_u32 s52, s50
    s_cbranch_scc1 .Lkvproj_kernel_mask_35
.Lkvproj_kernel_mret_36:
    v_cvt_pk_bf16_f32 v246, v84, v85
    v_add_f32 v89, v89, v86
    v_add_f32 v89, v89, v87
    v_cvt_pk_bf16_f32 v247, v86, v87
    s_waitcnt lgkmcnt(7)
    v_mfma_f32_32x32x16_bf16 v[176:191], v[44:47], v[240:243], v[176:191]
    v_cmp_lt_f32 vcc, s42, v89
    s_cbranch_vccnz .Lkvproj_kernel_fb_37
.Lkvproj_kernel_fret_38:
    v_add_f32 v90, v90, v89
    ds_read_b128 v[44:47], v13 offset:27648
    v_exp_f32 v80, v208
    v_exp_f32 v81, v209
    v_exp_f32 v82, v210
    v_add_f32 v88, v80, v81
    v_exp_f32 v83, v211
    s_waitcnt lgkmcnt(7)
    v_mfma_f32_32x32x16_bf16 v[128:143], v[48:51], v[244:247], v[128:143]
    ds_read_b128 v[48:51], v13 offset:28672
    v_cvt_pk_bf16_f32 v248, v80, v81
    v_exp_f32 v84, v212
    v_add_f32 v88, v88, v82
    v_exp_f32 v85, v213
    v_add_f32 v88, v88, v83
    s_waitcnt lgkmcnt(7)
    v_mfma_f32_32x32x16_bf16 v[144:159], v[52:55], v[244:247], v[144:159]
    ds_read_b128 v[52:55], v13 offset:29696
    v_cvt_pk_bf16_f32 v249, v82, v83
    v_exp_f32 v86, v214
    v_add_f32 v88, v88, v84
    v_exp_f32 v87, v215
    v_add_f32 v88, v88, v85
    s_waitcnt lgkmcnt(7)
    v_mfma_f32_32x32x16_bf16 v[160:175], v[56:59], v[244:247], v[160:175]
    ds_read_b128 v[56:59], v13 offset:30720
    v_cvt_pk_bf16_f32 v250, v84, v85
    v_add_f32 v88, v88, v86
    v_add_f32 v88, v88, v87
    v_cvt_pk_bf16_f32 v251, v86, v87
    s_waitcnt lgkmcnt(7)
    v_mfma_f32_32x32x16_bf16 v[176:191], v[60:63], v[244:247], v[176:191]
    v_cmp_lt_f32 vcc, s42, v88
    s_cbranch_vccnz .Lkvproj_kernel_fb_39
.Lkvproj_kernel_fret_40:
    v_add_f32 v90, v90, v88
    ds_read_b128 v[60:63], v13 offset:31744
    v_exp_f32 v80, v216
    v_exp_f32 v81, v217
    v_exp_f32 v82, v218
    v_add_f32 v89, v80, v81
    v_exp_f32 v83, v219
    s_waitcnt lgkmcnt(7)
    v_mfma_f32_32x32x16_bf16 v[128:143], v[32:35], v[248:251], v[128:143]
    v_cvt_pk_bf16_f32 v252, v80, v81
    v_exp_f32 v84, v220
    v_add_f32 v89, v89, v82
    v_exp_f32 v85, v221
    v_add_f32 v89, v89, v83
    s_waitcnt lgkmcnt(6)
    v_mfma_f32_32x32x16_bf16 v[144:159], v[36:39], v[248:251], v[144:159]
    v_cvt_pk_bf16_f32 v253, v82, v83
    v_exp_f32 v86, v222
    v_add_f32 v89, v89, v84
    v_exp_f32 v87, v223
    v_add_f32 v89, v89, v85
    s_waitcnt lgkmcnt(5)
    v_mfma_f32_32x32x16_bf16 v[160:175], v[40:43], v[248:251], v[160:175]
    v_cvt_pk_bf16_f32 v254, v84, v85
    v_add_f32 v89, v89, v86
    v_add_f32 v89, v89, v87
    v_cvt_pk_bf16_f32 v255, v86, v87
    s_waitcnt lgkmcnt(4)
    v_mfma_f32_32x32x16_bf16 v[176:191], v[44:47], v[248:251], v[176:191]
    v_cmp_lt_f32 vcc, s42, v89
    s_cbranch_vccnz .Lkvproj_kernel_fb_41
.Lkvproj_kernel_fret_42:
    v_add_f32 v90, v90, v89
    s_waitcnt vmcnt(1) lgkmcnt(0)
    s_barrier
    v_xor_b32 v13, s61, v13
    ds_read_b128 v[32:35], v13 offset:0
    ds_read_b128 v[36:39], v13 offset:1024
    ds_read_b128 v[40:43], v13 offset:2048
    ds_read_b128 v[44:47], v13 offset:3072
    s_add_u32 s54, s44, 2
    s_add_u32 s55, s54, s46
    s_cmp_lt_u32 s54, s45
    s_cselect_b32 s55, s54, s55
    s_lshl_b32 s55, s55, 15
    s_add_u32 s55, s55, s47
    s_sub_u32 s54, s54, s56
    s_cmp_le_u32 s54, s57
    s_cselect_b32 s60, 1, 0
    s_xor_b32 s48, s48, 0x10000
    v_mfma_f32_32x32x16_bf16 v[128:143], v[48:51], v[252:255], v[128:143]
    s_cmp_eq_u32 s60, 0
    s_cbranch_scc1 .Lkvproj_kernel_nod_43
    s_add_u32 m0, s48, 0x0
    s_add_u32 s38, s55, 0x0
    buffer_load_dwordx4 v15, s[24:27], s38 offen offset:0 lds
.Lkvproj_kernel_nod_43:
    ds_read_b128 v[48:51], v13 offset:4096
    v_mfma_f32_32x32x16_bf16 v[144:159], v[52:55], v[252:255], v[144:159]
    ds_read_b128 v[52:55], v13 offset:5120
    v_mfma_f32_32x32x16_bf16 v[160:175], v[56:59], v[252:255], v[160:175]
    s_cmp_eq_u32 s60, 0
    s_cbranch_scc1 .Lkvproj_kernel_nod_44
    buffer_load_dwordx4 v15, s[24:27], s38 offen offset:1024 lds
.Lkvproj_kernel_nod_44:
    ds_read_b128 v[56:59], v13 offset:6144
    v_mfma_f32_32x32x16_bf16 v[176:191], v[60:63], v[252:255], v[176:191]
    ds_read_b128 v[60:63], v13 offset:7168
    s_add_u32 s44, s44, 1
    s_add_u32 s49, s49, 64
    s_cmp_eq_u32 s44, s45
    s_cbranch_scc1 .Lk2_trans
    s_cmp_lt_u32 s44, s16
    s_cbranch_scc1 .Lk2_loop
    s_cmp_ge_u32 s44, 17
    s_cbranch_scc1 .Lk2_final
    s_cmp_eq_u32 s16, 14
    s_cbranch_scc0 .Lk2_ev1
    s_mov_b32 s4, s8
    s_and_b32 s5, s9, 0xffff
    s_mov_b32 s6, 0x1c0000
    s_mov_b32 s7, 0x00020000
    s_mov_b32 s58, 0
    s_mov_b32 s59, 0
    v_lshl_add_u32 v7, v3, 3, s19
    s_add_u32 s16, s16, 1
    s_branch .Lk2_loop
.Lk2_ev1:
    s_cmp_eq_u32 s16, 15
    s_cbranch_scc0 .Lk2_ev2
    s_mov_b32 s4, s12
    s_and_b32 s5, s13, 0xffff
    s_mov_b32 s6, 0x400000
    s_mov_b32 s7, 0x00020000
    v_lshl_add_u32 v7, v3, 3, s18
    s_add_u32 s16, s16, 1
    s_branch .Lk2_loop
.Lk2_ev2:
    v_mov_b32 v7, 0x40000000
    s_mov_b32 s16, 17
    s_branch .Lk2_loop
.Lk2_trans:
    v_mov_b32 v91, v90
    s_nop 1
    v_permlane32_swap_b32 v91, v90
    v_add_f32 v90, v90, v91
    v_rcp_f32 v91, v90
    s_mul_i32 s52, s50, 11776
    s_lshl_b32 s53, s36, 13
    s_add_u32 s52, s52, s53
    ds_read_b128 v[16:19], v9 offset:0
    ds_read_b128 v[20:23], v9 offset:1024
    ds_read_b128 v[24:27], v9 offset:2048
    ds_read_b128 v[28:31], v9 offset:3072
    ds_read_b128 v[64:67], v9 offset:4096
    ds_read_b128 v[68:71], v9 offset:5120
    ds_read_b128 v[72:75], v9 offset:6144
    ds_read_b128 v[76:79], v9 offset:7168
    v_mul_f32 v128, v128, v91
    v_mul_f32 v129, v129, v91
    v_mul_f32 v130, v130, v91
    v_mul_f32 v131, v131, v91
    v_mul_f32 v132, v132, v91
    v_mul_f32 v133, v133, v91
    v_mul_f32 v134, v134, v91
    v_mul_f32 v135, v135, v91
    v_cvt_pk_bf16_f32 v96, v128, v129
    v_cvt_pk_bf16_f32 v97, v130, v131
    v_cvt_pk_bf16_f32 v98, v132, v133
    v_cvt_pk_bf16_f32 v99, v134, v135
    buffer_store_dwordx4 v[96:99], v3, s[28:31], s52 offen offset:0 sc1
    v_mul_f32 v136, v136, v91
    v_mul_f32 v137, v137, v91
    v_mul_f32 v138, v138, v91
    v_mul_f32 v139, v139, v91
    v_mul_f32 v140, v140, v91
    v_mul_f32 v141, v141, v91
    v_mul_f32 v142, v142, v91
    v_mul_f32 v143, v143, v91
    v_cvt_pk_bf16_f32 v100, v136, v137
    v_cvt_pk_bf16_f32 v101, v138, v139
    v_cvt_pk_bf16_f32 v102, v140, v141
    v_cvt_pk_bf16_f32 v103, v142, v143
    buffer_store_dwordx4 v[100:103], v3, s[28:31], s52 offen offset:1024 sc1
    v_mul_f32 v144, v144, v91
    v_mul_f32 v145, v145, v91
    v_mul_f32 v146, v146, v91
    v_mul_f32 v147, v147, v91
    v_mul_f32 v148, v148, v91
    v_mul_f32 v149, v149, v91
    v_mul_f32 v150, v150, v91
    v_mul_f32 v151, v151, v91
    v_cvt_pk_bf16_f32 v104, v144, v145
    v_cvt_pk_bf16_f32 v105, v146, v147
    v_cvt_pk_bf16_f32 v106, v148, v149
    v_cvt_pk_bf16_f32 v107, v150, v151
    buffer_store_dwordx4 v[104:107], v3, s[28:31], s52 offen offset:2048 sc1
    v_mul_f32 v152, v152, v91
    v_mul_f32 v153, v153, v91
    v_mul_f32 v154, v154, v91
    v_mul_f32 v155, v155, v91
    v_mul_f32 v156, v156, v91
    v_mul_f32 v157, v157, v91
    v_mul_f32 v158, v158, v91
    v_mul_f32 v159, v159, v91
    v_cvt_pk_bf16_f32 v108, v152, v153
    v_cvt_pk_bf16_f32 v109, v154, v155
    v_cvt_pk_bf16_f32 v110, v156, v157
    v_cvt_pk_bf16_f32 v111, v158, v159
    buffer_store_dwordx4 v[108:111], v3, s[28:31], s52 offen offset:3072 sc1
    v_mul_f32 v160, v160, v91
    v_mul_f32 v161, v161, v91
    v_mul_f32 v162, v162, v91
    v_mul_f32 v163, v163, v91
    v_mul_f32 v164, v164, v91
    v_mul_f32 v165, v165, v91
    v_mul_f32 v166, v166, v91
    v_mul_f32 v167, v167, v91
    v_cvt_pk_bf16_f32 v112, v160, v161
    v_cvt_pk_bf16_f32 v113, v162, v163
    v_cvt_pk_bf16_f32 v114, v164, v165
    v_cvt_pk_bf16_f32 v115, v166, v167
    s_add_u32 s52, s52, 4096
    buffer_store_dwordx4 v[112:115], v3, s[28:31], s52 offen offset:0 sc1
    v_mul_f32 v168, v168, v91
    v_mul_f32 v169, v169, v91
    v_mul_f32 v170, v170, v91
    v_mul_f32 v171, v171, v91
    v_mul_f32 v172, v172, v91
    v_mul_f32 v173, v173, v91
    v_mul_f32 v174, v174, v91
    v_mul_f32 v175, v175, v91
    v_cvt_pk_bf16_f32 v116, v168, v169
    v_cvt_pk_bf16_f32 v117, v170, v171
    v_cvt_pk_bf16_f32 v118, v172, v173
    v_cvt_pk_bf16_f32 v119, v174, v175
    buffer_store_dwordx4 v[116:119], v3, s[28:31], s52 offen offset:1024 sc1
    v_mul_f32 v176, v176, v91
    v_mul_f32 v177, v177, v91
    v_mul_f32 v178, v178, v91
    v_mul_f32 v179, v179, v91
    v_mul_f32 v180, v180, v91
    v_mul_f32 v181, v181, v91
    v_mul_f32 v182, v182, v91
    v_mul_f32 v183, v183, v91
    v_cvt_pk_bf16_f32 v120, v176, v177
    v_cvt_pk_bf16_f32 v121, v178, v179
    v_cvt_pk_bf16_f32 v122, v180, v181
    v_cvt_pk_bf16_f32 v123, v182, v183
    buffer_store_dwordx4 v[120:123], v3, s[28:31], s52 offen offset:2048 sc1
    v_mul_f32 v184, v184, v91
    v_mul_f32 v185, v185, v91
    v_mul_f32 v186, v186, v91
    v_mul_f32 v187, v187, v91
    v_mul_f32 v188, v188, v91
    v_mul_f32 v189, v189, v91
    v_mul_f32 v190, v190, v91
    v_mul_f32 v191, v191, v91
    v_cvt_pk_bf16_f32 v124, v184, v185
    v_cvt_pk_bf16_f32 v125, v186, v187
    v_cvt_pk_bf16_f32 v126, v188, v189
    v_cvt_pk_bf16_f32 v127, v190, v191
    buffer_store_dwordx4 v[124:127], v3, s[28:31], s52 offen offset:3072 sc1
    v_mov_b32 v128, 0
    v_mov_b32 v129, 0
    v_mov_b32 v130, 0
    v_mov_b32 v131, 0
    v_mov_b32 v132, 0
    v_mov_b32 v133, 0
    v_mov_b32 v134, 0
    v_mov_b32 v135, 0
    v_mov_b32 v136, 0
    v_mov_b32 v137, 0
    v_mov_b32 v138, 0
    v_mov_b32 v139, 0
    v_mov_b32 v140, 0
    v_mov_b32 v141, 0
    v_mov_b32 v142, 0
    v_mov_b32 v143, 0
    v_mov_b32 v144, 0
    v_mov_b32 v145, 0
    v_mov_b32 v146, 0
    v_mov_b32 v147, 0
    v_mov_b32 v148, 0
    v_mov_b32 v149, 0
    v_mov_b32 v150, 0
    v_mov_b32 v151, 0
    v_mov_b32 v152, 0
    v_mov_b32 v153, 0
    v_mov_b32 v154, 0
    v_mov_b32 v155, 0
    v_mov_b32 v156, 0
    v_mov_b32 v157, 0
    v_mov_b32 v158, 0
    v_mov_b32 v159, 0
    v_mov_b32 v160, 0
    v_mov_b32 v161, 0
    v_mov_b32 v162, 0
    v_mov_b32 v163, 0
    v_mov_b32 v164, 0
    v_mov_b32 v165, 0
    v_mov_b32 v166, 0
    v_mov_b32 v167, 0
    v_mov_b32 v168, 0
    v_mov_b32 v169, 0
    v_mov_b32 v170, 0
    v_mov_b32 v171, 0
    v_mov_b32 v172, 0
    v_mov_b32 v173, 0
    v_mov_b32 v174, 0
    v_mov_b32 v175, 0
    v_mov_b32 v176, 0
    v_mov_b32 v177, 0
    v_mov_b32 v178, 0
    v_mov_b32 v179, 0
    v_mov_b32 v180, 0
    v_mov_b32 v181, 0
    v_mov_b32 v182, 0
    v_mov_b32 v183, 0
    v_mov_b32 v184, 0
    v_mov_b32 v185, 0
    v_mov_b32 v186, 0
    v_mov_b32 v187, 0
    v_mov_b32 v188, 0
    v_mov_b32 v189, 0
    v_mov_b32 v190, 0
    v_mov_b32 v191, 0
    v_mov_b32 v224, 0
    v_mov_b32 v225, 0
    v_mov_b32 v226, 0
    v_mov_b32 v227, 0
    v_mov_b32 v228, 0
    v_mov_b32 v229, 0
    v_mov_b32 v230, 0
    v_mov_b32 v231, 0
    v_mov_b32 v232, 0
    v_mov_b32 v233, 0
    v_mov_b32 v234, 0
    v_mov_b32 v235, 0
    v_mov_b32 v236, 0
    v_mov_b32 v237, 0
    v_mov_b32 v238, 0
    v_mov_b32 v239, 0
    v_mov_b32 v90, 0
    s_mov_b32 s42, 0xbf800000
    s_mov_b32 s43, 0xf149f2ca
    s_mov_b32 s49, 1088
    s_sub_u32 s52, 15, s37
    s_lshl_b32 s52, s52, 7
    s_lshl_b32 s53, s34, 5
    s_add_u32 s50, s52, s53
    s_waitcnt lgkmcnt(0)
    s_branch .Lk2_loop
.Lkvproj_kernel_mask_30:
    s_sub_u32 s52, s50, s49
    s_sub_u32 s52, s52, 0
    v_add_u32 v91, s52, v14
    v_mov_b32 v92, 0xff800000
    v_cmp_gt_i32 s[68:69], 0, v91
    v_cmp_gt_i32 s[70:71], 1, v91
    v_cmp_gt_i32 s[72:73], 2, v91
    v_cmp_gt_i32 s[74:75], 3, v91
    v_cmp_gt_i32 s[76:77], 8, v91
    v_cmp_gt_i32 s[78:79], 9, v91
    v_cmp_gt_i32 s[80:81], 10, v91
    v_cmp_gt_i32 s[82:83], 11, v91
    v_cmp_gt_i32 s[84:85], 16, v91
    v_cmp_gt_i32 s[86:87], 17, v91
    v_cmp_gt_i32 s[88:89], 18, v91
    v_cmp_gt_i32 s[90:91], 19, v91
    v_cmp_gt_i32 s[92:93], 24, v91
    v_cmp_gt_i32 s[94:95], 25, v91
    v_cmp_gt_i32 s[96:97], 26, v91
    v_cmp_gt_i32 s[98:99], 27, v91
    v_cndmask_b32 v192, v192, v92, s[68:69]
    v_cndmask_b32 v193, v193, v92, s[70:71]
    v_cndmask_b32 v194, v194, v92, s[72:73]
    v_cndmask_b32 v195, v195, v92, s[74:75]
    v_cndmask_b32 v196, v196, v92, s[76:77]
    v_cndmask_b32 v197, v197, v92, s[78:79]
    v_cndmask_b32 v198, v198, v92, s[80:81]
    v_cndmask_b32 v199, v199, v92, s[82:83]
    v_cndmask_b32 v200, v200, v92, s[84:85]
    v_cndmask_b32 v201, v201, v92, s[86:87]
    v_cndmask_b32 v202, v202, v92, s[88:89]
    v_cndmask_b32 v203, v203, v92, s[90:91]
    v_cndmask_b32 v204, v204, v92, s[92:93]
    v_cndmask_b32 v205, v205, v92, s[94:95]
    v_cndmask_b32 v206, v206, v92, s[96:97]
    v_cndmask_b32 v207, v207, v92, s[98:99]
    s_branch .Lkvproj_kernel_mret_31
.Lkvproj_kernel_fb_33:
    v_max3_f32 v91, v192, v193, v194
    v_max3_f32 v91, v91, v195, v196
    v_max3_f32 v91, v91, v197, v198
    v_max3_f32 v91, v91, v199, s43
    v_mov_b32 v92, v91
    s_nop 1
    v_permlane32_swap_b32 v91, v92
    v_max_f32 v91, v91, v92
    v_min_f32_e64 v92, -v91, 0
    v_exp_f32 v92, v92
    v_sub_f32 v192, v192, v91
    v_sub_f32 v193, v193, v91
    v_sub_f32 v194, v194, v91
    v_sub_f32 v195, v195, v91
    v_sub_f32 v196, v196, v91
    v_sub_f32 v197, v197, v91
    v_sub_f32 v198, v198, v91
    v_sub_f32 v199, v199, v91
    v_sub_f32 v200, v200, v91
    v_sub_f32 v201, v201, v91
    v_sub_f32 v202, v202, v91
    v_sub_f32 v203, v203, v91
    v_sub_f32 v204, v204, v91
    v_sub_f32 v205, v205, v91
    v_sub_f32 v206, v206, v91
    v_sub_f32 v207, v207, v91
    v_sub_f32 v208, v208, v91
    v_sub_f32 v209, v209, v91
    v_sub_f32 v210, v210, v91
    v_sub_f32 v211, v211, v91
    v_sub_f32 v212, v212, v91
    v_sub_f32 v213, v213, v91
    v_sub_f32 v214, v214, v91
    v_sub_f32 v215, v215, v91
    v_sub_f32 v216, v216, v91
    v_sub_f32 v217, v217, v91
    v_sub_f32 v218, v218, v91
    v_sub_f32 v219, v219, v91
    v_sub_f32 v220, v220, v91
    v_sub_f32 v221, v221, v91
    v_sub_f32 v222, v222, v91
    v_sub_f32 v223, v223, v91
    v_sub_f32 v224, v224, v91
    v_sub_f32 v225, v225, v91
    v_sub_f32 v226, v226, v91
    v_sub_f32 v227, v227, v91
    v_sub_f32 v228, v228, v91
    v_sub_f32 v229, v229, v91
    v_sub_f32 v230, v230, v91
    v_sub_f32 v231, v231, v91
    v_sub_f32 v232, v232, v91
    v_sub_f32 v233, v233, v91
    v_sub_f32 v234, v234, v91
    v_sub_f32 v235, v235, v91
    v_sub_f32 v236, v236, v91
    v_sub_f32 v237, v237, v91
    v_sub_f32 v238, v238, v91
    v_sub_f32 v239, v239, v91
    s_cmp_lg_u32 s43, 0
    s_cbranch_scc1 .Lkvproj_kernel_fsk_45
    v_mul_f32 v128, v128, v92
    v_mul_f32 v129, v129, v92
    v_mul_f32 v130, v130, v92
    v_mul_f32 v131, v131, v92
    v_mul_f32 v132, v132, v92
    v_mul_f32 v133, v133, v92
    v_mul_f32 v134, v134, v92
    v_mul_f32 v135, v135, v92
    v_mul_f32 v136, v136, v92
    v_mul_f32 v137, v137, v92
    v_mul_f32 v138, v138, v92
    v_mul_f32 v139, v139, v92
    v_mul_f32 v140, v140, v92
    v_mul_f32 v141, v141, v92
    v_mul_f32 v142, v142, v92
    v_mul_f32 v143, v143, v92
    v_mul_f32 v144, v144, v92
    v_mul_f32 v145, v145, v92
    v_mul_f32 v146, v146, v92
    v_mul_f32 v147, v147, v92
    v_mul_f32 v148, v148, v92
    v_mul_f32 v149, v149, v92
    v_mul_f32 v150, v150, v92
    v_mul_f32 v151, v151, v92
    v_mul_f32 v152, v152, v92
    v_mul_f32 v153, v153, v92
    v_mul_f32 v154, v154, v92
    v_mul_f32 v155, v155, v92
    v_mul_f32 v156, v156, v92
    v_mul_f32 v157, v157, v92
    v_mul_f32 v158, v158, v92
    v_mul_f32 v159, v159, v92
    v_mul_f32 v160, v160, v92
    v_mul_f32 v161, v161, v92
    v_mul_f32 v162, v162, v92
    v_mul_f32 v163, v163, v92
    v_mul_f32 v164, v164, v92
    v_mul_f32 v165, v165, v92
    v_mul_f32 v166, v166, v92
    v_mul_f32 v167, v167, v92
    v_mul_f32 v168, v168, v92
    v_mul_f32 v169, v169, v92
    v_mul_f32 v170, v170, v92
    v_mul_f32 v171, v171, v92
    v_mul_f32 v172, v172, v92
    v_mul_f32 v173, v173, v92
    v_mul_f32 v174, v174, v92
    v_mul_f32 v175, v175, v92
    v_mul_f32 v176, v176, v92
    v_mul_f32 v177, v177, v92
    v_mul_f32 v178, v178, v92
    v_mul_f32 v179, v179, v92
    v_mul_f32 v180, v180, v92
    v_mul_f32 v181, v181, v92
    v_mul_f32 v182, v182, v92
    v_mul_f32 v183, v183, v92
    v_mul_f32 v184, v184, v92
    v_mul_f32 v185, v185, v92
    v_mul_f32 v186, v186, v92
    v_mul_f32 v187, v187, v92
    v_mul_f32 v188, v188, v92
    v_mul_f32 v189, v189, v92
    v_mul_f32 v190, v190, v92
    v_mul_f32 v191, v191, v92
    v_mul_f32 v90, v90, v92
.Lkvproj_kernel_fsk_45:
    s_mov_b32 s42, 0x4b800000
    s_mov_b32 s43, 0
    v_exp_f32 v80, v192
    v_exp_f32 v81, v193
    v_exp_f32 v82, v194
    v_add_f32 v88, v80, v81
    v_exp_f32 v83, v195
    v_cvt_pk_bf16_f32 v240, v80, v81
    v_exp_f32 v84, v196
    v_add_f32 v88, v88, v82
    v_exp_f32 v85, v197
    v_add_f32 v88, v88, v83
    v_cvt_pk_bf16_f32 v241, v82, v83
    v_exp_f32 v86, v198
    v_add_f32 v88, v88, v84
    v_exp_f32 v87, v199
    v_add_f32 v88, v88, v85
    v_cvt_pk_bf16_f32 v242, v84, v85
    v_add_f32 v88, v88, v86
    v_add_f32 v88, v88, v87
    v_cvt_pk_bf16_f32 v243, v86, v87
    s_branch .Lkvproj_kernel_fret_34
.Lkvproj_kernel_mask_35:
    s_sub_u32 s52, s50, s49
    s_sub_u32 s52, s52, 32
    v_add_u32 v91, s52, v14
    v_mov_b32 v92, 0xff800000
    v_cmp_gt_i32 s[68:69], 0, v91
    v_cmp_gt_i32 s[70:71], 1, v91
    v_cmp_gt_i32 s[72:73], 2, v91
    v_cmp_gt_i32 s[74:75], 3, v91
    v_cmp_gt_i32 s[76:77], 8, v91
    v_cmp_gt_i32 s[78:79], 9, v91
    v_cmp_gt_i32 s[80:81], 10, v91
    v_cmp_gt_i32 s[82:83], 11, v91
    v_cmp_gt_i32 s[84:85], 16, v91
    v_cmp_gt_i32 s[86:87], 17, v91
    v_cmp_gt_i32 s[88:89], 18, v91
    v_cmp_gt_i32 s[90:91], 19, v91
    v_cmp_gt_i32 s[92:93], 24, v91
    v_cmp_gt_i32 s[94:95], 25, v91
    v_cmp_gt_i32 s[96:97], 26, v91
    v_cmp_gt_i32 s[98:99], 27, v91
    v_cndmask_b32 v208, v208, v92, s[68:69]
    v_cndmask_b32 v209, v209, v92, s[70:71]
    v_cndmask_b32 v210, v210, v92, s[72:73]
    v_cndmask_b32 v211, v211, v92, s[74:75]
    v_cndmask_b32 v212, v212, v92, s[76:77]
    v_cndmask_b32 v213, v213, v92, s[78:79]
    v_cndmask_b32 v214, v214, v92, s[80:81]
    v_cndmask_b32 v215, v215, v92, s[82:83]
    v_cndmask_b32 v216, v216, v92, s[84:85]
    v_cndmask_b32 v217, v217, v92, s[86:87]
    v_cndmask_b32 v218, v218, v92, s[88:89]
    v_cndmask_b32 v219, v219, v92, s[90:91]
    v_cndmask_b32 v220, v220, v92, s[92:93]
    v_cndmask_b32 v221, v221, v92, s[94:95]
    v_cndmask_b32 v222, v222, v92, s[96:97]
    v_cndmask_b32 v223, v223, v92, s[98:99]
    s_branch .Lkvproj_kernel_mret_36
.Lkvproj_kernel_fb_37:
    v_max3_f32 v91, v200, v201, v202
    v_max3_f32 v91, v91, v203, v204
    v_max3_f32 v91, v91, v205, v206
    v_max3_f32 v91, v91, v207, s43
    v_mov_b32 v92, v91
    s_nop 1
    v_permlane32_swap_b32 v91, v92
    v_max_f32 v91, v91, v92
    v_min_f32_e64 v92, -v91, 0
    v_exp_f32 v92, v92
    v_sub_f32 v200, v200, v91
    v_sub_f32 v201, v201, v91
    v_sub_f32 v202, v202, v91
    v_sub_f32 v203, v203, v91
    v_sub_f32 v204, v204, v91
    v_sub_f32 v205, v205, v91
    v_sub_f32 v206, v206, v91
    v_sub_f32 v207, v207, v91
    v_sub_f32 v208, v208, v91
    v_sub_f32 v209, v209, v91
    v_sub_f32 v210, v210, v91
    v_sub_f32 v211, v211, v91
    v_sub_f32 v212, v212, v91
    v_sub_f32 v213, v213, v91
    v_sub_f32 v214, v214, v91
    v_sub_f32 v215, v215, v91
    v_sub_f32 v216, v216, v91
    v_sub_f32 v217, v217, v91
    v_sub_f32 v218, v218, v91
    v_sub_f32 v219, v219, v91
    v_sub_f32 v220, v220, v91
    v_sub_f32 v221, v221, v91
    v_sub_f32 v222, v222, v91
    v_sub_f32 v223, v223, v91
    v_sub_f32 v224, v224, v91
    v_sub_f32 v225, v225, v91
    v_sub_f32 v226, v226, v91
    v_sub_f32 v227, v227, v91
    v_sub_f32 v228, v228, v91
    v_sub_f32 v229, v229, v91
    v_sub_f32 v230, v230, v91
    v_sub_f32 v231, v231, v91
    v_sub_f32 v232, v232, v91
    v_sub_f32 v233, v233, v91
    v_sub_f32 v234, v234, v91
    v_sub_f32 v235, v235, v91
    v_sub_f32 v236, v236, v91
    v_sub_f32 v237, v237, v91
    v_sub_f32 v238, v238, v91
    v_sub_f32 v239, v239, v91
    v_mul_f32 v128, v128, v92
    v_mul_f32 v129, v129, v92
    v_mul_f32 v130, v130, v92
    v_mul_f32 v131, v131, v92
    v_mul_f32 v132, v132, v92
    v_mul_f32 v133, v133, v92
    v_mul_f32 v134, v134, v92
    v_mul_f32 v135, v135, v92
    v_mul_f32 v136, v136, v92
    v_mul_f32 v137, v137, v92
    v_mul_f32 v138, v138, v92
    v_mul_f32 v139, v139, v92
    v_mul_f32 v140, v140, v92
    v_mul_f32 v141, v141, v92
    v_mul_f32 v142, v142, v92
    v_mul_f32 v143, v143, v92
    v_mul_f32 v144, v144, v92
    v_mul_f32 v145, v145, v92
    v_mul_f32 v146, v146, v92
    v_mul_f32 v147, v147, v92
    v_mul_f32 v148, v148, v92
    v_mul_f32 v149, v149, v92
    v_mul_f32 v150, v150, v92
    v_mul_f32 v151, v151, v92
    v_mul_f32 v152, v152, v92
    v_mul_f32 v153, v153, v92
    v_mul_f32 v154, v154, v92
    v_mul_f32 v155, v155, v92
    v_mul_f32 v156, v156, v92
    v_mul_f32 v157, v157, v92
    v_mul_f32 v158, v158, v92
    v_mul_f32 v159, v159, v92
    v_mul_f32 v160, v160, v92
    v_mul_f32 v161, v161, v92
    v_mul_f32 v162, v162, v92
    v_mul_f32 v163, v163, v92
    v_mul_f32 v164, v164, v92
    v_mul_f32 v165, v165, v92
    v_mul_f32 v166, v166, v92
    v_mul_f32 v167, v167, v92
    v_mul_f32 v168, v168, v92
    v_mul_f32 v169, v169, v92
    v_mul_f32 v170, v170, v92
    v_mul_f32 v171, v171, v92
    v_mul_f32 v172, v172, v92
    v_mul_f32 v173, v173, v92
    v_mul_f32 v174, v174, v92
    v_mul_f32 v175, v175, v92
    v_mul_f32 v176, v176, v92
    v_mul_f32 v177, v177, v92
    v_mul_f32 v178, v178, v92
    v_mul_f32 v179, v179, v92
    v_mul_f32 v180, v180, v92
    v_mul_f32 v181, v181, v92
    v_mul_f32 v182, v182, v92
    v_mul_f32 v183, v183, v92
    v_mul_f32 v184, v184, v92
    v_mul_f32 v185, v185, v92
    v_mul_f32 v186, v186, v92
    v_mul_f32 v187, v187, v92
    v_mul_f32 v188, v188, v92
    v_mul_f32 v189, v189, v92
    v_mul_f32 v190, v190, v92
    v_mul_f32 v191, v191, v92
    v_mul_f32 v90, v90, v92
    s_mov_b32 s42, 0x4b800000
    s_mov_b32 s43, 0
    v_exp_f32 v80, v200
    v_exp_f32 v81, v201
    v_exp_f32 v82, v202
    v_add_f32 v89, v80, v81
    v_exp_f32 v83, v203
    v_cvt_pk_bf16_f32 v244, v80, v81
    v_exp_f32 v84, v204
    v_add_f32 v89, v89, v82
    v_exp_f32 v85, v205
    v_add_f32 v89, v89, v83
    v_cvt_pk_bf16_f32 v245, v82, v83
    v_exp_f32 v86, v206
    v_add_f32 v89, v89, v84
    v_exp_f32 v87, v207
    v_add_f32 v89, v89, v85
    v_cvt_pk_bf16_f32 v246, v84, v85
    v_add_f32 v89, v89, v86
    v_add_f32 v89, v89, v87
    v_cvt_pk_bf16_f32 v247, v86, v87
    s_branch .Lkvproj_kernel_fret_38
.Lkvproj_kernel_fb_39:
    v_max3_f32 v91, v208, v209, v210
    v_max3_f32 v91, v91, v211, v212
    v_max3_f32 v91, v91, v213, v214
    v_max3_f32 v91, v91, v215, s43
    v_mov_b32 v92, v91
    s_nop 1
    v_permlane32_swap_b32 v91, v92
    v_max_f32 v91, v91, v92
    v_min_f32_e64 v92, -v91, 0
    v_exp_f32 v92, v92
    v_sub_f32 v208, v208, v91
    v_sub_f32 v209, v209, v91
    v_sub_f32 v210, v210, v91
    v_sub_f32 v211, v211, v91
    v_sub_f32 v212, v212, v91
    v_sub_f32 v213, v213, v91
    v_sub_f32 v214, v214, v91
    v_sub_f32 v215, v215, v91
    v_sub_f32 v216, v216, v91
    v_sub_f32 v217, v217, v91
    v_sub_f32 v218, v218, v91
    v_sub_f32 v219, v219, v91
    v_sub_f32 v220, v220, v91
    v_sub_f32 v221, v221, v91
    v_sub_f32 v222, v222, v91
    v_sub_f32 v223, v223, v91
    v_sub_f32 v224, v224, v91
    v_sub_f32 v225, v225, v91
    v_sub_f32 v226, v226, v91
    v_sub_f32 v227, v227, v91
    v_sub_f32 v228, v228, v91
    v_sub_f32 v229, v229, v91
    v_sub_f32 v230, v230, v91
    v_sub_f32 v231, v231, v91
    v_sub_f32 v232, v232, v91
    v_sub_f32 v233, v233, v91
    v_sub_f32 v234, v234, v91
    v_sub_f32 v235, v235, v91
    v_sub_f32 v236, v236, v91
    v_sub_f32 v237, v237, v91
    v_sub_f32 v238, v238, v91
    v_sub_f32 v239, v239, v91
    v_mul_f32 v128, v128, v92
    v_mul_f32 v129, v129, v92
    v_mul_f32 v130, v130, v92
    v_mul_f32 v131, v131, v92
    v_mul_f32 v132, v132, v92
    v_mul_f32 v133, v133, v92
    v_mul_f32 v134, v134, v92
    v_mul_f32 v135, v135, v92
    v_mul_f32 v136, v136, v92
    v_mul_f32 v137, v137, v92
    v_mul_f32 v138, v138, v92
    v_mul_f32 v139, v139, v92
    v_mul_f32 v140, v140, v92
    v_mul_f32 v141, v141, v92
    v_mul_f32 v142, v142, v92
    v_mul_f32 v143, v143, v92
    v_mul_f32 v144, v144, v92
    v_mul_f32 v145, v145, v92
    v_mul_f32 v146, v146, v92
    v_mul_f32 v147, v147, v92
    v_mul_f32 v148, v148, v92
    v_mul_f32 v149, v149, v92
    v_mul_f32 v150, v150, v92
    v_mul_f32 v151, v151, v92
    v_mul_f32 v152, v152, v92
    v_mul_f32 v153, v153, v92
    v_mul_f32 v154, v154, v92
    v_mul_f32 v155, v155, v92
    v_mul_f32 v156, v156, v92
    v_mul_f32 v157, v157, v92
    v_mul_f32 v158, v158, v92
    v_mul_f32 v159, v159, v92
    v_mul_f32 v160, v160, v92
    v_mul_f32 v161, v161, v92
    v_mul_f32 v162, v162, v92
    v_mul_f32 v163, v163, v92
    v_mul_f32 v164, v164, v92
    v_mul_f32 v165, v165, v92
    v_mul_f32 v166, v166, v92
    v_mul_f32 v167, v167, v92
    v_mul_f32 v168, v168, v92
    v_mul_f32 v169, v169, v92
    v_mul_f32 v170, v170, v92
    v_mul_f32 v171, v171, v92
    v_mul_f32 v172, v172, v92
    v_mul_f32 v173, v173, v92
    v_mul_f32 v174, v174, v92
    v_mul_f32 v175, v175, v92
    v_mul_f32 v176, v176, v92
    v_mul_f32 v177, v177, v92
    v_mul_f32 v178, v178, v92
    v_mul_f32 v179, v179, v92
    v_mul_f32 v180, v180, v92
    v_mul_f32 v181, v181, v92
    v_mul_f32 v182, v182, v92
    v_mul_f32 v183, v183, v92
    v_mul_f32 v184, v184, v92
    v_mul_f32 v185, v185, v92
    v_mul_f32 v186, v186, v92
    v_mul_f32 v187, v187, v92
    v_mul_f32 v188, v188, v92
    v_mul_f32 v189, v189, v92
    v_mul_f32 v190, v190, v92
    v_mul_f32 v191, v191, v92
    v_mul_f32 v90, v90, v92
    s_mov_b32 s42, 0x4b800000
    s_mov_b32 s43, 0
    v_exp_f32 v80, v208
    v_exp_f32 v81, v209
    v_exp_f32 v82, v210
    v_add_f32 v88, v80, v81
    v_exp_f32 v83, v211
    v_cvt_pk_bf16_f32 v248, v80, v81
    v_exp_f32 v84, v212
    v_add_f32 v88, v88, v82
    v_exp_f32 v85, v213
    v_add_f32 v88, v88, v83
    v_cvt_pk_bf16_f32 v249, v82, v83
    v_exp_f32 v86, v214
    v_add_f32 v88, v88, v84
    v_exp_f32 v87, v215
    v_add_f32 v88, v88, v85
    v_cvt_pk_bf16_f32 v250, v84, v85
    v_add_f32 v88, v88, v86
    v_add_f32 v88, v88, v87
    v_cvt_pk_bf16_f32 v251, v86, v87
    s_branch .Lkvproj_kernel_fret_40
.Lkvproj_kernel_fb_41:
    v_max3_f32 v91, v216, v217, v218
    v_max3_f32 v91, v91, v219, v220
    v_max3_f32 v91, v91, v221, v222
    v_max3_f32 v91, v91, v223, s43
    v_mov_b32 v92, v91
    s_nop 1
    v_permlane32_swap_b32 v91, v92
    v_max_f32 v91, v91, v92
    v_min_f32_e64 v92, -v91, 0
    v_exp_f32 v92, v92
    v_sub_f32 v216, v216, v91
    v_sub_f32 v217, v217, v91
    v_sub_f32 v218, v218, v91
    v_sub_f32 v219, v219, v91
    v_sub_f32 v220, v220, v91
    v_sub_f32 v221, v221, v91
    v_sub_f32 v222, v222, v91
    v_sub_f32 v223, v223, v91
    v_sub_f32 v224, v224, v91
    v_sub_f32 v225, v225, v91
    v_sub_f32 v226, v226, v91
    v_sub_f32 v227, v227, v91
    v_sub_f32 v228, v228, v91
    v_sub_f32 v229, v229, v91
    v_sub_f32 v230, v230, v91
    v_sub_f32 v231, v231, v91
    v_sub_f32 v232, v232, v91
    v_sub_f32 v233, v233, v91
    v_sub_f32 v234, v234, v91
    v_sub_f32 v235, v235, v91
    v_sub_f32 v236, v236, v91
    v_sub_f32 v237, v237, v91
    v_sub_f32 v238, v238, v91
    v_sub_f32 v239, v239, v91
    v_mul_f32 v128, v128, v92
    v_mul_f32 v129, v129, v92
    v_mul_f32 v130, v130, v92
    v_mul_f32 v131, v131, v92
    v_mul_f32 v132, v132, v92
    v_mul_f32 v133, v133, v92
    v_mul_f32 v134, v134, v92
    v_mul_f32 v135, v135, v92
    v_mul_f32 v136, v136, v92
    v_mul_f32 v137, v137, v92
    v_mul_f32 v138, v138, v92
    v_mul_f32 v139, v139, v92
    v_mul_f32 v140, v140, v92
    v_mul_f32 v141, v141, v92
    v_mul_f32 v142, v142, v92
    v_mul_f32 v143, v143, v92
    v_mul_f32 v144, v144, v92
    v_mul_f32 v145, v145, v92
    v_mul_f32 v146, v146, v92
    v_mul_f32 v147, v147, v92
    v_mul_f32 v148, v148, v92
    v_mul_f32 v149, v149, v92
    v_mul_f32 v150, v150, v92
    v_mul_f32 v151, v151, v92
    v_mul_f32 v152, v152, v92
    v_mul_f32 v153, v153, v92
    v_mul_f32 v154, v154, v92
    v_mul_f32 v155, v155, v92
    v_mul_f32 v156, v156, v92
    v_mul_f32 v157, v157, v92
    v_mul_f32 v158, v158, v92
    v_mul_f32 v159, v159, v92
    v_mul_f32 v160, v160, v92
    v_mul_f32 v161, v161, v92
    v_mul_f32 v162, v162, v92
    v_mul_f32 v163, v163, v92
    v_mul_f32 v164, v164, v92
    v_mul_f32 v165, v165, v92
    v_mul_f32 v166, v166, v92
    v_mul_f32 v167, v167, v92
    v_mul_f32 v168, v168, v92
    v_mul_f32 v169, v169, v92
    v_mul_f32 v170, v170, v92
    v_mul_f32 v171, v171, v92
    v_mul_f32 v172, v172, v92
    v_mul_f32 v173, v173, v92
    v_mul_f32 v174, v174, v92
    v_mul_f32 v175, v175, v92
    v_mul_f32 v176, v176, v92
    v_mul_f32 v177, v177, v92
    v_mul_f32 v178, v178, v92
    v_mul_f32 v179, v179, v92
    v_mul_f32 v180, v180, v92
    v_mul_f32 v181, v181, v92
    v_mul_f32 v182, v182, v92
    v_mul_f32 v183, v183, v92
    v_mul_f32 v184, v184, v92
    v_mul_f32 v185, v185, v92
    v_mul_f32 v186, v186, v92
    v_mul_f32 v187, v187, v92
    v_mul_f32 v188, v188, v92
    v_mul_f32 v189, v189, v92
    v_mul_f32 v190, v190, v92
    v_mul_f32 v191, v191, v92
    v_mul_f32 v90, v90, v92
    s_mov_b32 s42, 0x4b800000
    s_mov_b32 s43, 0
    v_exp_f32 v80, v216
    v_exp_f32 v81, v217
    v_exp_f32 v82, v218
    v_add_f32 v89, v80, v81
    v_exp_f32 v83, v219
    v_cvt_pk_bf16_f32 v252, v80, v81
    v_exp_f32 v84, v220
    v_add_f32 v89, v89, v82
    v_exp_f32 v85, v221
    v_add_f32 v89, v89, v83
    v_cvt_pk_bf16_f32 v253, v82, v83
    v_exp_f32 v86, v222
    v_add_f32 v89, v89, v84
    v_exp_f32 v87, v223
    v_add_f32 v89, v89, v85
    v_cvt_pk_bf16_f32 v254, v84, v85
    v_add_f32 v89, v89, v86
    v_add_f32 v89, v89, v87
    v_cvt_pk_bf16_f32 v255, v86, v87
    s_branch .Lkvproj_kernel_fret_42
.Lk2_final:
    s_add_u32 s88, s62, 0x6000000
    s_addc_u32 s89, s63, 0
    s_and_b32 s89, s89, 0xffff
    s_mov_b32 s90, 0x60000
    s_mov_b32 s91, 0x00020000
    s_sub_u32 s52, 7, s37
    s_bitcmp1_b32 s2, 0
    s_cselect_b32 s52, s52, s37
    s_lshl_b32 s52, s52, 13
    v_and_b32 v10, 31, v0
    v_lshl_add_u32 v10, v10, 8, s52
    s_cmp_lg_u32 s32, 0
    s_cselect_b32 s94, 0x4000, 4
    s_lshl_b32 s94, s94, 16
    v_add_u32 v10, s94, v10
    v_mov_b32 v11, 0
    buffer_load_dword v11, v10, s[88:91], 0 offen
    s_waitcnt lgkmcnt(0)
    v_mov_b32 v91, v90
    s_nop 1
    v_permlane32_swap_b32 v91, v90
    v_add_f32 v90, v90, v91
    v_mov_b32 v91, v224
    s_mul_i32 s52, s32, 0x2400
    s_xor_b32 s53, s32, 4
    s_mul_i32 s53, s53, 0x2400
    v_add_u32 v5, s52, v3
    v_add_u32 v6, s53, v3
    s_cmp_eq_u32 s35, 0
    s_cbranch_scc1 .Lk2_finA
    ds_write_b128 v5, v[128:131] offset:0
    ds_write_b128 v5, v[132:135] offset:1024
    ds_write_b128 v5, v[136:139] offset:2048
    ds_write_b128 v5, v[140:143] offset:3072
    ds_write_b128 v5, v[144:147] offset:4096
    ds_write_b128 v5, v[148:151] offset:5120
    ds_write_b128 v5, v[152:155] offset:6144
    ds_write_b128 v5, v[156:159] offset:7168
    ds_write_b64 v5, v[90:91] offset:8192
    s_waitcnt lgkmcnt(0)
    s_barrier
    ds_read_b64 v[92:93], v6 offset:8192
    ds_read_b128 v[96:99], v6 offset:0
    ds_read_b128 v[100:103], v6 offset:1024
    ds_read_b128 v[104:107], v6 offset:2048
    ds_read_b128 v[108:111], v6 offset:3072
    ds_read_b128 v[112:115], v6 offset:4096
    ds_read_b128 v[116:119], v6 offset:5120
    ds_read_b128 v[120:123], v6 offset:6144
    ds_read_b128 v[124:127], v6 offset:7168
    s_mul_i32 s52, s50, 11776
    s_lshl_b32 s53, s36, 13
    s_add_u32 s52, s52, s53
    s_add_u32 s52, s52, 4096
    s_waitcnt lgkmcnt(8)
    v_min_f32 v94, v91, v93
    v_sub_f32 v80, v94, v91
    v_sub_f32 v81, v94, v93
    v_exp_f32 v80, v80
    v_exp_f32 v81, v81
    v_mul_f32 v90, v90, v80
    v_fmac_f32 v90, v92, v81
    v_rcp_f32 v90, v90
    s_nop 0
    v_mul_f32 v80, v80, v90
    v_mul_f32 v81, v81, v90
    s_waitcnt lgkmcnt(0)
    v_mul_f32 v160, v160, v80
    v_fmac_f32 v160, v96, v81
    v_mul_f32 v161, v161, v80
    v_fmac_f32 v161, v97, v81
    v_mul_f32 v162, v162, v80
    v_fmac_f32 v162, v98, v81
    v_mul_f32 v163, v163, v80
    v_fmac_f32 v163, v99, v81
    v_mul_f32 v164, v164, v80
    v_fmac_f32 v164, v100, v81
    v_mul_f32 v165, v165, v80
    v_fmac_f32 v165, v101, v81
    v_mul_f32 v166, v166, v80
    v_fmac_f32 v166, v102, v81
    v_mul_f32 v167, v167, v80
    v_fmac_f32 v167, v103, v81
    v_cvt_pk_bf16_f32 v240, v160, v161
    v_cvt_pk_bf16_f32 v241, v162, v163
    v_cvt_pk_bf16_f32 v242, v164, v165
    v_cvt_pk_bf16_f32 v243, v166, v167
    buffer_store_dwordx4 v[240:243], v3, s[28:31], s52 offen offset:0 sc1
    v_mul_f32 v168, v168, v80
    v_fmac_f32 v168, v104, v81
    v_mul_f32 v169, v169, v80
    v_fmac_f32 v169, v105, v81
    v_mul_f32 v170, v170, v80
    v_fmac_f32 v170, v106, v81
    v_mul_f32 v171, v171, v80
    v_fmac_f32 v171, v107, v81
    v_mul_f32 v172, v172, v80
    v_fmac_f32 v172, v108, v81
    v_mul_f32 v173, v173, v80
    v_fmac_f32 v173, v109, v81
    v_mul_f32 v174, v174, v80
    v_fmac_f32 v174, v110, v81
    v_mul_f32 v175, v175, v80
    v_fmac_f32 v175, v111, v81
    v_cvt_pk_bf16_f32 v244, v168, v169
    v_cvt_pk_bf16_f32 v245, v170, v171
    v_cvt_pk_bf16_f32 v246, v172, v173
    v_cvt_pk_bf16_f32 v247, v174, v175
    buffer_store_dwordx4 v[244:247], v3, s[28:31], s52 offen offset:1024 sc1
    v_mul_f32 v176, v176, v80
    v_fmac_f32 v176, v112, v81
    v_mul_f32 v177, v177, v80
    v_fmac_f32 v177, v113, v81
    v_mul_f32 v178, v178, v80
    v_fmac_f32 v178, v114, v81
    v_mul_f32 v179, v179, v80
    v_fmac_f32 v179, v115, v81
    v_mul_f32 v180, v180, v80
    v_fmac_f32 v180, v116, v81
    v_mul_f32 v181, v181, v80
    v_fmac_f32 v181, v117, v81
    v_mul_f32 v182, v182, v80
    v_fmac_f32 v182, v118, v81
    v_mul_f32 v183, v183, v80
    v_fmac_f32 v183, v119, v81
    v_cvt_pk_bf16_f32 v248, v176, v177
    v_cvt_pk_bf16_f32 v249, v178, v179
    v_cvt_pk_bf16_f32 v250, v180, v181
    v_cvt_pk_bf16_f32 v251, v182, v183
    buffer_store_dwordx4 v[248:251], v3, s[28:31], s52 offen offset:2048 sc1
    v_mul_f32 v184, v184, v80
    v_fmac_f32 v184, v120, v81
    v_mul_f32 v185, v185, v80
    v_fmac_f32 v185, v121, v81
    v_mul_f32 v186, v186, v80
    v_fmac_f32 v186, v122, v81
    v_mul_f32 v187, v187, v80
    v_fmac_f32 v187, v123, v81
    v_mul_f32 v188, v188, v80
    v_fmac_f32 v188, v124, v81
    v_mul_f32 v189, v189, v80
    v_fmac_f32 v189, v125, v81
    v_mul_f32 v190, v190, v80
    v_fmac_f32 v190, v126, v81
    v_mul_f32 v191, v191, v80
    v_fmac_f32 v191, v127, v81
    v_cvt_pk_bf16_f32 v252, v184, v185
    v_cvt_pk_bf16_f32 v253, v186, v187
    v_cvt_pk_bf16_f32 v254, v188, v189
    v_cvt_pk_bf16_f32 v255, v190, v191
    buffer_store_dwordx4 v[252:255], v3, s[28:31], s52 offen offset:3072 sc1
    s_waitcnt vmcnt(4)
    s_branch .Lk3_begin
.Lk2_finA:
    ds_write_b128 v5, v[160:163] offset:0
    ds_write_b128 v5, v[164:167] offset:1024
    ds_write_b128 v5, v[168:171] offset:2048
    ds_write_b128 v5, v[172:175] offset:3072
    ds_write_b128 v5, v[176:179] offset:4096
    ds_write_b128 v5, v[180:183] offset:5120
    ds_write_b128 v5, v[184:187] offset:6144
    ds_write_b128 v5, v[188:191] offset:7168
    ds_write_b64 v5, v[90:91] offset:8192
    s_waitcnt lgkmcnt(0)
    s_barrier
    ds_read_b64 v[92:93], v6 offset:8192
    ds_read_b128 v[96:99], v6 offset:0
    ds_read_b128 v[100:103], v6 offset:1024
    ds_read_b128 v[104:107], v6 offset:2048
    ds_read_b128 v[108:111], v6 offset:3072
    ds_read_b128 v[112:115], v6 offset:4096
    ds_read_b128 v[116:119], v6 offset:5120
    ds_read_b128 v[120:123], v6 offset:6144
    ds_read_b128 v[124:127], v6 offset:7168
    s_mul_i32 s52, s50, 11776
    s_lshl_b32 s53, s36, 13
    s_add_u32 s52, s52, s53
    s_waitcnt lgkmcnt(8)
    v_min_f32 v94, v91, v93
    v_sub_f32 v80, v94, v91
    v_sub_f32 v81, v94, v93
    v_exp_f32 v80, v80
    v_exp_f32 v81, v81
    v_mul_f32 v90, v90, v80
    v_fmac_f32 v90, v92, v81
    v_rcp_f32 v90, v90
    s_nop 0
    v_mul_f32 v80, v80, v90
    v_mul_f32 v81, v81, v90
    s_waitcnt lgkmcnt(0)
    v_mul_f32 v128, v128, v80
    v_fmac_f32 v128, v96, v81
    v_mul_f32 v129, v129, v80
    v_fmac_f32 v129, v97, v81
    v_mul_f32 v130, v130, v80
    v_fmac_f32 v130, v98, v81
    v_mul_f32 v131, v131, v80
    v_fmac_f32 v131, v99, v81
    v_mul_f32 v132, v132, v80
    v_fmac_f32 v132, v100, v81
    v_mul_f32 v133, v133, v80
    v_fmac_f32 v133, v101, v81
    v_mul_f32 v134, v134, v80
    v_fmac_f32 v134, v102, v81
    v_mul_f32 v135, v135, v80
    v_fmac_f32 v135, v103, v81
    v_cvt_pk_bf16_f32 v240, v128, v129
    v_cvt_pk_bf16_f32 v241, v130, v131
    v_cvt_pk_bf16_f32 v242, v132, v133
    v_cvt_pk_bf16_f32 v243, v134, v135
    buffer_store_dwordx4 v[240:243], v3, s[28:31], s52 offen offset:0 sc1
    v_mul_f32 v136, v136, v80
    v_fmac_f32 v136, v104, v81
    v_mul_f32 v137, v137, v80
    v_fmac_f32 v137, v105, v81
    v_mul_f32 v138, v138, v80
    v_fmac_f32 v138, v106, v81
    v_mul_f32 v139, v139, v80
    v_fmac_f32 v139, v107, v81
    v_mul_f32 v140, v140, v80
    v_fmac_f32 v140, v108, v81
    v_mul_f32 v141, v141, v80
    v_fmac_f32 v141, v109, v81
    v_mul_f32 v142, v142, v80
    v_fmac_f32 v142, v110, v81
    v_mul_f32 v143, v143, v80
    v_fmac_f32 v143, v111, v81
    v_cvt_pk_bf16_f32 v244, v136, v137
    v_cvt_pk_bf16_f32 v245, v138, v139
    v_cvt_pk_bf16_f32 v246, v140, v141
    v_cvt_pk_bf16_f32 v247, v142, v143
    buffer_store_dwordx4 v[244:247], v3, s[28:31], s52 offen offset:1024 sc1
    v_mul_f32 v144, v144, v80
    v_fmac_f32 v144, v112, v81
    v_mul_f32 v145, v145, v80
    v_fmac_f32 v145, v113, v81
    v_mul_f32 v146, v146, v80
    v_fmac_f32 v146, v114, v81
    v_mul_f32 v147, v147, v80
    v_fmac_f32 v147, v115, v81
    v_mul_f32 v148, v148, v80
    v_fmac_f32 v148, v116, v81
    v_mul_f32 v149, v149, v80
    v_fmac_f32 v149, v117, v81
    v_mul_f32 v150, v150, v80
    v_fmac_f32 v150, v118, v81
    v_mul_f32 v151, v151, v80
    v_fmac_f32 v151, v119, v81
    v_cvt_pk_bf16_f32 v248, v144, v145
    v_cvt_pk_bf16_f32 v249, v146, v147
    v_cvt_pk_bf16_f32 v250, v148, v149
    v_cvt_pk_bf16_f32 v251, v150, v151
    buffer_store_dwordx4 v[248:251], v3, s[28:31], s52 offen offset:2048 sc1
    v_mul_f32 v152, v152, v80
    v_fmac_f32 v152, v120, v81
    v_mul_f32 v153, v153, v80
    v_fmac_f32 v153, v121, v81
    v_mul_f32 v154, v154, v80
    v_fmac_f32 v154, v122, v81
    v_mul_f32 v155, v155, v80
    v_fmac_f32 v155, v123, v81
    v_mul_f32 v156, v156, v80
    v_fmac_f32 v156, v124, v81
    v_mul_f32 v157, v157, v80
    v_fmac_f32 v157, v125, v81
    v_mul_f32 v158, v158, v80
    v_fmac_f32 v158, v126, v81
    v_mul_f32 v159, v159, v80
    v_fmac_f32 v159, v127, v81
    v_cvt_pk_bf16_f32 v252, v152, v153
    v_cvt_pk_bf16_f32 v253, v154, v155
    v_cvt_pk_bf16_f32 v254, v156, v157
    v_cvt_pk_bf16_f32 v255, v158, v159
    buffer_store_dwordx4 v[252:255], v3, s[28:31], s52 offen offset:3072 sc1
    s_waitcnt vmcnt(4)
    s_cmp_lg_u32 s32, 0
    s_cbranch_scc1 .Lkvproj_kernel_chk_49
    v_cmp_ne_u32 vcc, 1, v11
    s_cbranch_vccz .Lkvproj_kernel_cok_50
    s_mov_b32 s52, 0x40000
.Lkvproj_kernel_poll_51:
    buffer_load_dword v11, v10, s[88:91], 0 offen sc1
    s_waitcnt vmcnt(0)
    v_cmp_ne_u32 vcc, 1, v11
    s_cbranch_vccz .Lkvproj_kernel_pdone_52
    s_sub_u32 s52, s52, 1
    s_sleep 2
    s_cmp_lg_u32 s52, 0
    s_cbranch_scc1 .Lkvproj_kernel_poll_51
.Lkvproj_kernel_pdone_52:
.Lkvproj_kernel_cok_50:
.Lkvproj_kernel_chk_49:
.Lk3_begin:
    s_load_dwordx2 s[34:35], s[0:1], 40
    s_load_dwordx2 s[36:37], s[0:1], 72
    s_load_dwordx2 s[40:41], s[0:1], 96
    s_load_dwordx2 s[56:57], s[0:1], 0
    s_load_dwordx4 s[60:63], s[0:1], 80
    v_lshrrev_b32 v1, 6, v0
    v_and_b32 v2, 63, v0
    v_readfirstlane_b32 s24, v1
    s_and_b32 s42, s2, 7
    s_lshr_b32 s50, s42, 1
    s_and_b32 s42, s42, 1
    s_lshr_b32 s43, s2, 5
    s_lshl_b32 s42, s42, 3
    s_add_u32 s42, s42, s43
    s_lshr_b32 s44, s2, 3
    s_and_b32 s44, s44, 3
    s_lshl_b32 s25, s24, 12
    s_lshl_b32 s45, s44, 1
    s_add_u32 s45, s45, s43
    s_sub_u32 s46, s45, 7
    s_cmp_ge_u32 s45, 7
    s_cselect_b32 s30, s46, s45
    s_lshl_b32 s45, s45, 1
    s_and_b32 s45, s45, 15
    s_add_u32 s31, s45, 7
    v_lshlrev_b32 v3, 4, v2
    v_lshrrev_b32 v6, 5, v2
    v_lshlrev_b32 v6, 2, v6
    v_bfe_u32 v7, v2, 2, 2
    v_add_u32 v6, v6, v7
    v_bfe_u32 v7, v2, 4, 1
    v_lshlrev_b32 v7, 6, v7
    v_and_b32 v8, 3, v2
    v_lshl_add_u32 v7, v8, 4, v7
    v_lshl_add_u32 v4, v6, 10, v7
    v_add_u32 v5, 7168, v4
    s_mul_i32 s45, s50, 28
    s_lshr_b32 s46, s24, 1
    s_add_u32 s47, s45, s46
    s_lshl_b32 s58, s50, 6
    s_sub_u32 s58, s58, 28
    s_add_u32 s48, s58, s46
    s_lshl_b32 s49, s44, 8
    s_and_b32 s52, s24, 1
    s_lshl_b32 s53, s52, 7
    s_add_u32 s49, s49, s53
    s_lshl_b32 s53, s47, 14
    s_add_u32 s26, s53, s49
    s_lshl_b32 s53, s48, 14
    s_add_u32 s27, s53, s49
    s_lshl_b32 s53, s42, 2
    s_add_u32 s53, s53, s46
    s_mul_i32 s53, s53, 368
    s_lshl_b32 s52, s52, 1
    s_add_u32 s53, s53, s52
    s_add_u32 s58, s58, s53
    s_lshl_b32 s58, s58, 10
    s_add_u32 s53, s53, s45
    s_add_u32 s53, s53, 256
    s_lshl_b32 s28, s53, 10
    s_waitcnt lgkmcnt(0)
    s_mov_b32 s4, s36
    s_and_b32 s5, s37, 0xffff
    s_mov_b32 s6, 0x1c0000
    s_mov_b32 s7, 0x00020000
    s_add_u32 s12, s40, 0x21ff800
    s_addc_u32 s13, s41, 0
    s_and_b32 s13, s13, 0xffff
    s_mov_b32 s14, 0x1700800
    s_mov_b32 s15, 0x00020000
    s_add_u32 s68, s40, 0x6000000
    s_addc_u32 s69, s41, 0
    s_and_b32 s69, s69, 0xffff
    s_mov_b32 s70, 0x60000
    s_mov_b32 s71, 0x00020000
    s_sub_u32 s45, 7, s43
    s_bitcmp1_b32 s2, 0
    s_cselect_b32 s45, s45, s43
    s_lshl_b32 s45, s45, 13
    v_and_b32 v13, 31, v2
    v_lshl_add_u32 v13, v13, 8, s45
    s_cmp_lg_u32 s24, 0
    s_cselect_b32 s94, 0x4000, 2
    s_lshl_b32 s94, s94, 16
    v_add_u32 v13, s94, v13
    s_barrier
    s_add_u32 m0, s25, 0x0
    s_lshl_b32 s29, s30, 16
    s_add_u32 s29, s29, s26
    buffer_load_dwordx4 v4, s[4:7], s29 offen lds
    buffer_load_dwordx4 v5, s[4:7], s29 offen offset:1024 lds
    s_lshl_b32 s29, s30, 12
    s_add_u32 s29, s29, s28
    buffer_load_dwordx4 v3, s[12:15], s29 offen offset:2048 lds
    buffer_load_dwordx4 v3, s[12:15], s29 offen offset:3072 lds
    s_add_u32 s30, s30, 1
    s_cmp_eq_u32 s30, 7
    s_cselect_b32 s30, 0, s30
    s_add_u32 m0, s25, 0x8000
    s_lshl_b32 s29, s30, 16
    s_add_u32 s29, s29, s26
    buffer_load_dwordx4 v4, s[4:7], s29 offen lds
    buffer_load_dwordx4 v5, s[4:7], s29 offen offset:1024 lds
    s_lshl_b32 s29, s30, 12
    s_add_u32 s29, s29, s28
    buffer_load_dwordx4 v3, s[12:15], s29 offen offset:2048 lds
    buffer_load_dwordx4 v3, s[12:15], s29 offen offset:3072 lds
    s_add_u32 s30, s30, 1
    s_cmp_eq_u32 s30, 7
    s_cselect_b32 s30, 0, s30
    s_mov_b32 s8, s34
    s_and_b32 s9, s35, 0xffff
    s_mov_b32 s10, 0x400000
    s_mov_b32 s11, 0x00020000
    s_add_u32 s16, s40, 0x4000000
    s_addc_u32 s17, s41, 0
    s_and_b32 s17, s17, 0xffff
    s_mov_b32 s18, 0x1000000
    s_mov_b32 s19, 0x00020000
    s_lshr_b32 s45, s24, 2
    s_and_b32 s46, s24, 3
    s_lshl_b32 s47, s45, 14
    s_add_u32 s47, s47, 2048
    v_add_u32 v8, s47, v3
    v_add_u32 v9, 0x10000, v8
    v_lshrrev_b32 v6, 5, v2
    v_lshlrev_b32 v6, 9, v6
    v_bfe_u32 v7, v2, 2, 2
    v_lshl_add_u32 v6, v7, 6, v6
    v_bfe_u32 v7, v2, 4, 1
    v_lshl_add_u32 v6, v7, 5, v6
    v_and_b32 v7, 3, v2
    v_lshl_add_u32 v6, v7, 3, v6
    s_lshr_b32 s47, s46, 1
    s_lshl_b32 s47, s47, 12
    s_and_b32 s48, s46, 1
    s_lshl_b32 s48, s48, 8
    s_add_u32 s47, s47, s48
    v_add_u32 v10, s47, v6
    v_add_u32 v11, 0x10000, v10
    s_lshl_b32 s47, s42, 2
    s_lshl_b32 s48, s45, 1
    s_add_u32 s47, s47, s48
    s_lshl_b32 s47, s47, 4
    s_lshl_b32 s48, s44, 2
    s_add_u32 s47, s47, s48
    s_add_u32 s47, s47, s46
    s_lshl_b32 s47, s47, 11
    s_lshl_b32 s48, s50, 21
    s_add_u32 s51, s47, s48
    s_add_u32 s54, s51, 0x800000
    s_waitcnt vmcnt(8)
    s_barrier
    s_cmp_lg_u32 s24, 0
    s_cbranch_scc1 .Lk3_nw
    s_waitcnt vmcnt(63)
    s_lshl_b32 s45, s2, 8
    s_add_u32 s45, s45, 0x20000
    v_mov_b32 v6, s45
    v_mov_b32 v7, 1
    s_mov_b64 exec, 1
    buffer_store_dword v7, v6, s[68:71], 0 offen sc1
    s_mov_b64 exec, -1
.Lk3_nw:
    s_add_u32 m0, s25, 0x10000
    s_lshl_b32 s29, s30, 16
    s_add_u32 s29, s29, s26
    buffer_load_dwordx4 v4, s[4:7], s29 offen lds
    buffer_load_dwordx4 v5, s[4:7], s29 offen offset:1024 lds
    s_lshl_b32 s29, s30, 12
    s_add_u32 s29, s29, s28
    buffer_load_dwordx4 v3, s[12:15], s29 offen offset:2048 lds
    buffer_load_dwordx4 v3, s[12:15], s29 offen offset:3072 lds
    s_add_u32 s30, s30, 1
    s_cmp_eq_u32 s30, 7
    s_cselect_b32 s30, 0, s30
    s_waitcnt vmcnt(8)
    s_barrier
    ds_read_b64_tr_b16 v[32:33], v10 offset:0
    ds_read_b64_tr_b16 v[34:35], v10 offset:1024
    ds_read_b128 v[36:39], v8 offset:0
    ds_read_b128 v[40:43], v8 offset:8192
    ds_read_b64_tr_b16 v[44:45], v10 offset:8192
    ds_read_b64_tr_b16 v[46:47], v10 offset:9216
    ds_read_b128 v[48:51], v8 offset:1024
    ds_read_b128 v[52:55], v8 offset:9216
    ds_read_b64_tr_b16 v[56:57], v10 offset:16384
    ds_read_b64_tr_b16 v[58:59], v10 offset:17408
    ds_read_b128 v[60:63], v8 offset:4096
    ds_read_b128 v[64:67], v8 offset:12288
    ds_read_b64_tr_b16 v[68:69], v10 offset:24576
    ds_read_b64_tr_b16 v[70:71], v10 offset:25600
    ds_read_b128 v[72:75], v8 offset:5120
    ds_read_b128 v[76:79], v8 offset:13312
    s_waitcnt lgkmcnt(12)
    v_mfma_f32_32x32x16_bf16 v[128:143], v[32:35], v[36:39], 0
    s_add_u32 m0, s25, 0x18000
    s_lshl_b32 s29, s30, 16
    s_add_u32 s29, s29, s26
    buffer_load_dwordx4 v4, s[4:7], s29 offen lds
    v_mfma_f32_32x32x16_bf16 v[144:159], v[32:35], v[40:43], 0
    buffer_load_dwordx4 v5, s[4:7], s29 offen offset:1024 lds
    s_lshl_b32 s29, s30, 12
    s_add_u32 s29, s29, s28
    s_waitcnt lgkmcnt(8)
    v_mfma_f32_32x32x16_bf16 v[128:143], v[44:47], v[48:51], v[128:143]
    buffer_load_dwordx4 v3, s[12:15], s29 offen offset:2048 lds
    v_mfma_f32_32x32x16_bf16 v[144:159], v[44:47], v[52:55], v[144:159]
    buffer_load_dwordx4 v3, s[12:15], s29 offen offset:3072 lds
    s_add_u32 s30, s30, 1
    s_cmp_eq_u32 s30, 7
    s_cselect_b32 s30, 0, s30
    s_waitcnt vmcnt(8) lgkmcnt(0)
    s_barrier
    ds_read_b64_tr_b16 v[80:81], v10 offset:32768
    ds_read_b64_tr_b16 v[82:83], v10 offset:33792
    ds_read_b128 v[84:87], v8 offset:32768
    ds_read_b128 v[88:91], v8 offset:40960
    v_mfma_f32_32x32x16_bf16 v[128:143], v[56:59], v[60:63], v[128:143]
    ds_read_b64_tr_b16 v[92:93], v10 offset:40960
    ds_read_b64_tr_b16 v[94:95], v10 offset:41984
    ds_read_b128 v[96:99], v8 offset:33792
    ds_read_b128 v[100:103], v8 offset:41984
    s_add_u32 m0, s25, 0x0
    s_lshl_b32 s29, s30, 16
    s_add_u32 s29, s29, s26
    buffer_load_dwordx4 v4, s[4:7], s29 offen lds
    v_mfma_f32_32x32x16_bf16 v[144:159], v[56:59], v[64:67], v[144:159]
    ds_read_b64_tr_b16 v[104:105], v10 offset:49152
    ds_read_b64_tr_b16 v[106:107], v10 offset:50176
    ds_read_b128 v[108:111], v8 offset:36864
    ds_read_b128 v[112:115], v8 offset:45056
    buffer_load_dwordx4 v5, s[4:7], s29 offen offset:1024 lds
    s_lshl_b32 s29, s30, 12
    s_add_u32 s29, s29, s28
    v_mfma_f32_32x32x16_bf16 v[128:143], v[68:71], v[72:75], v[128:143]
    ds_read_b64_tr_b16 v[116:117], v10 offset:57344
    ds_read_b64_tr_b16 v[118:119], v10 offset:58368
    ds_read_b128 v[120:123], v8 offset:37888
    ds_read_b128 v[124:127], v8 offset:46080
    buffer_load_dwordx4 v3, s[12:15], s29 offen offset:2048 lds
    v_mfma_f32_32x32x16_bf16 v[144:159], v[68:71], v[76:79], v[144:159]
    buffer_load_dwordx4 v3, s[12:15], s29 offen offset:3072 lds
    s_add_u32 s30, s30, 1
    s_cmp_eq_u32 s30, 7
    s_cselect_b32 s30, 0, s30
    s_waitcnt lgkmcnt(12)
    v_mfma_f32_32x32x16_bf16 v[128:143], v[80:83], v[84:87], v[128:143]
    v_mfma_f32_32x32x16_bf16 v[144:159], v[80:83], v[88:91], v[144:159]
    s_waitcnt lgkmcnt(8)
    v_mfma_f32_32x32x16_bf16 v[128:143], v[92:95], v[96:99], v[128:143]
    v_mfma_f32_32x32x16_bf16 v[144:159], v[92:95], v[100:103], v[144:159]
    s_waitcnt vmcnt(8) lgkmcnt(0)
    s_barrier
    ds_read_b64_tr_b16 v[32:33], v11 offset:0
    ds_read_b64_tr_b16 v[34:35], v11 offset:1024
    ds_read_b128 v[36:39], v9 offset:0
    ds_read_b128 v[40:43], v9 offset:8192
    v_mfma_f32_32x32x16_bf16 v[128:143], v[104:107], v[108:111], v[128:143]
    ds_read_b64_tr_b16 v[44:45], v11 offset:8192
    ds_read_b64_tr_b16 v[46:47], v11 offset:9216
    ds_read_b128 v[48:51], v9 offset:1024
    ds_read_b128 v[52:55], v9 offset:9216
    s_add_u32 m0, s25, 0x8000
    s_lshl_b32 s29, s30, 16
    s_add_u32 s29, s29, s26
    buffer_load_dwordx4 v4, s[4:7], s29 offen lds
    v_mov_b32 v14, 0
    buffer_load_dword v14, v13, s[68:71], 0 offen sc1
    v_mfma_f32_32x32x16_bf16 v[144:159], v[104:107], v[112:115], v[144:159]
    ds_read_b64_tr_b16 v[56:57], v11 offset:16384
    ds_read_b64_tr_b16 v[58:59], v11 offset:17408
    ds_read_b128 v[60:63], v9 offset:4096
    ds_read_b128 v[64:67], v9 offset:12288
    v_mfma_f32_32x32x16_bf16 v[128:143], v[116:119], v[120:123], v[128:143]
    ds_read_b64_tr_b16 v[68:69], v11 offset:24576
    ds_read_b64_tr_b16 v[70:71], v11 offset:25600
    ds_read_b128 v[72:75], v9 offset:5120
    ds_read_b128 v[76:79], v9 offset:13312
    buffer_load_dwordx4 v5, s[4:7], s29 offen offset:1024 lds
    s_lshl_b32 s29, s30, 12
    s_add_u32 s29, s29, s28
    v_mfma_f32_32x32x16_bf16 v[144:159], v[116:119], v[124:127], v[144:159]
    s_waitcnt lgkmcnt(12)
    v_mfma_f32_32x32x16_bf16 v[128:143], v[32:35], v[36:39], v[128:143]
    buffer_load_dwordx4 v3, s[12:15], s29 offen offset:2048 lds
    v_mfma_f32_32x32x16_bf16 v[144:159], v[32:35], v[40:43], v[144:159]
    s_waitcnt lgkmcnt(8)
    v_mfma_f32_32x32x16_bf16 v[128:143], v[44:47], v[48:51], v[128:143]
    buffer_load_dwordx4 v3, s[12:15], s29 offen offset:3072 lds
    s_add_u32 s30, s30, 1
    s_cmp_eq_u32 s30, 7
    s_cselect_b32 s30, 0, s30
    v_mfma_f32_32x32x16_bf16 v[144:159], v[44:47], v[52:55], v[144:159]
    s_waitcnt vmcnt(9) lgkmcnt(0)
    s_barrier
    ds_read_b64_tr_b16 v[80:81], v11 offset:32768
    ds_read_b64_tr_b16 v[82:83], v11 offset:33792
    ds_read_b128 v[84:87], v9 offset:32768
    ds_read_b128 v[88:91], v9 offset:40960
    v_mfma_f32_32x32x16_bf16 v[128:143], v[56:59], v[60:63], v[128:143]
    ds_read_b64_tr_b16 v[92:93], v11 offset:40960
    ds_read_b64_tr_b16 v[94:95], v11 offset:41984
    ds_read_b128 v[96:99], v9 offset:33792
    ds_read_b128 v[100:103], v9 offset:41984
    s_add_u32 m0, s25, 0x10000
    s_lshl_b32 s29, s30, 16
    s_add_u32 s29, s29, s26
    buffer_load_dwordx4 v4, s[4:7], s29 offen lds
    v_mfma_f32_32x32x16_bf16 v[144:159], v[56:59], v[64:67], v[144:159]
    ds_read_b64_tr_b16 v[104:105], v11 offset:49152
    ds_read_b64_tr_b16 v[106:107], v11 offset:50176
    ds_read_b128 v[108:111], v9 offset:36864
    ds_read_b128 v[112:115], v9 offset:45056
    v_mfma_f32_32x32x16_bf16 v[128:143], v[68:71], v[72:75], v[128:143]
    ds_read_b64_tr_b16 v[116:117], v11 offset:57344
    ds_read_b64_tr_b16 v[118:119], v11 offset:58368
    ds_read_b128 v[120:123], v9 offset:37888
    ds_read_b128 v[124:127], v9 offset:46080
    buffer_load_dwordx4 v5, s[4:7], s29 offen offset:1024 lds
    s_lshl_b32 s29, s30, 12
    s_add_u32 s29, s29, s28
    v_mfma_f32_32x32x16_bf16 v[144:159], v[68:71], v[76:79], v[144:159]
    s_waitcnt lgkmcnt(12)
    v_mfma_f32_32x32x16_bf16 v[128:143], v[80:83], v[84:87], v[128:143]
    buffer_load_dwordx4 v3, s[12:15], s29 offen offset:2048 lds
    v_mfma_f32_32x32x16_bf16 v[144:159], v[80:83], v[88:91], v[144:159]
    s_waitcnt lgkmcnt(8)
    v_mfma_f32_32x32x16_bf16 v[128:143], v[92:95], v[96:99], v[128:143]
    buffer_load_dwordx4 v3, s[12:15], s29 offen offset:3072 lds
    s_add_u32 s30, s30, 1
    s_cmp_eq_u32 s30, 7
    s_cselect_b32 s30, 0, s30
    v_mfma_f32_32x32x16_bf16 v[144:159], v[92:95], v[100:103], v[144:159]
    s_waitcnt vmcnt(9) lgkmcnt(0)
    s_waitcnt vmcnt(7)
    s_cmp_lg_u32 s24, 0
    s_cbranch_scc1 .Lkvproj_kernel_chk_53
    v_cmp_ne_u32 vcc, 1, v14
    s_cbranch_vccz .Lkvproj_kernel_cok_54
    s_mov_b32 s45, 0x40000
.Lkvproj_kernel_poll_55:
    buffer_load_dword v14, v13, s[68:71], 0 offen sc1
    s_waitcnt vmcnt(0)
    v_cmp_ne_u32 vcc, 1, v14
    s_cbranch_vccz .Lkvproj_kernel_pdone_56
    s_sub_u32 s45, s45, 1
    s_sleep 2
    s_cmp_lg_u32 s45, 0
    s_cbranch_scc1 .Lkvproj_kernel_poll_55
.Lkvproj_kernel_pdone_56:
.Lkvproj_kernel_cok_54:
.Lkvproj_kernel_chk_53:
    s_barrier
    ds_read_b64_tr_b16 v[32:33], v10 offset:0
    ds_read_b64_tr_b16 v[34:35], v10 offset:1024
    ds_read_b128 v[36:39], v8 offset:0
    ds_read_b128 v[40:43], v8 offset:8192
    v_mfma_f32_32x32x16_bf16 v[128:143], v[104:107], v[108:111], v[128:143]
    ds_read_b64_tr_b16 v[44:45], v10 offset:8192
    ds_read_b64_tr_b16 v[46:47], v10 offset:9216
    ds_read_b128 v[48:51], v8 offset:1024
    ds_read_b128 v[52:55], v8 offset:9216
    s_mov_b32 s30, s31
    s_mov_b32 s28, s58
    s_add_u32 m0, s25, 0x18000
    s_lshl_b32 s29, s30, 16
    s_add_u32 s29, s29, s27
    buffer_load_dwordx4 v4, s[8:11], s29 offen lds
    v_mfma_f32_32x32x16_bf16 v[144:159], v[104:107], v[112:115], v[144:159]
    ds_read_b64_tr_b16 v[56:57], v10 offset:16384
    ds_read_b64_tr_b16 v[58:59], v10 offset:17408
    ds_read_b128 v[60:63], v8 offset:4096
    ds_read_b128 v[64:67], v8 offset:12288
    v_mfma_f32_32x32x16_bf16 v[128:143], v[116:119], v[120:123], v[128:143]
    ds_read_b64_tr_b16 v[68:69], v10 offset:24576
    ds_read_b64_tr_b16 v[70:71], v10 offset:25600
    ds_read_b128 v[72:75], v8 offset:5120
    ds_read_b128 v[76:79], v8 offset:13312
    buffer_load_dwordx4 v5, s[8:11], s29 offen offset:1024 lds
    s_lshl_b32 s29, s30, 12
    s_add_u32 s29, s29, s28
    v_mfma_f32_32x32x16_bf16 v[144:159], v[116:119], v[124:127], v[144:159]
    s_waitcnt lgkmcnt(12)
    v_mfma_f32_32x32x16_bf16 v[128:143], v[32:35], v[36:39], v[128:143]
    buffer_load_dwordx4 v3, s[12:15], s29 offen offset:2048 lds
    v_mfma_f32_32x32x16_bf16 v[144:159], v[32:35], v[40:43], v[144:159]
    s_waitcnt lgkmcnt(8)
    v_mfma_f32_32x32x16_bf16 v[128:143], v[44:47], v[48:51], v[128:143]
    buffer_load_dwordx4 v3, s[12:15], s29 offen offset:3072 lds
    s_add_u32 s30, s30, 1
    s_cmp_eq_u32 s30, 23
    s_cselect_b32 s30, 7, s30
    v_mfma_f32_32x32x16_bf16 v[144:159], v[44:47], v[52:55], v[144:159]
    s_waitcnt vmcnt(8) lgkmcnt(0)
    s_barrier
    ds_read_b64_tr_b16 v[80:81], v10 offset:32768
    ds_read_b64_tr_b16 v[82:83], v10 offset:33792
    ds_read_b128 v[84:87], v8 offset:32768
    ds_read_b128 v[88:91], v8 offset:40960
    v_mfma_f32_32x32x16_bf16 v[128:143], v[56:59], v[60:63], v[128:143]
    ds_read_b64_tr_b16 v[92:93], v10 offset:40960
    ds_read_b64_tr_b16 v[94:95], v10 offset:41984
    ds_read_b128 v[96:99], v8 offset:33792
    ds_read_b128 v[100:103], v8 offset:41984
    s_add_u32 m0, s25, 0x0
    s_lshl_b32 s29, s30, 16
    s_add_u32 s29, s29, s27
    buffer_load_dwordx4 v4, s[8:11], s29 offen lds
    v_mfma_f32_32x32x16_bf16 v[144:159], v[56:59], v[64:67], v[144:159]
    ds_read_b64_tr_b16 v[104:105], v10 offset:49152
    ds_read_b64_tr_b16 v[106:107], v10 offset:50176
    ds_read_b128 v[108:111], v8 offset:36864
    ds_read_b128 v[112:115], v8 offset:45056
    v_mfma_f32_32x32x16_bf16 v[128:143], v[68:71], v[72:75], v[128:143]
    ds_read_b64_tr_b16 v[116:117], v10 offset:57344
    ds_read_b64_tr_b16 v[118:119], v10 offset:58368
    ds_read_b128 v[120:123], v8 offset:37888
    ds_read_b128 v[124:127], v8 offset:46080
    buffer_load_dwordx4 v5, s[8:11], s29 offen offset:1024 lds
    s_lshl_b32 s29, s30, 12
    s_add_u32 s29, s29, s28
    v_mfma_f32_32x32x16_bf16 v[144:159], v[68:71], v[76:79], v[144:159]
    s_waitcnt lgkmcnt(12)
    v_mfma_f32_32x32x16_bf16 v[128:143], v[80:83], v[84:87], v[128:143]
    buffer_load_dwordx4 v3, s[12:15], s29 offen offset:2048 lds
    v_mfma_f32_32x32x16_bf16 v[144:159], v[80:83], v[88:91], v[144:159]
    s_waitcnt lgkmcnt(8)
    v_mfma_f32_32x32x16_bf16 v[128:143], v[92:95], v[96:99], v[128:143]
    buffer_load_dwordx4 v3, s[12:15], s29 offen offset:3072 lds
    s_add_u32 s30, s30, 1
    s_cmp_eq_u32 s30, 23
    s_cselect_b32 s30, 7, s30
    v_mfma_f32_32x32x16_bf16 v[144:159], v[92:95], v[100:103], v[144:159]
    s_waitcnt vmcnt(8) lgkmcnt(0)
    s_barrier
    ds_read_b64_tr_b16 v[32:33], v11 offset:0
    ds_read_b64_tr_b16 v[34:35], v11 offset:1024
    ds_read_b128 v[36:39], v9 offset:0
    ds_read_b128 v[40:43], v9 offset:8192
    v_mfma_f32_32x32x16_bf16 v[128:143], v[104:107], v[108:111], v[128:143]
    ds_read_b64_tr_b16 v[44:45], v11 offset:8192
    ds_read_b64_tr_b16 v[46:47], v11 offset:9216
    ds_read_b128 v[48:51], v9 offset:1024
    ds_read_b128 v[52:55], v9 offset:9216
    s_add_u32 m0, s25, 0x8000
    s_lshl_b32 s29, s30, 16
    s_add_u32 s29, s29, s27
    buffer_load_dwordx4 v4, s[8:11], s29 offen lds
    v_mfma_f32_32x32x16_bf16 v[144:159], v[104:107], v[112:115], v[144:159]
    ds_read_b64_tr_b16 v[56:57], v11 offset:16384
    ds_read_b64_tr_b16 v[58:59], v11 offset:17408
    ds_read_b128 v[60:63], v9 offset:4096
    ds_read_b128 v[64:67], v9 offset:12288
    v_mfma_f32_32x32x16_bf16 v[128:143], v[116:119], v[120:123], v[128:143]
    ds_read_b64_tr_b16 v[68:69], v11 offset:24576
    ds_read_b64_tr_b16 v[70:71], v11 offset:25600
    ds_read_b128 v[72:75], v9 offset:5120
    ds_read_b128 v[76:79], v9 offset:13312
    buffer_load_dwordx4 v5, s[8:11], s29 offen offset:1024 lds
    s_lshl_b32 s29, s30, 12
    s_add_u32 s29, s29, s28
    v_mfma_f32_32x32x16_bf16 v[144:159], v[116:119], v[124:127], v[144:159]
    s_waitcnt lgkmcnt(12)
    v_mfma_f32_32x32x16_bf16 v[128:143], v[32:35], v[36:39], v[128:143]
    buffer_load_dwordx4 v3, s[12:15], s29 offen offset:2048 lds
    v_mfma_f32_32x32x16_bf16 v[144:159], v[32:35], v[40:43], v[144:159]
    s_waitcnt lgkmcnt(8)
    v_mfma_f32_32x32x16_bf16 v[128:143], v[44:47], v[48:51], v[128:143]
    buffer_load_dwordx4 v3, s[12:15], s29 offen offset:3072 lds
    s_add_u32 s30, s30, 1
    s_cmp_eq_u32 s30, 23
    s_cselect_b32 s30, 7, s30
    v_mfma_f32_32x32x16_bf16 v[144:159], v[44:47], v[52:55], v[144:159]
    s_waitcnt vmcnt(8) lgkmcnt(0)
    s_barrier
    ds_read_b64_tr_b16 v[80:81], v11 offset:32768
    ds_read_b64_tr_b16 v[82:83], v11 offset:33792
    ds_read_b128 v[84:87], v9 offset:32768
    ds_read_b128 v[88:91], v9 offset:40960
    v_mfma_f32_32x32x16_bf16 v[128:143], v[56:59], v[60:63], v[128:143]
    ds_read_b64_tr_b16 v[92:93], v11 offset:40960
    ds_read_b64_tr_b16 v[94:95], v11 offset:41984
    ds_read_b128 v[96:99], v9 offset:33792
    ds_read_b128 v[100:103], v9 offset:41984
    s_add_u32 m0, s25, 0x10000
    s_lshl_b32 s29, s30, 16
    s_add_u32 s29, s29, s27
    buffer_load_dwordx4 v4, s[8:11], s29 offen lds
    v_mfma_f32_32x32x16_bf16 v[144:159], v[56:59], v[64:67], v[144:159]
    ds_read_b64_tr_b16 v[104:105], v11 offset:49152
    ds_read_b64_tr_b16 v[106:107], v11 offset:50176
    ds_read_b128 v[108:111], v9 offset:36864
    ds_read_b128 v[112:115], v9 offset:45056
    v_mfma_f32_32x32x16_bf16 v[128:143], v[68:71], v[72:75], v[128:143]
    ds_read_b64_tr_b16 v[116:117], v11 offset:57344
    ds_read_b64_tr_b16 v[118:119], v11 offset:58368
    ds_read_b128 v[120:123], v9 offset:37888
    ds_read_b128 v[124:127], v9 offset:46080
    buffer_load_dwordx4 v5, s[8:11], s29 offen offset:1024 lds
    s_lshl_b32 s29, s30, 12
    s_add_u32 s29, s29, s28
    v_mfma_f32_32x32x16_bf16 v[144:159], v[68:71], v[76:79], v[144:159]
    s_waitcnt lgkmcnt(12)
    v_mfma_f32_32x32x16_bf16 v[160:175], v[80:83], v[84:87], 0
    buffer_load_dwordx4 v3, s[12:15], s29 offen offset:2048 lds
    v_mfma_f32_32x32x16_bf16 v[176:191], v[80:83], v[88:91], 0
    s_waitcnt lgkmcnt(8)
    v_mfma_f32_32x32x16_bf16 v[160:175], v[92:95], v[96:99], v[160:175]
    buffer_load_dwordx4 v3, s[12:15], s29 offen offset:3072 lds
    s_add_u32 s30, s30, 1
    s_cmp_eq_u32 s30, 23
    s_cselect_b32 s30, 7, s30
    v_mfma_f32_32x32x16_bf16 v[176:191], v[92:95], v[100:103], v[176:191]
    s_waitcnt vmcnt(8) lgkmcnt(0)
    s_barrier
    ds_read_b64_tr_b16 v[32:33], v10 offset:0
    ds_read_b64_tr_b16 v[34:35], v10 offset:1024
    ds_read_b128 v[36:39], v8 offset:0
    ds_read_b128 v[40:43], v8 offset:8192
    v_mfma_f32_32x32x16_bf16 v[160:175], v[104:107], v[108:111], v[160:175]
    ds_read_b64_tr_b16 v[44:45], v10 offset:8192
    ds_read_b64_tr_b16 v[46:47], v10 offset:9216
    ds_read_b128 v[48:51], v8 offset:1024
    ds_read_b128 v[52:55], v8 offset:9216
    s_add_u32 m0, s25, 0x18000
    s_lshl_b32 s29, s30, 16
    s_add_u32 s29, s29, s27
    buffer_load_dwordx4 v4, s[8:11], s29 offen lds
    v_mfma_f32_32x32x16_bf16 v[176:191], v[104:107], v[112:115], v[176:191]
    ds_read_b64_tr_b16 v[56:57], v10 offset:16384
    ds_read_b64_tr_b16 v[58:59], v10 offset:17408
    ds_read_b128 v[60:63], v8 offset:4096
    ds_read_b128 v[64:67], v8 offset:12288
    v_mfma_f32_32x32x16_bf16 v[160:175], v[116:119], v[120:123], v[160:175]
    ds_read_b64_tr_b16 v[68:69], v10 offset:24576
    ds_read_b64_tr_b16 v[70:71], v10 offset:25600
    ds_read_b128 v[72:75], v8 offset:5120
    ds_read_b128 v[76:79], v8 offset:13312
    buffer_load_dwordx4 v5, s[8:11], s29 offen offset:1024 lds
    s_lshl_b32 s29, s30, 12
    s_add_u32 s29, s29, s28
    v_mfma_f32_32x32x16_bf16 v[176:191], v[116:119], v[124:127], v[176:191]
    s_waitcnt lgkmcnt(12)
    v_mfma_f32_32x32x16_bf16 v[160:175], v[32:35], v[36:39], v[160:175]
    buffer_load_dwordx4 v3, s[12:15], s29 offen offset:2048 lds
    v_mfma_f32_32x32x16_bf16 v[176:191], v[32:35], v[40:43], v[176:191]
    s_waitcnt lgkmcnt(8)
    v_mfma_f32_32x32x16_bf16 v[160:175], v[44:47], v[48:51], v[160:175]
    buffer_load_dwordx4 v3, s[12:15], s29 offen offset:3072 lds
    s_add_u32 s30, s30, 1
    s_cmp_eq_u32 s30, 23
    s_cselect_b32 s30, 7, s30
    v_cvt_pk_bf16_f32 v192, v128, v129
    v_cvt_pk_bf16_f32 v193, v130, v131
    v_cvt_pk_bf16_f32 v194, v132, v133
    v_cvt_pk_bf16_f32 v195, v134, v135
    buffer_store_dwordx4 v[192:195], v3, s[16:19], s54 offen offset:0 sc1
    v_mfma_f32_32x32x16_bf16 v[176:191], v[44:47], v[52:55], v[176:191]
    s_waitcnt vmcnt(9) lgkmcnt(0)
    s_barrier
    ds_read_b64_tr_b16 v[80:81], v10 offset:32768
    ds_read_b64_tr_b16 v[82:83], v10 offset:33792
    ds_read_b128 v[84:87], v8 offset:32768
    ds_read_b128 v[88:91], v8 offset:40960
    v_mfma_f32_32x32x16_bf16 v[160:175], v[56:59], v[60:63], v[160:175]
    ds_read_b64_tr_b16 v[92:93], v10 offset:40960
    ds_read_b64_tr_b16 v[94:95], v10 offset:41984
    ds_read_b128 v[96:99], v8 offset:33792
    ds_read_b128 v[100:103], v8 offset:41984
    s_add_u32 m0, s25, 0x0
    s_lshl_b32 s29, s30, 16
    s_add_u32 s29, s29, s27
    buffer_load_dwordx4 v4, s[8:11], s29 offen lds
    v_mfma_f32_32x32x16_bf16 v[176:191], v[56:59], v[64:67], v[176:191]
    ds_read_b64_tr_b16 v[104:105], v10 offset:49152
    ds_read_b64_tr_b16 v[106:107], v10 offset:50176
    ds_read_b128 v[108:111], v8 offset:36864
    ds_read_b128 v[112:115], v8 offset:45056
    v_mfma_f32_32x32x16_bf16 v[160:175], v[68:71], v[72:75], v[160:175]
    ds_read_b64_tr_b16 v[116:117], v10 offset:57344
    ds_read_b64_tr_b16 v[118:119], v10 offset:58368
    ds_read_b128 v[120:123], v8 offset:37888
    ds_read_b128 v[124:127], v8 offset:46080
    buffer_load_dwordx4 v5, s[8:11], s29 offen offset:1024 lds
    s_lshl_b32 s29, s30, 12
    s_add_u32 s29, s29, s28
    v_mfma_f32_32x32x16_bf16 v[176:191], v[68:71], v[76:79], v[176:191]
    s_waitcnt lgkmcnt(12)
    v_mfma_f32_32x32x16_bf16 v[160:175], v[80:83], v[84:87], v[160:175]
    buffer_load_dwordx4 v3, s[12:15], s29 offen offset:2048 lds
    v_mfma_f32_32x32x16_bf16 v[176:191], v[80:83], v[88:91], v[176:191]
    s_waitcnt lgkmcnt(8)
    v_mfma_f32_32x32x16_bf16 v[160:175], v[92:95], v[96:99], v[160:175]
    buffer_load_dwordx4 v3, s[12:15], s29 offen offset:3072 lds
    s_add_u32 s30, s30, 1
    s_cmp_eq_u32 s30, 23
    s_cselect_b32 s30, 7, s30
    v_cvt_pk_bf16_f32 v196, v136, v137
    v_cvt_pk_bf16_f32 v197, v138, v139
    v_cvt_pk_bf16_f32 v198, v140, v141
    v_cvt_pk_bf16_f32 v199, v142, v143
    buffer_store_dwordx4 v[196:199], v3, s[16:19], s54 offen offset:1024 sc1
    v_mfma_f32_32x32x16_bf16 v[176:191], v[92:95], v[100:103], v[176:191]
    s_waitcnt vmcnt(10) lgkmcnt(0)
    s_barrier
    ds_read_b64_tr_b16 v[32:33], v11 offset:0
    ds_read_b64_tr_b16 v[34:35], v11 offset:1024
    ds_read_b128 v[36:39], v9 offset:0
    ds_read_b128 v[40:43], v9 offset:8192
    v_mfma_f32_32x32x16_bf16 v[160:175], v[104:107], v[108:111], v[160:175]
    ds_read_b64_tr_b16 v[44:45], v11 offset:8192
    ds_read_b64_tr_b16 v[46:47], v11 offset:9216
    ds_read_b128 v[48:51], v9 offset:1024
    ds_read_b128 v[52:55], v9 offset:9216
    s_add_u32 m0, s25, 0x8000
    s_lshl_b32 s29, s30, 16
    s_add_u32 s29, s29, s27
    buffer_load_dwordx4 v4, s[8:11], s29 offen lds
    v_mfma_f32_32x32x16_bf16 v[176:191], v[104:107], v[112:115], v[176:191]
    ds_read_b64_tr_b16 v[56:57], v11 offset:16384
    ds_read_b64_tr_b16 v[58:59], v11 offset:17408
    ds_read_b128 v[60:63], v9 offset:4096
    ds_read_b128 v[64:67], v9 offset:12288
    v_mfma_f32_32x32x16_bf16 v[160:175], v[116:119], v[120:123], v[160:175]
    ds_read_b64_tr_b16 v[68:69], v11 offset:24576
    ds_read_b64_tr_b16 v[70:71], v11 offset:25600
    ds_read_b128 v[72:75], v9 offset:5120
    ds_read_b128 v[76:79], v9 offset:13312
    buffer_load_dwordx4 v5, s[8:11], s29 offen offset:1024 lds
    s_lshl_b32 s29, s30, 12
    s_add_u32 s29, s29, s28
    v_mfma_f32_32x32x16_bf16 v[176:191], v[116:119], v[124:127], v[176:191]
    s_waitcnt lgkmcnt(12)
    v_mfma_f32_32x32x16_bf16 v[160:175], v[32:35], v[36:39], v[160:175]
    buffer_load_dwordx4 v3, s[12:15], s29 offen offset:2048 lds
    v_mfma_f32_32x32x16_bf16 v[176:191], v[32:35], v[40:43], v[176:191]
    s_waitcnt lgkmcnt(8)
    v_mfma_f32_32x32x16_bf16 v[160:175], v[44:47], v[48:51], v[160:175]
    buffer_load_dwordx4 v3, s[12:15], s29 offen offset:3072 lds
    s_add_u32 s30, s30, 1
    s_cmp_eq_u32 s30, 23
    s_cselect_b32 s30, 7, s30
    v_cvt_pk_bf16_f32 v200, v144, v145
    v_cvt_pk_bf16_f32 v201, v146, v147
    v_cvt_pk_bf16_f32 v202, v148, v149
    v_cvt_pk_bf16_f32 v203, v150, v151
    s_add_u32 s54, s54, 0x8000
    buffer_store_dwordx4 v[200:203], v3, s[16:19], s54 offen offset:0 sc1
    v_mfma_f32_32x32x16_bf16 v[176:191], v[44:47], v[52:55], v[176:191]
    s_waitcnt vmcnt(11) lgkmcnt(0)
    s_barrier
    ds_read_b64_tr_b16 v[80:81], v11 offset:32768
    ds_read_b64_tr_b16 v[82:83], v11 offset:33792
    ds_read_b128 v[84:87], v9 offset:32768
    ds_read_b128 v[88:91], v9 offset:40960
    v_mfma_f32_32x32x16_bf16 v[160:175], v[56:59], v[60:63], v[160:175]
    ds_read_b64_tr_b16 v[92:93], v11 offset:40960
    ds_read_b64_tr_b16 v[94:95], v11 offset:41984
    ds_read_b128 v[96:99], v9 offset:33792
    ds_read_b128 v[100:103], v9 offset:41984
    s_add_u32 m0, s25, 0x10000
    s_lshl_b32 s29, s30, 16
    s_add_u32 s29, s29, s27
    buffer_load_dwordx4 v4, s[8:11], s29 offen lds
    v_mfma_f32_32x32x16_bf16 v[176:191], v[56:59], v[64:67], v[176:191]
    ds_read_b64_tr_b16 v[104:105], v11 offset:49152
    ds_read_b64_tr_b16 v[106:107], v11 offset:50176
    ds_read_b128 v[108:111], v9 offset:36864
    ds_read_b128 v[112:115], v9 offset:45056
    v_mfma_f32_32x32x16_bf16 v[160:175], v[68:71], v[72:75], v[160:175]
    ds_read_b64_tr_b16 v[116:117], v11 offset:57344
    ds_read_b64_tr_b16 v[118:119], v11 offset:58368
    ds_read_b128 v[120:123], v9 offset:37888
    ds_read_b128 v[124:127], v9 offset:46080
    buffer_load_dwordx4 v5, s[8:11], s29 offen offset:1024 lds
    s_lshl_b32 s29, s30, 12
    s_add_u32 s29, s29, s28
    v_mfma_f32_32x32x16_bf16 v[176:191], v[68:71], v[76:79], v[176:191]
    s_waitcnt lgkmcnt(12)
    v_mfma_f32_32x32x16_bf16 v[160:175], v[80:83], v[84:87], v[160:175]
    buffer_load_dwordx4 v3, s[12:15], s29 offen offset:2048 lds
    v_mfma_f32_32x32x16_bf16 v[176:191], v[80:83], v[88:91], v[176:191]
    s_waitcnt lgkmcnt(8)
    v_mfma_f32_32x32x16_bf16 v[160:175], v[92:95], v[96:99], v[160:175]
    buffer_load_dwordx4 v3, s[12:15], s29 offen offset:3072 lds
    s_add_u32 s30, s30, 1
    s_cmp_eq_u32 s30, 23
    s_cselect_b32 s30, 7, s30
    v_cvt_pk_bf16_f32 v204, v152, v153
    v_cvt_pk_bf16_f32 v205, v154, v155
    v_cvt_pk_bf16_f32 v206, v156, v157
    v_cvt_pk_bf16_f32 v207, v158, v159
    buffer_store_dwordx4 v[204:207], v3, s[16:19], s54 offen offset:1024 sc1
    v_mfma_f32_32x32x16_bf16 v[176:191], v[92:95], v[100:103], v[176:191]
    s_waitcnt vmcnt(11) lgkmcnt(0)
    s_barrier
    ds_read_b64_tr_b16 v[32:33], v10 offset:0
    ds_read_b64_tr_b16 v[34:35], v10 offset:1024
    ds_read_b128 v[36:39], v8 offset:0
    ds_read_b128 v[40:43], v8 offset:8192
    v_mfma_f32_32x32x16_bf16 v[160:175], v[104:107], v[108:111], v[160:175]
    ds_read_b64_tr_b16 v[44:45], v10 offset:8192
    ds_read_b64_tr_b16 v[46:47], v10 offset:9216
    ds_read_b128 v[48:51], v8 offset:1024
    ds_read_b128 v[52:55], v8 offset:9216
    s_add_u32 m0, s25, 0x18000
    s_lshl_b32 s29, s30, 16
    s_add_u32 s29, s29, s27
    buffer_load_dwordx4 v4, s[8:11], s29 offen lds
    v_mfma_f32_32x32x16_bf16 v[176:191], v[104:107], v[112:115], v[176:191]
    ds_read_b64_tr_b16 v[56:57], v10 offset:16384
    ds_read_b64_tr_b16 v[58:59], v10 offset:17408
    ds_read_b128 v[60:63], v8 offset:4096
    ds_read_b128 v[64:67], v8 offset:12288
    v_mfma_f32_32x32x16_bf16 v[160:175], v[116:119], v[120:123], v[160:175]
    ds_read_b64_tr_b16 v[68:69], v10 offset:24576
    ds_read_b64_tr_b16 v[70:71], v10 offset:25600
    ds_read_b128 v[72:75], v8 offset:5120
    ds_read_b128 v[76:79], v8 offset:13312
    buffer_load_dwordx4 v5, s[8:11], s29 offen offset:1024 lds
    s_lshl_b32 s29, s30, 12
    s_add_u32 s29, s29, s28
    v_mfma_f32_32x32x16_bf16 v[176:191], v[116:119], v[124:127], v[176:191]
    s_waitcnt lgkmcnt(12)
    v_mfma_f32_32x32x16_bf16 v[160:175], v[32:35], v[36:39], v[160:175]
    buffer_load_dwordx4 v3, s[12:15], s29 offen offset:2048 lds
    v_mfma_f32_32x32x16_bf16 v[176:191], v[32:35], v[40:43], v[176:191]
    s_waitcnt lgkmcnt(8)
    v_mfma_f32_32x32x16_bf16 v[160:175], v[44:47], v[48:51], v[160:175]
    buffer_load_dwordx4 v3, s[12:15], s29 offen offset:3072 lds
    s_add_u32 s30, s30, 1
    s_cmp_eq_u32 s30, 23
    s_cselect_b32 s30, 7, s30
    v_mfma_f32_32x32x16_bf16 v[176:191], v[44:47], v[52:55], v[176:191]
    s_waitcnt vmcnt(10) lgkmcnt(0)
    s_barrier
    ds_read_b64_tr_b16 v[80:81], v10 offset:32768
    ds_read_b64_tr_b16 v[82:83], v10 offset:33792
    ds_read_b128 v[84:87], v8 offset:32768
    ds_read_b128 v[88:91], v8 offset:40960
    v_mfma_f32_32x32x16_bf16 v[160:175], v[56:59], v[60:63], v[160:175]
    ds_read_b64_tr_b16 v[92:93], v10 offset:40960
    ds_read_b64_tr_b16 v[94:95], v10 offset:41984
    ds_read_b128 v[96:99], v8 offset:33792
    ds_read_b128 v[100:103], v8 offset:41984
    s_add_u32 m0, s25, 0x0
    s_lshl_b32 s29, s30, 16
    s_add_u32 s29, s29, s27
    buffer_load_dwordx4 v4, s[8:11], s29 offen lds
    v_mfma_f32_32x32x16_bf16 v[176:191], v[56:59], v[64:67], v[176:191]
    ds_read_b64_tr_b16 v[104:105], v10 offset:49152
    ds_read_b64_tr_b16 v[106:107], v10 offset:50176
    ds_read_b128 v[108:111], v8 offset:36864
    ds_read_b128 v[112:115], v8 offset:45056
    v_mfma_f32_32x32x16_bf16 v[160:175], v[68:71], v[72:75], v[160:175]
    ds_read_b64_tr_b16 v[116:117], v10 offset:57344
    ds_read_b64_tr_b16 v[118:119], v10 offset:58368
    ds_read_b128 v[120:123], v8 offset:37888
    ds_read_b128 v[124:127], v8 offset:46080
    buffer_load_dwordx4 v5, s[8:11], s29 offen offset:1024 lds
    s_lshl_b32 s29, s30, 12
    s_add_u32 s29, s29, s28
    v_mfma_f32_32x32x16_bf16 v[176:191], v[68:71], v[76:79], v[176:191]
    s_waitcnt lgkmcnt(12)
    v_mfma_f32_32x32x16_bf16 v[160:175], v[80:83], v[84:87], v[160:175]
    buffer_load_dwordx4 v3, s[12:15], s29 offen offset:2048 lds
    v_mfma_f32_32x32x16_bf16 v[176:191], v[80:83], v[88:91], v[176:191]
    s_waitcnt lgkmcnt(8)
    v_mfma_f32_32x32x16_bf16 v[160:175], v[92:95], v[96:99], v[160:175]
    buffer_load_dwordx4 v3, s[12:15], s29 offen offset:3072 lds
    s_add_u32 s30, s30, 1
    s_cmp_eq_u32 s30, 23
    s_cselect_b32 s30, 7, s30
    v_mfma_f32_32x32x16_bf16 v[176:191], v[92:95], v[100:103], v[176:191]
    s_waitcnt vmcnt(9) lgkmcnt(0)
    s_barrier
    ds_read_b64_tr_b16 v[32:33], v11 offset:0
    ds_read_b64_tr_b16 v[34:35], v11 offset:1024
    ds_read_b128 v[36:39], v9 offset:0
    ds_read_b128 v[40:43], v9 offset:8192
    v_mfma_f32_32x32x16_bf16 v[160:175], v[104:107], v[108:111], v[160:175]
    ds_read_b64_tr_b16 v[44:45], v11 offset:8192
    ds_read_b64_tr_b16 v[46:47], v11 offset:9216
    ds_read_b128 v[48:51], v9 offset:1024
    ds_read_b128 v[52:55], v9 offset:9216
    s_add_u32 m0, s25, 0x8000
    s_lshl_b32 s29, s30, 16
    s_add_u32 s29, s29, s27
    buffer_load_dwordx4 v4, s[8:11], s29 offen lds
    v_mfma_f32_32x32x16_bf16 v[176:191], v[104:107], v[112:115], v[176:191]
    ds_read_b64_tr_b16 v[56:57], v11 offset:16384
    ds_read_b64_tr_b16 v[58:59], v11 offset:17408
    ds_read_b128 v[60:63], v9 offset:4096
    ds_read_b128 v[64:67], v9 offset:12288
    v_mfma_f32_32x32x16_bf16 v[160:175], v[116:119], v[120:123], v[160:175]
    ds_read_b64_tr_b16 v[68:69], v11 offset:24576
    ds_read_b64_tr_b16 v[70:71], v11 offset:25600
    ds_read_b128 v[72:75], v9 offset:5120
    ds_read_b128 v[76:79], v9 offset:13312
    buffer_load_dwordx4 v5, s[8:11], s29 offen offset:1024 lds
    s_lshl_b32 s29, s30, 12
    s_add_u32 s29, s29, s28
    v_mfma_f32_32x32x16_bf16 v[176:191], v[116:119], v[124:127], v[176:191]
    s_waitcnt lgkmcnt(12)
    v_mfma_f32_32x32x16_bf16 v[160:175], v[32:35], v[36:39], v[160:175]
    buffer_load_dwordx4 v3, s[12:15], s29 offen offset:2048 lds
    v_mfma_f32_32x32x16_bf16 v[176:191], v[32:35], v[40:43], v[176:191]
    s_waitcnt lgkmcnt(8)
    v_mfma_f32_32x32x16_bf16 v[160:175], v[44:47], v[48:51], v[160:175]
    buffer_load_dwordx4 v3, s[12:15], s29 offen offset:3072 lds
    s_add_u32 s30, s30, 1
    s_cmp_eq_u32 s30, 23
    s_cselect_b32 s30, 7, s30
    v_mfma_f32_32x32x16_bf16 v[176:191], v[44:47], v[52:55], v[176:191]
    s_waitcnt vmcnt(8) lgkmcnt(0)
    s_barrier
    ds_read_b64_tr_b16 v[80:81], v11 offset:32768
    ds_read_b64_tr_b16 v[82:83], v11 offset:33792
    ds_read_b128 v[84:87], v9 offset:32768
    ds_read_b128 v[88:91], v9 offset:40960
    v_mfma_f32_32x32x16_bf16 v[160:175], v[56:59], v[60:63], v[160:175]
    ds_read_b64_tr_b16 v[92:93], v11 offset:40960
    ds_read_b64_tr_b16 v[94:95], v11 offset:41984
    ds_read_b128 v[96:99], v9 offset:33792
    ds_read_b128 v[100:103], v9 offset:41984
    s_add_u32 m0, s25, 0x10000
    s_lshl_b32 s29, s30, 16
    s_add_u32 s29, s29, s27
    buffer_load_dwordx4 v4, s[8:11], s29 offen lds
    v_mfma_f32_32x32x16_bf16 v[176:191], v[56:59], v[64:67], v[176:191]
    ds_read_b64_tr_b16 v[104:105], v11 offset:49152
    ds_read_b64_tr_b16 v[106:107], v11 offset:50176
    ds_read_b128 v[108:111], v9 offset:36864
    ds_read_b128 v[112:115], v9 offset:45056
    v_mfma_f32_32x32x16_bf16 v[160:175], v[68:71], v[72:75], v[160:175]
    ds_read_b64_tr_b16 v[116:117], v11 offset:57344
    ds_read_b64_tr_b16 v[118:119], v11 offset:58368
    ds_read_b128 v[120:123], v9 offset:37888
    ds_read_b128 v[124:127], v9 offset:46080
    buffer_load_dwordx4 v5, s[8:11], s29 offen offset:1024 lds
    s_lshl_b32 s29, s30, 12
    s_add_u32 s29, s29, s28
    v_mfma_f32_32x32x16_bf16 v[176:191], v[68:71], v[76:79], v[176:191]
    s_waitcnt lgkmcnt(12)
    v_mfma_f32_32x32x16_bf16 v[160:175], v[80:83], v[84:87], v[160:175]
    buffer_load_dwordx4 v3, s[12:15], s29 offen offset:2048 lds
    v_mfma_f32_32x32x16_bf16 v[176:191], v[80:83], v[88:91], v[176:191]
    s_waitcnt lgkmcnt(8)
    v_mfma_f32_32x32x16_bf16 v[160:175], v[92:95], v[96:99], v[160:175]
    buffer_load_dwordx4 v3, s[12:15], s29 offen offset:3072 lds
    s_add_u32 s30, s30, 1
    s_cmp_eq_u32 s30, 23
    s_cselect_b32 s30, 7, s30
    v_mfma_f32_32x32x16_bf16 v[176:191], v[92:95], v[100:103], v[176:191]
    s_waitcnt vmcnt(8) lgkmcnt(0)
    s_barrier
    ds_read_b64_tr_b16 v[32:33], v10 offset:0
    ds_read_b64_tr_b16 v[34:35], v10 offset:1024
    ds_read_b128 v[36:39], v8 offset:0
    ds_read_b128 v[40:43], v8 offset:8192
    s_cmp_lg_u32 s24, 0
    s_cbranch_scc1 .Lk3_n6
    s_waitcnt vmcnt(63)
    s_lshl_b32 s79, s2, 8
    s_add_u32 s79, s79, 0x50000
    v_mov_b32 v212, s79
    v_mov_b32 v213, 1
    s_mov_b64 exec, 1
    buffer_store_dword v213, v212, s[68:71], 0 offen sc1
    s_mov_b64 exec, -1
.Lk3_n6:
    v_lshrrev_b32 v210, 3, v2
    v_and_b32 v211, 7, v2
    v_lshrrev_b32 v208, 4, v2
    v_lshlrev_b32 v208, 10, v208
    v_lshl_add_u32 v208, v211, 4, v208
    v_and_b32 v209, 8, v2
    v_add_u32 v208, v208, v209
    v_lshlrev_b32 v209, 10, v211
    v_lshl_add_u32 v209, v210, 4, v209
    s_lshl_b32 s74, s42, 2
    s_add_u32 s74, s74, s50
    s_lshl_b32 s74, s74, 15
    s_and_b32 s75, s24, 1
    s_lshl_b32 s76, s44, 1
    s_add_u32 s75, s75, s76
    s_lshr_b32 s76, s24, 1
    s_lshl_b32 s77, s75, 12
    s_lshl_b32 s78, s76, 7
    s_add_u32 s77, s77, s78
    s_add_u32 s72, s74, s77
    s_lshl_b32 s77, s75, 7
    s_lshl_b32 s78, s76, 13
    s_add_u32 s77, s77, s78
    s_add_u32 s73, s74, s77
    s_mov_b32 s80, s56
    s_and_b32 s81, s57, 0xffff
    s_mov_b32 s82, 0x200000
    s_mov_b32 s83, 0x00020000
    s_lshl_b32 s79, s2, 8
    s_andn2_b32 s79, s79, 0x600
    v_and_b32 v13, 3, v2
    v_lshlrev_b32 v13, 9, v13
    v_add_u32 v13, s79, v13
    s_cmp_lg_u32 s24, 0
    s_cselect_b32 s94, 0x4000, 5
    s_lshl_b32 s94, s94, 16
    v_add_u32 v13, s94, v13
    v_mfma_f32_32x32x16_bf16 v[160:175], v[104:107], v[108:111], v[160:175]
    ds_read_b64_tr_b16 v[44:45], v10 offset:8192
    ds_read_b64_tr_b16 v[46:47], v10 offset:9216
    ds_read_b128 v[48:51], v8 offset:1024
    ds_read_b128 v[52:55], v8 offset:9216
    s_add_u32 m0, s25, 0x18000
    s_lshl_b32 s29, s30, 16
    s_add_u32 s29, s29, s27
    buffer_load_dwordx4 v4, s[8:11], s29 offen lds
    v_mfma_f32_32x32x16_bf16 v[176:191], v[104:107], v[112:115], v[176:191]
    ds_read_b64_tr_b16 v[56:57], v10 offset:16384
    ds_read_b64_tr_b16 v[58:59], v10 offset:17408
    ds_read_b128 v[60:63], v8 offset:4096
    ds_read_b128 v[64:67], v8 offset:12288
    v_mfma_f32_32x32x16_bf16 v[160:175], v[116:119], v[120:123], v[160:175]
    ds_read_b64_tr_b16 v[68:69], v10 offset:24576
    ds_read_b64_tr_b16 v[70:71], v10 offset:25600
    ds_read_b128 v[72:75], v8 offset:5120
    ds_read_b128 v[76:79], v8 offset:13312
    buffer_load_dwordx4 v5, s[8:11], s29 offen offset:1024 lds
    s_lshl_b32 s29, s30, 12
    s_add_u32 s29, s29, s28
    v_mfma_f32_32x32x16_bf16 v[176:191], v[116:119], v[124:127], v[176:191]
    s_waitcnt lgkmcnt(12)
    v_mfma_f32_32x32x16_bf16 v[160:175], v[32:35], v[36:39], v[160:175]
    buffer_load_dwordx4 v3, s[12:15], s29 offen offset:2048 lds
    v_mfma_f32_32x32x16_bf16 v[176:191], v[32:35], v[40:43], v[176:191]
    s_waitcnt lgkmcnt(8)
    v_mfma_f32_32x32x16_bf16 v[160:175], v[44:47], v[48:51], v[160:175]
    buffer_load_dwordx4 v3, s[12:15], s29 offen offset:3072 lds
    s_add_u32 s30, s30, 1
    s_cmp_eq_u32 s30, 23
    s_cselect_b32 s30, 7, s30
    v_mfma_f32_32x32x16_bf16 v[176:191], v[44:47], v[52:55], v[176:191]
    s_waitcnt vmcnt(8) lgkmcnt(0)
    s_barrier
    ds_read_b64_tr_b16 v[80:81], v10 offset:32768
    ds_read_b64_tr_b16 v[82:83], v10 offset:33792
    ds_read_b128 v[84:87], v8 offset:32768
    ds_read_b128 v[88:91], v8 offset:40960
    v_mfma_f32_32x32x16_bf16 v[160:175], v[56:59], v[60:63], v[160:175]
    ds_read_b64_tr_b16 v[92:93], v10 offset:40960
    ds_read_b64_tr_b16 v[94:95], v10 offset:41984
    ds_read_b128 v[96:99], v8 offset:33792
    ds_read_b128 v[100:103], v8 offset:41984
    s_add_u32 m0, s25, 0x0
    s_lshl_b32 s29, s30, 16
    s_add_u32 s29, s29, s27
    buffer_load_dwordx4 v4, s[8:11], s29 offen lds
    v_mfma_f32_32x32x16_bf16 v[176:191], v[56:59], v[64:67], v[176:191]
    ds_read_b64_tr_b16 v[104:105], v10 offset:49152
    ds_read_b64_tr_b16 v[106:107], v10 offset:50176
    ds_read_b128 v[108:111], v8 offset:36864
    ds_read_b128 v[112:115], v8 offset:45056
    v_mfma_f32_32x32x16_bf16 v[160:175], v[68:71], v[72:75], v[160:175]
    ds_read_b64_tr_b16 v[116:117], v10 offset:57344
    ds_read_b64_tr_b16 v[118:119], v10 offset:58368
    ds_read_b128 v[120:123], v8 offset:37888
    ds_read_b128 v[124:127], v8 offset:46080
    buffer_load_dwordx4 v5, s[8:11], s29 offen offset:1024 lds
    s_lshl_b32 s29, s30, 12
    s_add_u32 s29, s29, s28
    v_mfma_f32_32x32x16_bf16 v[176:191], v[68:71], v[76:79], v[176:191]
    s_waitcnt lgkmcnt(12)
    v_mfma_f32_32x32x16_bf16 v[160:175], v[80:83], v[84:87], v[160:175]
    buffer_load_dwordx4 v3, s[12:15], s29 offen offset:2048 lds
    v_mfma_f32_32x32x16_bf16 v[176:191], v[80:83], v[88:91], v[176:191]
    s_waitcnt lgkmcnt(8)
    v_mfma_f32_32x32x16_bf16 v[160:175], v[92:95], v[96:99], v[160:175]
    buffer_load_dwordx4 v3, s[12:15], s29 offen offset:3072 lds
    s_add_u32 s30, s30, 1
    s_cmp_eq_u32 s30, 23
    s_cselect_b32 s30, 7, s30
    v_mfma_f32_32x32x16_bf16 v[176:191], v[92:95], v[100:103], v[176:191]
    s_waitcnt vmcnt(8) lgkmcnt(0)
    s_barrier
    ds_read_b64_tr_b16 v[32:33], v11 offset:0
    ds_read_b64_tr_b16 v[34:35], v11 offset:1024
    ds_read_b128 v[36:39], v9 offset:0
    ds_read_b128 v[40:43], v9 offset:8192
    v_mfma_f32_32x32x16_bf16 v[160:175], v[104:107], v[108:111], v[160:175]
    ds_read_b64_tr_b16 v[44:45], v11 offset:8192
    ds_read_b64_tr_b16 v[46:47], v11 offset:9216
    ds_read_b128 v[48:51], v9 offset:1024
    ds_read_b128 v[52:55], v9 offset:9216
    s_add_u32 m0, s25, 0x8000
    s_lshl_b32 s29, s30, 16
    s_add_u32 s29, s29, s27
    buffer_load_dwordx4 v4, s[8:11], s29 offen lds
    v_mfma_f32_32x32x16_bf16 v[176:191], v[104:107], v[112:115], v[176:191]
    ds_read_b64_tr_b16 v[56:57], v11 offset:16384
    ds_read_b64_tr_b16 v[58:59], v11 offset:17408
    ds_read_b128 v[60:63], v9 offset:4096
    ds_read_b128 v[64:67], v9 offset:12288
    v_mfma_f32_32x32x16_bf16 v[160:175], v[116:119], v[120:123], v[160:175]
    ds_read_b64_tr_b16 v[68:69], v11 offset:24576
    ds_read_b64_tr_b16 v[70:71], v11 offset:25600
    ds_read_b128 v[72:75], v9 offset:5120
    ds_read_b128 v[76:79], v9 offset:13312
    buffer_load_dwordx4 v5, s[8:11], s29 offen offset:1024 lds
    s_lshl_b32 s29, s30, 12
    s_add_u32 s29, s29, s28
    v_mfma_f32_32x32x16_bf16 v[176:191], v[116:119], v[124:127], v[176:191]
    s_waitcnt lgkmcnt(12)
    v_mfma_f32_32x32x16_bf16 v[160:175], v[32:35], v[36:39], v[160:175]
    buffer_load_dwordx4 v3, s[12:15], s29 offen offset:2048 lds
    v_mfma_f32_32x32x16_bf16 v[176:191], v[32:35], v[40:43], v[176:191]
    s_waitcnt lgkmcnt(8)
    v_mfma_f32_32x32x16_bf16 v[160:175], v[44:47], v[48:51], v[160:175]
    buffer_load_dwordx4 v3, s[12:15], s29 offen offset:3072 lds
    s_add_u32 s30, s30, 1
    s_cmp_eq_u32 s30, 23
    s_cselect_b32 s30, 7, s30
    v_mfma_f32_32x32x16_bf16 v[176:191], v[44:47], v[52:55], v[176:191]
    s_waitcnt vmcnt(8) lgkmcnt(0)
    s_barrier
    ds_read_b64_tr_b16 v[80:81], v11 offset:32768
    ds_read_b64_tr_b16 v[82:83], v11 offset:33792
    ds_read_b128 v[84:87], v9 offset:32768
    ds_read_b128 v[88:91], v9 offset:40960
    v_mfma_f32_32x32x16_bf16 v[160:175], v[56:59], v[60:63], v[160:175]
    ds_read_b64_tr_b16 v[92:93], v11 offset:40960
    ds_read_b64_tr_b16 v[94:95], v11 offset:41984
    ds_read_b128 v[96:99], v9 offset:33792
    ds_read_b128 v[100:103], v9 offset:41984
    s_add_u32 m0, s25, 0x10000
    s_lshl_b32 s29, s30, 16
    s_add_u32 s29, s29, s27
    buffer_load_dwordx4 v4, s[8:11], s29 offen lds
    v_mfma_f32_32x32x16_bf16 v[176:191], v[56:59], v[64:67], v[176:191]
    ds_read_b64_tr_b16 v[104:105], v11 offset:49152
    ds_read_b64_tr_b16 v[106:107], v11 offset:50176
    ds_read_b128 v[108:111], v9 offset:36864
    ds_read_b128 v[112:115], v9 offset:45056
    v_mfma_f32_32x32x16_bf16 v[160:175], v[68:71], v[72:75], v[160:175]
    ds_read_b64_tr_b16 v[116:117], v11 offset:57344
    ds_read_b64_tr_b16 v[118:119], v11 offset:58368
    ds_read_b128 v[120:123], v9 offset:37888
    ds_read_b128 v[124:127], v9 offset:46080
    buffer_load_dwordx4 v5, s[8:11], s29 offen offset:1024 lds
    s_lshl_b32 s29, s30, 12
    s_add_u32 s29, s29, s28
    v_mfma_f32_32x32x16_bf16 v[176:191], v[68:71], v[76:79], v[176:191]
    s_waitcnt lgkmcnt(12)
    v_mfma_f32_32x32x16_bf16 v[160:175], v[80:83], v[84:87], v[160:175]
    buffer_load_dwordx4 v3, s[12:15], s29 offen offset:2048 lds
    v_mfma_f32_32x32x16_bf16 v[176:191], v[80:83], v[88:91], v[176:191]
    s_waitcnt lgkmcnt(8)
    v_mfma_f32_32x32x16_bf16 v[160:175], v[92:95], v[96:99], v[160:175]
    buffer_load_dwordx4 v3, s[12:15], s29 offen offset:3072 lds
    s_add_u32 s30, s30, 1
    s_cmp_eq_u32 s30, 23
    s_cselect_b32 s30, 7, s30
    v_mfma_f32_32x32x16_bf16 v[176:191], v[92:95], v[100:103], v[176:191]
    s_waitcnt vmcnt(8) lgkmcnt(0)
    s_barrier
    ds_read_b64_tr_b16 v[32:33], v10 offset:0
    ds_read_b64_tr_b16 v[34:35], v10 offset:1024
    ds_read_b128 v[36:39], v8 offset:0
    ds_read_b128 v[40:43], v8 offset:8192
    v_mfma_f32_32x32x16_bf16 v[160:175], v[104:107], v[108:111], v[160:175]
    ds_read_b64_tr_b16 v[44:45], v10 offset:8192
    ds_read_b64_tr_b16 v[46:47], v10 offset:9216
    ds_read_b128 v[48:51], v8 offset:1024
    ds_read_b128 v[52:55], v8 offset:9216
    v_mov_b32 v14, 0
    buffer_load_dword v14, v13, s[68:71], 0 offen sc1
    v_mfma_f32_32x32x16_bf16 v[176:191], v[104:107], v[112:115], v[176:191]
    ds_read_b64_tr_b16 v[56:57], v10 offset:16384
    ds_read_b64_tr_b16 v[58:59], v10 offset:17408
    ds_read_b128 v[60:63], v8 offset:4096
    ds_read_b128 v[64:67], v8 offset:12288
    v_mfma_f32_32x32x16_bf16 v[160:175], v[116:119], v[120:123], v[160:175]
    ds_read_b64_tr_b16 v[68:69], v10 offset:24576
    ds_read_b64_tr_b16 v[70:71], v10 offset:25600
    ds_read_b128 v[72:75], v8 offset:5120
    ds_read_b128 v[76:79], v8 offset:13312
    v_mfma_f32_32x32x16_bf16 v[176:191], v[116:119], v[124:127], v[176:191]
    s_waitcnt lgkmcnt(12)
    v_mfma_f32_32x32x16_bf16 v[160:175], v[32:35], v[36:39], v[160:175]
    v_mfma_f32_32x32x16_bf16 v[176:191], v[32:35], v[40:43], v[176:191]
    s_waitcnt lgkmcnt(8)
    v_mfma_f32_32x32x16_bf16 v[160:175], v[44:47], v[48:51], v[160:175]
    v_mfma_f32_32x32x16_bf16 v[176:191], v[44:47], v[52:55], v[176:191]
    s_waitcnt vmcnt(5) lgkmcnt(0)
    s_barrier
    ds_read_b64_tr_b16 v[80:81], v10 offset:32768
    ds_read_b64_tr_b16 v[82:83], v10 offset:33792
    ds_read_b128 v[84:87], v8 offset:32768
    ds_read_b128 v[88:91], v8 offset:40960
    v_mfma_f32_32x32x16_bf16 v[160:175], v[56:59], v[60:63], v[160:175]
    ds_read_b64_tr_b16 v[92:93], v10 offset:40960
    ds_read_b64_tr_b16 v[94:95], v10 offset:41984
    ds_read_b128 v[96:99], v8 offset:33792
    ds_read_b128 v[100:103], v8 offset:41984
    v_mfma_f32_32x32x16_bf16 v[176:191], v[56:59], v[64:67], v[176:191]
    ds_read_b64_tr_b16 v[104:105], v10 offset:49152
    ds_read_b64_tr_b16 v[106:107], v10 offset:50176
    ds_read_b128 v[108:111], v8 offset:36864
    ds_read_b128 v[112:115], v8 offset:45056
    v_mfma_f32_32x32x16_bf16 v[160:175], v[68:71], v[72:75], v[160:175]
    ds_read_b64_tr_b16 v[116:117], v10 offset:57344
    ds_read_b64_tr_b16 v[118:119], v10 offset:58368
    ds_read_b128 v[120:123], v8 offset:37888
    ds_read_b128 v[124:127], v8 offset:46080
    v_mfma_f32_32x32x16_bf16 v[176:191], v[68:71], v[76:79], v[176:191]
    s_waitcnt lgkmcnt(12)
    v_mfma_f32_32x32x16_bf16 v[160:175], v[80:83], v[84:87], v[160:175]
    v_mfma_f32_32x32x16_bf16 v[176:191], v[80:83], v[88:91], v[176:191]
    s_waitcnt lgkmcnt(8)
    v_mfma_f32_32x32x16_bf16 v[160:175], v[92:95], v[96:99], v[160:175]
    v_mfma_f32_32x32x16_bf16 v[176:191], v[92:95], v[100:103], v[176:191]
    s_waitcnt vmcnt(1) lgkmcnt(0)
    s_waitcnt vmcnt(0)
    s_cmp_lg_u32 s24, 0
    s_cbranch_scc1 .Lkvproj_kernel_chk_57
    v_cmp_ne_u32 vcc, 1, v14
    s_cbranch_vccz .Lkvproj_kernel_cok_58
    s_mov_b32 s45, 0x40000
.Lkvproj_kernel_poll_59:
    buffer_load_dword v14, v13, s[68:71], 0 offen sc1
    s_waitcnt vmcnt(0)
    v_cmp_ne_u32 vcc, 1, v14
    s_cbranch_vccz .Lkvproj_kernel_pdone_60
    s_sub_u32 s45, s45, 1
    s_sleep 2
    s_cmp_lg_u32 s45, 0
    s_cbranch_scc1 .Lkvproj_kernel_poll_59
.Lkvproj_kernel_pdone_60:
.Lkvproj_kernel_cok_58:
.Lkvproj_kernel_chk_57:
    s_barrier
    ds_read_b64_tr_b16 v[32:33], v11 offset:0
    ds_read_b64_tr_b16 v[34:35], v11 offset:1024
    ds_read_b128 v[36:39], v9 offset:0
    ds_read_b128 v[40:43], v9 offset:8192
    buffer_load_dwordx4 v[216:219], v209, s[80:83], s73 offen
    s_add_u32 s74, s72, 0x800000
    buffer_load_dwordx2 v[192:193], v208, s[16:19], s74 offen offset:0 sc1
    buffer_load_dwordx2 v[194:195], v208, s[16:19], s74 offen offset:512 sc1
    s_add_u32 s74, s72, 0xa00000
    buffer_load_dwordx2 v[196:197], v208, s[16:19], s74 offen offset:0 sc1
    buffer_load_dwordx2 v[198:199], v208, s[16:19], s74 offen offset:512 sc1
    s_add_u32 s74, s72, 0xc00000
    buffer_load_dwordx2 v[200:201], v208, s[16:19], s74 offen offset:0 sc1
    buffer_load_dwordx2 v[202:203], v208, s[16:19], s74 offen offset:512 sc1
    s_add_u32 s74, s72, 0xe00000
    buffer_load_dwordx2 v[204:205], v208, s[16:19], s74 offen offset:0 sc1
    buffer_load_dwordx2 v[206:207], v208, s[16:19], s74 offen offset:512 sc1
    v_mfma_f32_32x32x16_bf16 v[160:175], v[104:107], v[108:111], v[160:175]
    ds_read_b64_tr_b16 v[44:45], v11 offset:8192
    ds_read_b64_tr_b16 v[46:47], v11 offset:9216
    ds_read_b128 v[48:51], v9 offset:1024
    ds_read_b128 v[52:55], v9 offset:9216
    v_mfma_f32_32x32x16_bf16 v[176:191], v[104:107], v[112:115], v[176:191]
    ds_read_b64_tr_b16 v[56:57], v11 offset:16384
    ds_read_b64_tr_b16 v[58:59], v11 offset:17408
    ds_read_b128 v[60:63], v9 offset:4096
    ds_read_b128 v[64:67], v9 offset:12288
    v_mfma_f32_32x32x16_bf16 v[160:175], v[116:119], v[120:123], v[160:175]
    ds_read_b64_tr_b16 v[68:69], v11 offset:24576
    ds_read_b64_tr_b16 v[70:71], v11 offset:25600
    ds_read_b128 v[72:75], v9 offset:5120
    ds_read_b128 v[76:79], v9 offset:13312
    v_mfma_f32_32x32x16_bf16 v[176:191], v[116:119], v[124:127], v[176:191]
    s_waitcnt lgkmcnt(12)
    v_mfma_f32_32x32x16_bf16 v[160:175], v[32:35], v[36:39], v[160:175]
    v_mfma_f32_32x32x16_bf16 v[176:191], v[32:35], v[40:43], v[176:191]
    s_waitcnt lgkmcnt(8)
    v_mfma_f32_32x32x16_bf16 v[160:175], v[44:47], v[48:51], v[160:175]
    v_mfma_f32_32x32x16_bf16 v[176:191], v[44:47], v[52:55], v[176:191]
    s_waitcnt lgkmcnt(4)
    v_mfma_f32_32x32x16_bf16 v[160:175], v[56:59], v[60:63], v[160:175]
    v_mfma_f32_32x32x16_bf16 v[176:191], v[56:59], v[64:67], v[176:191]
    s_waitcnt lgkmcnt(0)
    v_mfma_f32_32x32x16_bf16 v[160:175], v[68:71], v[72:75], v[160:175]
    v_mfma_f32_32x32x16_bf16 v[176:191], v[68:71], v[76:79], v[176:191]
    s_nop 7
    s_nop 2
    v_cvt_pk_bf16_f32 v32, v160, v161
    v_cvt_pk_bf16_f32 v33, v162, v163
    v_cvt_pk_bf16_f32 v34, v164, v165
    v_cvt_pk_bf16_f32 v35, v166, v167
    buffer_store_dwordx4 v[32:35], v3, s[16:19], s51 offen offset:0 sc1
    v_cvt_pk_bf16_f32 v36, v168, v169
    v_cvt_pk_bf16_f32 v37, v170, v171
    v_cvt_pk_bf16_f32 v38, v172, v173
    v_cvt_pk_bf16_f32 v39, v174, v175
    buffer_store_dwordx4 v[36:39], v3, s[16:19], s51 offen offset:1024 sc1
    v_cvt_pk_bf16_f32 v40, v176, v177
    v_cvt_pk_bf16_f32 v41, v178, v179
    v_cvt_pk_bf16_f32 v42, v180, v181
    v_cvt_pk_bf16_f32 v43, v182, v183
    s_add_u32 s51, s51, 0x8000
    buffer_store_dwordx4 v[40:43], v3, s[16:19], s51 offen offset:0 sc1
    v_cvt_pk_bf16_f32 v44, v184, v185
    v_cvt_pk_bf16_f32 v45, v186, v187
    v_cvt_pk_bf16_f32 v46, v188, v189
    v_cvt_pk_bf16_f32 v47, v190, v191
    buffer_store_dwordx4 v[44:47], v3, s[16:19], s51 offen offset:1024 sc1
    s_mov_b32 s8, s60
    s_and_b32 s9, s61, 0xffff
    s_mov_b32 s10, 0x200000
    s_mov_b32 s11, 0x00020000
    s_add_u32 s12, s40, 0x6000000
    s_addc_u32 s13, s41, 0
    s_and_b32 s13, s13, 0xffff
    s_mov_b32 s14, 0x60000
    s_mov_b32 s15, 0x00020000
    s_waitcnt vmcnt(0)
    s_barrier
    s_cmp_lg_u32 s24, 0
    s_cbranch_scc1 .Lk3_w3
.Lkvproj_kernel_wb_61:
    s_waitcnt vmcnt(0)
    s_lshl_b32 s46, s2, 8
    s_add_u32 s46, s46, 0x30000
    v_mov_b32 v5, s46
    v_mov_b32 v6, 1
    s_mov_b64 exec, 1
    buffer_store_dword v6, v5, s[12:15], 0 offen sc1
    s_mov_b64 exec, -1
    s_andn2_b32 s46, s46, 0x600
    v_and_b32 v5, 3, v2
    v_lshlrev_b32 v5, 9, v5
    v_add_u32 v5, s46, v5
.Lk3_w3:
    v_lshlrev_b32 v160, 16, v192
    v_and_b32 v161, 0xffff0000, v192
    v_lshlrev_b32 v162, 16, v193
    v_and_b32 v163, 0xffff0000, v193
    v_lshlrev_b32 v164, 16, v194
    v_and_b32 v165, 0xffff0000, v194
    v_lshlrev_b32 v166, 16, v195
    v_and_b32 v167, 0xffff0000, v195
    v_lshlrev_b32 v168, 16, v196
    v_and_b32 v169, 0xffff0000, v196
    v_lshlrev_b32 v170, 16, v197
    v_and_b32 v171, 0xffff0000, v197
    v_lshlrev_b32 v172, 16, v198
    v_and_b32 v173, 0xffff0000, v198
    v_lshlrev_b32 v174, 16, v199
    v_and_b32 v175, 0xffff0000, v199
    v_add_f32 v160, v160, v168
    v_add_f32 v161, v161, v169
    v_add_f32 v162, v162, v170
    v_add_f32 v163, v163, v171
    v_add_f32 v164, v164, v172
    v_add_f32 v165, v165, v173
    v_add_f32 v166, v166, v174
    v_add_f32 v167, v167, v175
    v_lshlrev_b32 v176, 16, v200
    v_and_b32 v177, 0xffff0000, v200
    v_lshlrev_b32 v178, 16, v201
    v_and_b32 v179, 0xffff0000, v201
    v_lshlrev_b32 v180, 16, v202
    v_and_b32 v181, 0xffff0000, v202
    v_lshlrev_b32 v182, 16, v203
    v_and_b32 v183, 0xffff0000, v203
    v_lshlrev_b32 v184, 16, v204
    v_and_b32 v185, 0xffff0000, v204
    v_lshlrev_b32 v186, 16, v205
    v_and_b32 v187, 0xffff0000, v205
    v_lshlrev_b32 v188, 16, v206
    v_and_b32 v189, 0xffff0000, v206
    v_lshlrev_b32 v190, 16, v207
    v_and_b32 v191, 0xffff0000, v207
    v_add_f32 v176, v176, v184
    v_add_f32 v177, v177, v185
    v_add_f32 v178, v178, v186
    v_add_f32 v179, v179, v187
    v_add_f32 v180, v180, v188
    v_add_f32 v181, v181, v189
    v_add_f32 v182, v182, v190
    v_add_f32 v183, v183, v191
    v_add_f32 v160, v160, v176
    v_add_f32 v161, v161, v177
    v_add_f32 v162, v162, v178
    v_add_f32 v163, v163, v179
    v_add_f32 v164, v164, v180
    v_add_f32 v165, v165, v181
    v_add_f32 v166, v166, v182
    v_add_f32 v167, v167, v183
    v_cvt_pk_bf16_f32 v60, v160, v161
    v_cvt_pk_bf16_f32 v61, v162, v163
    v_cvt_pk_bf16_f32 v62, v164, v165
    v_cvt_pk_bf16_f32 v63, v166, v167
    v_lshlrev_b32 v160, 16, v60
    v_and_b32 v161, 0xffff0000, v60
    v_lshlrev_b32 v162, 16, v61
    v_and_b32 v163, 0xffff0000, v61
    v_lshlrev_b32 v164, 16, v62
    v_and_b32 v165, 0xffff0000, v62
    v_lshlrev_b32 v166, 16, v63
    v_and_b32 v167, 0xffff0000, v63
    v_mul_f32 v64, 0xbfb8aa3b, v160
    v_mul_f32 v65, 0xbfb8aa3b, v161
    v_mul_f32 v66, 0xbfb8aa3b, v162
    v_mul_f32 v67, 0xbfb8aa3b, v163
    v_mul_f32 v68, 0xbfb8aa3b, v164
    v_mul_f32 v69, 0xbfb8aa3b, v165
    v_mul_f32 v70, 0xbfb8aa3b, v166
    v_mul_f32 v71, 0xbfb8aa3b, v167
    v_exp_f32 v64, v64
    v_exp_f32 v65, v65
    v_exp_f32 v66, v66
    v_exp_f32 v67, v67
    v_exp_f32 v68, v68
    v_exp_f32 v69, v69
    v_exp_f32 v70, v70
    v_exp_f32 v71, v71
    v_add_f32 v64, 1.0, v64
    v_add_f32 v65, 1.0, v65
    v_add_f32 v66, 1.0, v66
    v_add_f32 v67, 1.0, v67
    v_add_f32 v68, 1.0, v68
    v_add_f32 v69, 1.0, v69
    v_add_f32 v70, 1.0, v70
    v_add_f32 v71, 1.0, v71
    v_rcp_f32 v64, v64
    v_rcp_f32 v65, v65
    v_rcp_f32 v66, v66
    v_rcp_f32 v67, v67
    v_rcp_f32 v68, v68
    v_rcp_f32 v69, v69
    v_rcp_f32 v70, v70
    v_rcp_f32 v71, v71
    v_mul_f32 v64, v64, v160
    v_mul_f32 v65, v65, v161
    v_mul_f32 v66, v66, v162
    v_mul_f32 v67, v67, v163
    v_mul_f32 v68, v68, v164
    v_mul_f32 v69, v69, v165
    v_mul_f32 v70, v70, v166
    v_mul_f32 v71, v71, v167
    v_cvt_pk_bf16_f32 v60, v64, v65
    v_cvt_pk_bf16_f32 v61, v66, v67
    v_cvt_pk_bf16_f32 v62, v68, v69
    v_cvt_pk_bf16_f32 v63, v70, v71
    v_lshlrev_b32 v64, 16, v60
    v_and_b32 v65, 0xffff0000, v60
    v_lshlrev_b32 v66, 16, v61
    v_and_b32 v67, 0xffff0000, v61
    v_lshlrev_b32 v68, 16, v62
    v_and_b32 v69, 0xffff0000, v62
    v_lshlrev_b32 v70, 16, v63
    v_and_b32 v71, 0xffff0000, v63
    s_cmp_lg_u32 s24, 0
    s_cbranch_scc1 .Lk3_w4
    s_mov_b32 s46, 0x40000
.Lkvproj_kernel_poll_62:
    buffer_load_dword v6, v5, s[12:15], 0 offen sc1
    s_waitcnt vmcnt(0)
    v_cmp_ne_u32 vcc, 1, v6
    s_cbranch_vccz .Lkvproj_kernel_pdone_63
    s_sub_u32 s46, s46, 1
    s_sleep 1
    s_cmp_lg_u32 s46, 0
    s_cbranch_scc1 .Lkvproj_kernel_poll_62
.Lkvproj_kernel_pdone_63:
.Lk3_w4:
    s_barrier
    s_add_u32 s74, s72, 0x0
    buffer_load_dwordx2 v[72:73], v208, s[16:19], s74 offen offset:0 sc1
    buffer_load_dwordx2 v[74:75], v208, s[16:19], s74 offen offset:512 sc1
    s_add_u32 s74, s72, 0x200000
    buffer_load_dwordx2 v[76:77], v208, s[16:19], s74 offen offset:0 sc1
    buffer_load_dwordx2 v[78:79], v208, s[16:19], s74 offen offset:512 sc1
    s_add_u32 s74, s72, 0x400000
    buffer_load_dwordx2 v[80:81], v208, s[16:19], s74 offen offset:0 sc1
    buffer_load_dwordx2 v[82:83], v208, s[16:19], s74 offen offset:512 sc1
    s_add_u32 s74, s72, 0x600000
    buffer_load_dwordx2 v[84:85], v208, s[16:19], s74 offen offset:0 sc1
    buffer_load_dwordx2 v[86:87], v208, s[16:19], s74 offen offset:512 sc1
    s_waitcnt vmcnt(4)
    v_lshlrev_b32 v128, 16, v72
    v_and_b32 v129, 0xffff0000, v72
    v_lshlrev_b32 v130, 16, v73
    v_and_b32 v131, 0xffff0000, v73
    v_lshlrev_b32 v132, 16, v74
    v_and_b32 v133, 0xffff0000, v74
    v_lshlrev_b32 v134, 16, v75
    v_and_b32 v135, 0xffff0000, v75
    v_lshlrev_b32 v136, 16, v76
    v_and_b32 v137, 0xffff0000, v76
    v_lshlrev_b32 v138, 16, v77
    v_and_b32 v139, 0xffff0000, v77
    v_lshlrev_b32 v140, 16, v78
    v_and_b32 v141, 0xffff0000, v78
    v_lshlrev_b32 v142, 16, v79
    v_and_b32 v143, 0xffff0000, v79
    v_add_f32 v128, v128, v136
    v_add_f32 v129, v129, v137
    v_add_f32 v130, v130, v138
    v_add_f32 v131, v131, v139
    v_add_f32 v132, v132, v140
    v_add_f32 v133, v133, v141
    v_add_f32 v134, v134, v142
    v_add_f32 v135, v135, v143
    s_waitcnt vmcnt(0)
    v_lshlrev_b32 v144, 16, v80
    v_and_b32 v145, 0xffff0000, v80
    v_lshlrev_b32 v146, 16, v81
    v_and_b32 v147, 0xffff0000, v81
    v_lshlrev_b32 v148, 16, v82
    v_and_b32 v149, 0xffff0000, v82
    v_lshlrev_b32 v150, 16, v83
    v_and_b32 v151, 0xffff0000, v83
    v_lshlrev_b32 v152, 16, v84
    v_and_b32 v153, 0xffff0000, v84
    v_lshlrev_b32 v154, 16, v85
    v_and_b32 v155, 0xffff0000, v85
    v_lshlrev_b32 v156, 16, v86
    v_and_b32 v157, 0xffff0000, v86
    v_lshlrev_b32 v158, 16, v87
    v_and_b32 v159, 0xffff0000, v87
    v_add_f32 v144, v144, v152
    v_add_f32 v145, v145, v153
    v_add_f32 v146, v146, v154
    v_add_f32 v147, v147, v155
    v_add_f32 v148, v148, v156
    v_add_f32 v149, v149, v157
    v_add_f32 v150, v150, v158
    v_add_f32 v151, v151, v159
    v_add_f32 v128, v128, v144
    v_add_f32 v129, v129, v145
    v_add_f32 v130, v130, v146
    v_add_f32 v131, v131, v147
    v_add_f32 v132, v132, v148
    v_add_f32 v133, v133, v149
    v_add_f32 v134, v134, v150
    v_add_f32 v135, v135, v151
    v_cvt_pk_bf16_f32 v60, v128, v129
    v_cvt_pk_bf16_f32 v61, v130, v131
    v_cvt_pk_bf16_f32 v62, v132, v133
    v_cvt_pk_bf16_f32 v63, v134, v135
    v_lshlrev_b32 v128, 16, v60
    v_and_b32 v129, 0xffff0000, v60
    v_lshlrev_b32 v130, 16, v61
    v_and_b32 v131, 0xffff0000, v61
    v_lshlrev_b32 v132, 16, v62
    v_and_b32 v133, 0xffff0000, v62
    v_lshlrev_b32 v134, 16, v63
    v_and_b32 v135, 0xffff0000, v63
    v_mul_f32 v64, v64, v128
    v_mul_f32 v65, v65, v129
    v_mul_f32 v66, v66, v130
    v_mul_f32 v67, v67, v131
    v_mul_f32 v68, v68, v132
    v_mul_f32 v69, v69, v133
    v_mul_f32 v70, v70, v134
    v_mul_f32 v71, v71, v135
    v_cvt_pk_bf16_f32 v60, v64, v65
    v_cvt_pk_bf16_f32 v61, v66, v67
    v_cvt_pk_bf16_f32 v62, v68, v69
    v_cvt_pk_bf16_f32 v63, v70, v71
    v_lshlrev_b32 v64, 16, v60
    v_and_b32 v65, 0xffff0000, v60
    v_lshlrev_b32 v66, 16, v61
    v_and_b32 v67, 0xffff0000, v61
    v_lshlrev_b32 v68, 16, v62
    v_and_b32 v69, 0xffff0000, v62
    v_lshlrev_b32 v70, 16, v63
    v_and_b32 v71, 0xffff0000, v63
    v_lshlrev_b32 v160, 16, v216
    v_and_b32 v161, 0xffff0000, v216
    v_lshlrev_b32 v162, 16, v217
    v_and_b32 v163, 0xffff0000, v217
    v_lshlrev_b32 v164, 16, v218
    v_and_b32 v165, 0xffff0000, v218
    v_lshlrev_b32 v166, 16, v219
    v_and_b32 v167, 0xffff0000, v219
    v_add_f32 v64, v64, v160
    v_add_f32 v65, v65, v161
    v_add_f32 v66, v66, v162
    v_add_f32 v67, v67, v163
    v_add_f32 v68, v68, v164
    v_add_f32 v69, v69, v165
    v_add_f32 v70, v70, v166
    v_add_f32 v71, v71, v167
    v_cvt_pk_bf16_f32 v60, v64, v65
    v_cvt_pk_bf16_f32 v61, v66, v67
    v_cvt_pk_bf16_f32 v62, v68, v69
    v_cvt_pk_bf16_f32 v63, v70, v71
    buffer_store_dwordx4 v[60:63], v209, s[8:11], s73 offen
    s_endpgm
.section .rodata,"a"
.p2align 6
.amdhsa_kernel kvproj_kernel
  .amdhsa_next_free_vgpr 256
  .amdhsa_next_free_sgpr 102
  .amdhsa_accum_offset 256
  .amdhsa_group_segment_fixed_size 0
  .amdhsa_kernarg_size 104
  .amdhsa_user_sgpr_count 2
  .amdhsa_user_sgpr_kernarg_segment_ptr 1
  .amdhsa_system_sgpr_workgroup_id_x 1
.end_amdhsa_kernel
```
